```python
import torch

def _softmax(x, axis=-1):
    return torch.softmax(x, dim=axis)
def _gelu(x):
    return torch.nn.functional.gelu(x, approximate="tanh")
def _silu(x):
    return torch.nn.functional.silu(x)
def _sigmoid(x):
    return torch.sigmoid(x)
def _layernorm(x, axis=-1, eps=1e-5):
    m = x.mean(dim=axis, keepdim=True)
    v = x.var(dim=axis, keepdim=True, unbiased=False)
    return (x - m) / torch.sqrt(v + eps)
def _scatter_add(tgt, idx, src, axis=0):
    return tgt.clone().index_add_(axis, idx, src)
def _segment_sum(src, seg, n):
    out = torch.zeros((n,) + src.shape[1:], dtype=src.dtype)
    return out.index_add_(0, seg, src)
def _pad(x, pw):
    flat = tuple(v for pair in reversed(pw) for v in pair)
    return torch.nn.functional.pad(x, flat)

kernel_name = 'standalone__weight_only_int_quip__sampling'

def setup_inputs():

    _w = (lambda a: (lambda t: t.to(torch.bfloat16) if t.is_floating_point() else t)(torch.as_tensor(a)))
    B, S, D, F = 32, 8, 1024, 3584
    G = -1 if -1 > 0 else D
    D = (D // G) * G
    ng = D // G
    bits = 3 if 3 > 0 else 4
    qmax = 1 << bits
    qw = torch.randint(0, qmax, (D, F)).to(torch.int32)
    U, _ = (lambda *_a, **_k: torch.linalg.qr(*[torch.as_tensor(_x).float() for _x in _a], **_k))((lambda *s: torch.randn(*s, dtype=torch.bfloat16) * 0.05)(D, D))
    V, _ = (lambda *_a, **_k: torch.linalg.qr(*[torch.as_tensor(_x).float() for _x in _a], **_k))((lambda *s: torch.randn(*s, dtype=torch.bfloat16) * 0.05)(F, F))
    return {
        "x": _w((lambda *s: torch.randn(*s, dtype=torch.bfloat16) * 0.05)(B, S, D)),
        "qw": _w(qw),
        "scales": _w(torch.abs((lambda *s: torch.randn(*s, dtype=torch.bfloat16) * 0.05)(ng, F)) * 0.02 + 0.005),
        "zeros": _w(torch.full((ng, F), qmax / 2.0, dtype=float)),
        "U": _w(U.to(float)),
        "V": _w(V.to(float)),
    }

def reference(x, qw, scales, zeros, U, V):
    B, S, D = x.shape
    ng, F = scales.shape
    G = D // ng
    s = (lambda x, n, axis: torch.repeat_interleave(x, n, dim=axis))(scales, G, axis=0)
    z = (lambda x, n, axis: torch.repeat_interleave(x, n, dim=axis))(zeros, G, axis=0)
    wq = ((lambda x, dt: x.to(dt))(qw, x.dtype) - z) * s
    xr = torch.einsum("bsd,de->bse", x, U)
    h  = torch.einsum("bse,ef->bsf", xr, wq)
    y  = torch.einsum("bsf,fg->bsg", h, V)
    return y
```

```asm
; @launch grid=(256,1,1) block=(256,1,1) lds=163840
.amdgcn_target "amdgcn-amd-amdhsa--gfx950"
.text
.globl standalone__weight_only_int_quip__sampling_kernel
.p2align 12
.p2align 8
.type standalone__weight_only_int_quip__sampling_kernel,@function
standalone__weight_only_int_quip__sampling_kernel:
  s_cmp_ge_u32 s2, 256
  s_cbranch_scc1 L_exit
  s_load_dwordx16 s[64:79], s[0:1], 0
  s_load_dwordx2 s[80:81], s[0:1], 64
  v_lshrrev_b32 v2, 6, v0
  v_and_b32 v1, 63, v0
  v_mov_b32 v29, 0
  v_readfirstlane_b32 s3, v2
  s_and_b32 s4, s2, 7
  s_lshr_b32 s5, s2, 3
  s_mov_b32 s47, 20000
  v_lshlrev_b32 v8, 4, v1
  s_cmp_lt_u32 s5, 4
  s_cbranch_scc1 L_g1
  s_sub_u32 s5, s5, 4
  s_lshl_b32 s7, s4, 2
  s_lshr_b32 s7, 0x1016010, s7
  s_and_b32 s7, s7, 7
  s_lshr_b32 s6, s5, 2
  s_add_u32 s7, s7, s6
  s_sub_u32 s60, s7, 7
  s_cselect_b32 s7, s7, s60
  s_mul_i32 s60, s4, 7
  s_add_u32 s60, s60, s7
  s_and_b32 s63, s5, 1
  s_lshr_b32 s7, s5, 1
  s_xor_b32 s6, s6, s7
  s_and_b32 s6, s6, 1
  s_mul_i32 s6, s6, 0x44444444
  s_mov_b32 s94, 0x76543210
  s_mov_b32 s44, 0x73625140
  s_and_b32 s7, s60, 3
  s_cmp_eq_u32 s7, 1
  s_cselect_b32 s94, 0x76543210, s94
  s_cselect_b32 s44, 0x10765432, s44
  s_cmp_eq_u32 s63, 1
  s_cselect_b32 s94, s44, s94
  s_xor_b32 s94, s94, s6
  v_and_b32 v30, 15, v1
  v_lshrrev_b32 v31, 4, v1
  v_mul_u32_u24 v2, 57344, v31
  v_lshl_add_u32 v2, v30, 4, v2
  s_lshl_b32 s6, s60, 8
  v_add_u32 v2, s6, v2
  s_lshl_b32 s95, s3, 3
  s_mov_b32 s44, 0x0303f303
  s_cmp_eq_u32 s4, 2
  s_cselect_b32 s44, 0x03f30303, s44
  s_cmp_ge_u32 s4, 4
  s_cselect_b32 s44, 0x0f300f30, s44
  s_sub_u32 s7, s4, 5
  s_cmp_lt_u32 s7, 2
  s_cselect_b32 s44, 0x003f003f, s44
  s_bfm_b32 s7, s5, 0
  s_and_b32 s7, s7, s44
  s_and_b32 s6, s7, 0xaaaaaaaa
  s_bcnt1_i32_b32 s7, s7
  s_bcnt1_i32_b32 s6, s6
  s_sub_u32 s97, s5, s7
  s_min_u32 s45, s6, 4
  s_sub_u32 s7, s7, s45
  s_add_u32 s7, s7, 16
  s_add_u32 s45, s6, 24
  s_cmp_lt_u32 s6, 4
  s_cselect_b32 s45, s45, s7
  s_cmp_eq_u32 s63, 1
  s_cselect_b32 s7, s45, s7
  s_bitcmp1_b32 s44, s5
  s_cselect_b32 s97, s7, s97
  s_waitcnt lgkmcnt(0)
  s_mov_b32 s12, s66
  s_mov_b32 s13, s67
  s_mov_b32 s14, 14680064
  s_mov_b32 s15, 0x20000
  s_lshl_b32 s7, s97, 2
  s_add_u32 s7, s7, s3
  s_cmp_lt_u32 s7, 32
  s_cbranch_scc0 L_pf_x
  s_mov_b32 s16, s72
  s_mov_b32 s17, s73
  s_mov_b32 s18, 2097152
  s_mov_b32 s19, 0x20000
  v_lshrrev_b32 v28, 1, v1
  v_lshlrev_b32 v28, 11, v28
  v_and_b32 v26, 1, v1
  v_lshl_add_u32 v28, v26, 7, v28
  s_lshl_b32 s6, s7, 16
  s_lshl_b32 s44, s4, 8
  s_add_u32 s6, s6, s44
  buffer_load_dword v13, v28, s[16:19], s6 offen
  s_branch L_pf_done
L_pf_x:
  s_cmp_lt_u32 s7, 96
  s_cbranch_scc1 L_pf_x2
  s_sub_u32 s46, s7, 96
  s_getpc_b64 s[44:45]
L_pc_1:
  s_sub_u32 s44, s44, L_pc_1-standalone__weight_only_int_quip__sampling_kernel
  s_subb_u32 s45, s45, 0
  s_lshl_b32 s6, s46, 13
  s_add_u32 s6, s6, (standalone__weight_only_int_quip__sampling_kernel-standalone__weight_only_int_quip__sampling_kernel)&0xffffff80
  v_lshlrev_b32 v26, 7, v1
  v_add_u32 v26, s6, v26
  v_min_u32 v26, L_end-standalone__weight_only_int_quip__sampling_kernel-4, v26
  v_mov_b32 v27, s45
  v_add_co_u32 v26, vcc, s44, v26
  v_addc_co_u32 v27, vcc, 0, v27, vcc
  global_load_dword v13, v[26:27], off
  s_mov_b32 s24, s80
  s_mov_b32 s25, s81
  s_mov_b32 s26, 33554432
  s_mov_b32 s27, 0x20000
  s_lshl_b32 s6, s4, 4
  s_add_u32 s6, s6, s7
  s_lshl_b32 s6, s6, 12
  s_add_u32 s6, s6, 655360
  v_mov_b32 v20, -1
  v_mov_b32 v21, -1
  v_mov_b32 v22, -1
  v_mov_b32 v23, -1
  buffer_store_dwordx4 v[20:23], v8, s[24:27], s6 offen offset:0 sc1
  buffer_store_dwordx4 v[20:23], v8, s[24:27], s6 offen offset:1024 sc1
  buffer_store_dwordx4 v[20:23], v8, s[24:27], s6 offen offset:2048 sc1
  buffer_store_dwordx4 v[20:23], v8, s[24:27], s6 offen offset:3072 sc1
  s_branch L_pf_done
L_pf_x2:
  s_mov_b32 s8, s64
  s_mov_b32 s9, s65
  s_mov_b32 s10, 524288
  s_mov_b32 s11, 0x20000
  v_lshlrev_b32 v27, 7, v1
  s_and_b32 s6, s7, 15
  s_lshl_b32 s6, s6, 13
  s_sub_u32 s44, s7, 32
  s_lshr_b32 s44, s44, 4
  s_lshl_b32 s44, s44, 18
  s_add_u32 s6, s6, s44
  buffer_load_dword v13, v27, s[8:11], s6 offen
L_pf_done:
  s_mov_b32 s36, s70
  s_mov_b32 s37, s71
  s_mov_b32 s38, 7168
  s_mov_b32 s39, 0x20000
  s_lshl_b32 s6, s60, 7
  v_lshlrev_b32 v28, 3, v30
  buffer_load_dwordx2 v[18:19], v28, s[36:39], s6 offen
  s_bfe_u32 s6, s94, 0x40000
  s_add_u32 s6, s6, s95
  s_mul_i32 s45, s6, 458752
  buffer_load_dwordx4 v[32:35], v2, s[12:15], s45 offen
  s_add_u32 s44, s45, 14336
  buffer_load_dwordx4 v[36:39], v2, s[12:15], s44 offen
  s_add_u32 s44, s45, 28672
  buffer_load_dwordx4 v[40:43], v2, s[12:15], s44 offen
  s_add_u32 s44, s45, 43008
  buffer_load_dwordx4 v[44:47], v2, s[12:15], s44 offen
  s_add_u32 s44, s45, 229376
  buffer_load_dwordx4 v[48:51], v2, s[12:15], s44 offen
  s_add_u32 s44, s45, 243712
  buffer_load_dwordx4 v[52:55], v2, s[12:15], s44 offen
  s_add_u32 s44, s45, 258048
  buffer_load_dwordx4 v[56:59], v2, s[12:15], s44 offen
  s_add_u32 s44, s45, 272384
  buffer_load_dwordx4 v[60:63], v2, s[12:15], s44 offen
L_w2:
  s_and_b32 s61, s5, 3
  s_xor_b32 s61, s61, 1
  s_and_b32 s62, s4, 3
  s_lshr_b32 s6, s4, 2
  s_lshl_b32 s6, s6, 1
  s_add_u32 s62, s62, s6
  s_add_u32 s62, s62, 1
  s_and_b32 s62, s62, 3
  s_lshr_b32 s82, s4, 2
  s_mul_i32 s82, s82, 14
  s_lshr_b32 s6, s5, 1
  s_add_u32 s82, s82, s6
  s_mov_b32 s32, s68
  s_mov_b32 s33, s69
  s_mov_b32 s34, 7168
  s_mov_b32 s35, 0x20000
  s_mov_b32 s20, s74
  s_mov_b32 s21, s75
  s_mov_b32 s22, 25690112
  s_mov_b32 s23, 0x20000
  s_mov_b32 s24, s80
  s_mov_b32 s25, s81
  s_mov_b32 s26, 33554432
  s_mov_b32 s27, 0x20000
  s_mov_b32 s36, s64
  s_mov_b32 s37, s65
  s_mov_b32 s38, 524288
  s_mov_b32 s39, 0x20000
  s_lshl_b32 s7, s97, 2
  s_add_u32 s7, s7, s3
  s_and_b32 s6, s7, 15
  s_lshl_b32 s6, s6, 13
  s_sub_u32 s44, s7, 64
  s_lshr_b32 s44, s44, 4
  s_min_u32 s44, s44, 4
  s_lshl_b32 s44, s44, 18
  s_add_u32 s6, s6, s44
  s_add_u32 s80, s6, 131072
  s_mov_b32 s28, s76
  s_mov_b32 s29, s77
  s_mov_b32 s30, 1835008
  s_mov_b32 s31, 0x20000
  s_mov_b32 s40, s78
  s_mov_b32 s41, s79
  s_mov_b32 s42, 256
  s_mov_b32 s43, 0x20000
  v_lshlrev_b32 v28, 2, v31
  v_xor_b32 v28, v28, v30
  v_mul_u32_u24 v3, 28672, v31
  v_lshl_add_u32 v3, v28, 4, v3
  s_mul_i32 s83, s3, 24576
  v_lshrrev_b32 v28, 2, v30
  v_lshlrev_b32 v12, 11, v31
  v_lshl_add_u32 v12, v28, 8, v12
  v_and_b32 v11, 3, v1
  v_lshl_add_u32 v12, v11, 4, v12
  v_add_u32 v12, s83, v12
  s_add_u32 s6, s3, 1
  s_and_b32 s6, s6, 3
  v_xor_b32 v11, s6, v28
  v_lshl_add_u32 v4, v11, 6, v12
  s_add_u32 s6, s3, 2
  s_and_b32 s6, s6, 3
  v_xor_b32 v11, s6, v28
  v_lshl_add_u32 v5, v11, 6, v12
  s_add_u32 s6, s3, 3
  s_and_b32 s6, s6, 3
  v_xor_b32 v11, s6, v28
  v_lshl_add_u32 v6, v11, 6, v12
  s_add_u32 s6, s3, 4
  s_and_b32 s6, s6, 3
  v_xor_b32 v11, s6, v28
  v_lshl_add_u32 v7, v11, 6, v12
  s_mul_i32 s6, s62, 28
  s_mul_i32 s7, s3, 7
  s_add_u32 s96, s6, s7
  s_cmp_eq_u32 s63, 1
  s_mov_b32 s45, 0x5463210
  s_cselect_b32 s45, 0x6054321, s45
  s_lshl_b32 s46, s82, 8
  s_bfe_u32 s7, s45, 0x40000
  s_add_u32 s6, s96, s7
  s_lshl_b32 s72, s6, 10
  s_lshr_b32 s44, s6, 1
  s_lshl_b32 s44, s44, 5
  s_and_b32 s6, s6, 1
  s_add_u32 s44, s44, s6
  s_mul_i32 s44, s44, 14336
  s_add_u32 s64, s44, s46
  s_bfe_u32 s7, s45, 0x40004
  s_add_u32 s6, s96, s7
  s_lshl_b32 s73, s6, 10
  s_lshr_b32 s44, s6, 1
  s_lshl_b32 s44, s44, 5
  s_and_b32 s6, s6, 1
  s_add_u32 s44, s44, s6
  s_mul_i32 s44, s44, 14336
  s_add_u32 s65, s44, s46
  s_bfe_u32 s7, s45, 0x40008
  s_add_u32 s6, s96, s7
  s_lshl_b32 s74, s6, 10
  s_lshr_b32 s44, s6, 1
  s_lshl_b32 s44, s44, 5
  s_and_b32 s6, s6, 1
  s_add_u32 s44, s44, s6
  s_mul_i32 s44, s44, 14336
  s_add_u32 s66, s44, s46
  s_bfe_u32 s7, s45, 0x4000c
  s_add_u32 s6, s96, s7
  s_lshl_b32 s75, s6, 10
  s_lshr_b32 s44, s6, 1
  s_lshl_b32 s44, s44, 5
  s_and_b32 s6, s6, 1
  s_add_u32 s44, s44, s6
  s_mul_i32 s44, s44, 14336
  s_add_u32 s67, s44, s46
  s_bfe_u32 s7, s45, 0x40010
  s_add_u32 s6, s96, s7
  s_lshl_b32 s76, s6, 10
  s_lshr_b32 s44, s6, 1
  s_lshl_b32 s44, s44, 5
  s_and_b32 s6, s6, 1
  s_add_u32 s44, s44, s6
  s_mul_i32 s44, s44, 14336
  s_add_u32 s68, s44, s46
  s_bfe_u32 s7, s45, 0x40014
  s_add_u32 s6, s96, s7
  s_lshl_b32 s77, s6, 10
  s_lshr_b32 s44, s6, 1
  s_lshl_b32 s44, s44, 5
  s_and_b32 s6, s6, 1
  s_add_u32 s44, s44, s6
  s_mul_i32 s44, s44, 14336
  s_add_u32 s69, s44, s46
  s_bfe_u32 s7, s45, 0x40018
  s_add_u32 s6, s96, s7
  s_lshl_b32 s78, s6, 10
  s_lshr_b32 s44, s6, 1
  s_lshl_b32 s44, s44, 5
  s_and_b32 s6, s6, 1
  s_add_u32 s44, s44, s6
  s_mul_i32 s44, s44, 14336
  s_add_u32 s70, s44, s46
  s_bfe_u32 s6, s94, 0x40000
  s_lshl_b32 s8, s6, 10
  s_bfe_u32 s6, s94, 0x40004
  s_lshl_b32 s9, s6, 10
  s_bfe_u32 s6, s94, 0x40008
  s_lshl_b32 s10, s6, 10
  s_bfe_u32 s6, s94, 0x4000c
  s_lshl_b32 s11, s6, 10
  s_bfe_u32 s6, s94, 0x40010
  s_lshl_b32 s16, s6, 10
  s_bfe_u32 s6, s94, 0x40014
  s_lshl_b32 s17, s6, 10
  s_bfe_u32 s6, s94, 0x40018
  s_lshl_b32 s18, s6, 10
  s_bfe_u32 s6, s94, 0x4001c
  s_lshl_b32 s19, s6, 10
  s_lshl_b32 s6, s3, 13
  s_add_u32 s6, s6, 98304
  v_add_u32 v9, s6, v8
  s_lshl_b32 s6, s3, 11
  s_add_u32 s6, s6, 98304
  v_add_u32 v10, s6, v8
  v_lshlrev_b32 v11, 9, v28
  v_and_b32 v28, 3, v1
  v_lshl_add_u32 v11, v28, 2, v11
  s_lshl_b32 s6, s3, 11
  s_lshl_b32 s7, s61, 7
  s_add_u32 s6, s6, s7
  s_add_u32 s6, s6, 0
  v_add_u32 v11, s6, v11
  s_add_u32 s6, s62, 1
  s_and_b32 s84, s6, 3
  s_add_u32 s87, s84, 4
  s_add_u32 s6, s62, 2
  s_and_b32 s85, s6, 3
  s_add_u32 s88, s85, 4
  s_add_u32 s6, s62, 3
  s_and_b32 s86, s6, 3
  s_add_u32 s89, s86, 4
  s_mov_b32 s90, s62
  s_add_u32 s91, s62, 4
  v_mov_b32 v28, s84
  v_lshrrev_b32 v12, 3, v1
  v_mov_b32 v26, s85
  v_cmp_eq_u32 vcc, 1, v12
  s_nop 1
  v_cndmask_b32 v28, v28, v26, vcc
  v_mov_b32 v26, s86
  v_cmp_eq_u32 vcc, 2, v12
  s_nop 1
  v_cndmask_b32 v28, v28, v26, vcc
  v_mov_b32 v26, s87
  v_cmp_eq_u32 vcc, 3, v12
  s_nop 1
  v_cndmask_b32 v28, v28, v26, vcc
  v_mov_b32 v26, s88
  v_cmp_eq_u32 vcc, 4, v12
  s_nop 1
  v_cndmask_b32 v28, v28, v26, vcc
  v_mov_b32 v26, s89
  v_cmp_eq_u32 vcc, 5, v12
  s_nop 1
  v_cndmask_b32 v28, v28, v26, vcc
  v_mov_b32 v26, s90
  v_cmp_eq_u32 vcc, 6, v12
  s_nop 1
  v_cndmask_b32 v28, v28, v26, vcc
  v_mov_b32 v26, s91
  v_cmp_eq_u32 vcc, 7, v12
  s_nop 1
  v_cndmask_b32 v28, v28, v26, vcc
  v_lshrrev_b32 v12, 1, v28
  v_lshlrev_b32 v12, 7, v12
  v_and_b32 v28, 1, v28
  v_lshl_add_u32 v12, v28, 3, v12
  v_and_b32 v28, 7, v1
  v_min_u32 v28, 6, v28
  v_add_u32 v28, s96, v28
  v_lshrrev_b32 v26, 1, v28
  v_lshl_add_u32 v12, v26, 10, v12
  v_and_b32 v28, 1, v28
  v_lshl_add_u32 v12, v28, 2, v12
  s_lshl_b32 s6, s63, 9
  s_add_u32 s6, s6, 65536
  v_add_u32 v12, s6, v12
  v_mul_u32_u24 v28, 7168, v30
  v_lshl_add_u32 v28, v31, 4, v28
  s_lshl_b32 s6, s3, 6
  v_add_u32 v28, s6, v28
  s_mul_i32 s92, s63, 28
  s_add_u32 s92, s92, s82
  s_lshl_b32 s92, s92, 18
  s_lshl_b32 s6, s3, 11
  s_add_u32 s92, s92, s6
  s_add_u32 s92, s92, 4194304
  s_mul_i32 s93, s63, 917504
  s_add_u32 s93, s93, 2097152
  s_lshr_b32 s49, s5, 3
  s_mov_b32 s52, 0x7060500
  s_mov_b32 s53, 0x7060501
  s_mov_b32 s54, 0x7060502
  s_mov_b32 s55, 0x7060503
  s_cmp_lt_u32 s97, 24
  s_cbranch_scc1 L_armed
  s_waitcnt vmcnt(9)
  s_barrier
  s_cmp_lg_u32 s3, 0
  s_cbranch_scc1 L_arm2
  s_lshl_b32 s6, s4, 2
  s_add_u32 s6, s6, s97
  s_lshl_b32 s6, s6, 2
  v_mov_b32 v14, 1
  s_mov_b64 exec, 1
  buffer_store_dword v14, v29, s[40:43], s6 offen offset:32 sc1
  s_mov_b64 exec, -1
L_arm2:
  s_barrier
L_armed:
  s_bfe_u32 s6, s94, 0x40004
  s_add_u32 s6, s6, s95
  s_mul_i32 s45, s6, 458752
  buffer_load_dwordx4 v[64:67], v2, s[12:15], s45 offen
  s_add_u32 s44, s45, 14336
  buffer_load_dwordx4 v[68:71], v2, s[12:15], s44 offen
  s_add_u32 s44, s45, 28672
  buffer_load_dwordx4 v[72:75], v2, s[12:15], s44 offen
  s_add_u32 s44, s45, 43008
  buffer_load_dwordx4 v[76:79], v2, s[12:15], s44 offen
  s_add_u32 s44, s45, 229376
  buffer_load_dwordx4 v[80:83], v2, s[12:15], s44 offen
  s_add_u32 s44, s45, 243712
  buffer_load_dwordx4 v[84:87], v2, s[12:15], s44 offen
  s_add_u32 s44, s45, 258048
  buffer_load_dwordx4 v[88:91], v2, s[12:15], s44 offen
  s_add_u32 s44, s45, 272384
  buffer_load_dwordx4 v[92:95], v2, s[12:15], s44 offen
  s_branch L_w3
L_g1:
  s_memrealtime s[44:45]
  s_and_b32 s63, s5, 1
  s_lshr_b32 s6, s5, 1
  s_lshl_b32 s60, s4, 1
  s_add_u32 s60, s60, s6
  v_lshrrev_b32 v30, 3, v1
  v_lshrrev_b32 v31, 2, v30
  v_and_b32 v2, 3, v30
  v_lshl_add_u32 v2, v31, 3, v2
  v_lshlrev_b32 v2, 11, v2
  v_lshlrev_b32 v3, 11, v30
  v_and_b32 v30, 6, v30
  v_and_b32 v31, 7, v1
  v_xor_b32 v30, v30, v31
  v_lshl_add_u32 v2, v30, 4, v2
  v_lshl_add_u32 v3, v30, 4, v3
  s_lshl_b32 s7, s3, 11
  s_mul_i32 s83, s3, 24576
  s_add_u32 s83, s83, 65536
  s_lshl_b32 s94, s3, 15
  s_lshl_b32 s6, s60, 7
  s_add_u32 s94, s94, s6
  s_lshl_b32 s95, s63, 18
  s_lshl_b32 s6, s3, 15
  s_add_u32 s95, s95, s6
  s_waitcnt lgkmcnt(0)
  s_mov_b32 s16, s72
  s_mov_b32 s17, s73
  s_mov_b32 s18, 2097152
  s_mov_b32 s19, 0x20000
  s_mov_b32 s8, s64
  s_mov_b32 s9, s65
  s_mov_b32 s10, 524288
  s_mov_b32 s11, 0x20000
  s_add_u32 m0, s7, 0
  s_add_u32 s46, s94, 0
  buffer_load_dwordx4 v2, s[16:19], s46 offen lds
  s_add_u32 m0, m0, 1024
  s_add_u32 s46, s94, 8192
  buffer_load_dwordx4 v2, s[16:19], s46 offen lds
  s_add_u32 m0, s83, 0
  s_add_u32 s46, s95, 0
  buffer_load_dwordx4 v3, s[8:11], s46 offen lds
  s_add_u32 m0, m0, 1024
  s_add_u32 s46, s95, 16384
  buffer_load_dwordx4 v3, s[8:11], s46 offen lds
  s_mov_b32 s40, s78
  s_mov_b32 s41, s79
  s_mov_b32 s42, 256
  s_mov_b32 s43, 0x20000
  s_or_b32 s6, s2, s3
  s_cmp_lg_u32 s6, 0
  s_cbranch_scc1 L_g1_nonz
  s_mul_i32 s44, s44, 0x9E3779B1
  s_or_b32 s44, s44, 0x01010101
  v_mov_b32 v13, s44
  s_mov_b64 exec, 1
  buffer_store_dword v13, v29, s[40:43], 0 offen sc1
  s_mov_b64 exec, -1
L_g1_nonz:
  s_mov_b32 s24, s80
  s_mov_b32 s25, s81
  s_mov_b32 s26, 33554432
  s_mov_b32 s27, 0x20000
  s_lshl_b32 s92, s63, 3
  s_add_u32 s92, s92, s3
  s_lshl_b32 s92, s92, 4
  s_add_u32 s92, s92, s60
  s_lshl_b32 s92, s92, 11
  s_add_u32 s92, s92, 1048576
  s_add_u32 s96, s92, 131072
  s_add_u32 m0, s7, 8192
  s_add_u32 s46, s94, 131072
  buffer_load_dwordx4 v2, s[16:19], s46 offen lds
  s_add_u32 m0, m0, 1024
  s_add_u32 s46, s94, 139264
  buffer_load_dwordx4 v2, s[16:19], s46 offen lds
  s_add_u32 m0, s83, 2048
  s_add_u32 s46, s95, 128
  buffer_load_dwordx4 v3, s[8:11], s46 offen lds
  s_add_u32 m0, m0, 1024
  s_add_u32 s46, s95, 16512
  buffer_load_dwordx4 v3, s[8:11], s46 offen lds
  s_add_u32 m0, s7, 16384
  s_add_u32 s46, s94, 262144
  buffer_load_dwordx4 v2, s[16:19], s46 offen lds
  s_add_u32 m0, m0, 1024
  s_add_u32 s46, s94, 270336
  buffer_load_dwordx4 v2, s[16:19], s46 offen lds
  s_add_u32 m0, s83, 4096
  s_add_u32 s46, s95, 256
  buffer_load_dwordx4 v3, s[8:11], s46 offen lds
  s_add_u32 m0, m0, 1024
  s_add_u32 s46, s95, 16640
  buffer_load_dwordx4 v3, s[8:11], s46 offen lds
  v_lshrrev_b32 v30, 2, v1
  v_and_b32 v30, 7, v30
  v_lshrrev_b32 v31, 5, v1
  v_lshlrev_b32 v31, 11, v31
  v_lshl_add_u32 v31, v30, 7, v31
  v_and_b32 v28, 3, v1
  v_lshl_add_u32 v31, v28, 3, v31
  v_lshrrev_b32 v30, 1, v30
  v_xor_b32 v28, 0, v30
  v_lshl_add_u32 v4, v28, 5, v31
  v_xor_b32 v28, 1, v30
  v_lshl_add_u32 v5, v28, 5, v31
  v_xor_b32 v28, 2, v30
  v_lshl_add_u32 v6, v28, 5, v31
  v_xor_b32 v28, 3, v30
  v_lshl_add_u32 v7, v28, 5, v31
  v_and_b32 v30, 15, v1
  v_lshrrev_b32 v31, 4, v1
  v_and_b32 v28, 6, v30
  v_xor_b32 v28, v28, v31
  v_lshlrev_b32 v16, 7, v30
  v_lshl_add_u32 v16, v28, 4, v16
  v_add_u32 v16, s83, v16
  v_xor_b32 v17, 64, v16
  s_lshl_b32 s93, s60, 1
  s_add_u32 s93, s93, s63
  s_lshl_b32 s93, s93, 8
  s_lshl_b32 s6, s3, 2
  s_add_u32 s93, s93, s6
  s_add_u32 s93, s93, 0
  v_lshlrev_b32 v18, 2, v1
  s_waitcnt vmcnt(8)
  s_barrier
  ds_read_b128 v[64:67], v16 offset:0
  ds_read_b64_tr_b16 a[0:1], v4 offset:0
  ds_read_b64_tr_b16 a[2:3], v4 offset:1024
  ds_read_b64_tr_b16 a[4:5], v5 offset:0
  ds_read_b64_tr_b16 a[6:7], v5 offset:1024
  ds_read_b64_tr_b16 a[8:9], v6 offset:0
  ds_read_b64_tr_b16 a[10:11], v6 offset:1024
  ds_read_b64_tr_b16 a[12:13], v7 offset:0
  ds_read_b64_tr_b16 a[14:15], v7 offset:1024
  ds_read_b128 v[68:71], v17 offset:0
  ds_read_b64_tr_b16 a[16:17], v4 offset:4096
  ds_read_b64_tr_b16 a[18:19], v4 offset:5120
  ds_read_b64_tr_b16 a[20:21], v5 offset:4096
  ds_read_b64_tr_b16 a[22:23], v5 offset:5120
  ds_read_b64_tr_b16 a[24:25], v6 offset:4096
  ds_read_b64_tr_b16 a[26:27], v6 offset:5120
  ds_read_b64_tr_b16 a[28:29], v7 offset:4096
  ds_read_b64_tr_b16 a[30:31], v7 offset:5120
  s_waitcnt lgkmcnt(9)
  v_mfma_f32_16x16x32_bf16 v[32:35], a[0:3], v[64:67], 0
  s_add_u32 m0, s7, 24576
  s_add_u32 s46, s94, 393216
  buffer_load_dwordx4 v2, s[16:19], s46 offen lds
  v_mfma_f32_16x16x32_bf16 v[36:39], a[4:7], v[64:67], 0
  s_waitcnt lgkmcnt(0)
  s_add_u32 m0, m0, 1024
  s_add_u32 s46, s94, 401408
  buffer_load_dwordx4 v2, s[16:19], s46 offen lds
  v_mfma_f32_16x16x32_bf16 v[40:43], a[8:11], v[64:67], 0
  s_waitcnt vmcnt(6)
  s_barrier
  ds_read_b128 v[72:75], v16 offset:2048
  ds_read_b64_tr_b16 a[32:33], v4 offset:8192
  ds_read_b64_tr_b16 a[34:35], v4 offset:9216
  ds_read_b64_tr_b16 a[36:37], v5 offset:8192
  s_add_u32 m0, s83, 6144
  s_add_u32 s46, s95, 384
  buffer_load_dwordx4 v3, s[8:11], s46 offen lds
  v_mfma_f32_16x16x32_bf16 v[44:47], a[12:15], v[64:67], 0
  ds_read_b64_tr_b16 a[38:39], v5 offset:9216
  ds_read_b64_tr_b16 a[40:41], v6 offset:8192
  ds_read_b64_tr_b16 a[42:43], v6 offset:9216
  ds_read_b64_tr_b16 a[44:45], v7 offset:8192
  s_add_u32 m0, m0, 1024
  s_add_u32 s46, s95, 16768
  buffer_load_dwordx4 v3, s[8:11], s46 offen lds
  v_mfma_f32_16x16x32_bf16 v[32:35], a[16:19], v[68:71], v[32:35]
  ds_read_b64_tr_b16 a[46:47], v7 offset:9216
  ds_read_b128 v[76:79], v17 offset:2048
  ds_read_b64_tr_b16 a[48:49], v4 offset:12288
  ds_read_b64_tr_b16 a[50:51], v4 offset:13312
  v_mfma_f32_16x16x32_bf16 v[36:39], a[20:23], v[68:71], v[36:39]
  ds_read_b64_tr_b16 a[52:53], v5 offset:12288
  ds_read_b64_tr_b16 a[54:55], v5 offset:13312
  ds_read_b64_tr_b16 a[56:57], v6 offset:12288
  ds_read_b64_tr_b16 a[58:59], v6 offset:13312
  v_mfma_f32_16x16x32_bf16 v[40:43], a[24:27], v[68:71], v[40:43]
  ds_read_b64_tr_b16 a[60:61], v7 offset:12288
  ds_read_b64_tr_b16 a[62:63], v7 offset:13312
  v_mfma_f32_16x16x32_bf16 v[44:47], a[28:31], v[68:71], v[44:47]
  s_waitcnt lgkmcnt(9)
  v_mfma_f32_16x16x32_bf16 v[32:35], a[32:35], v[72:75], v[32:35]
  s_add_u32 m0, s7, 32768
  s_add_u32 s46, s94, 524288
  buffer_load_dwordx4 v2, s[16:19], s46 offen lds
  v_mfma_f32_16x16x32_bf16 v[36:39], a[36:39], v[72:75], v[36:39]
  s_waitcnt lgkmcnt(0)
  s_add_u32 m0, m0, 1024
  s_add_u32 s46, s94, 532480
  buffer_load_dwordx4 v2, s[16:19], s46 offen lds
  v_mfma_f32_16x16x32_bf16 v[40:43], a[40:43], v[72:75], v[40:43]
  s_waitcnt vmcnt(6)
  s_barrier
  ds_read_b128 v[64:67], v16 offset:4096
  ds_read_b64_tr_b16 a[64:65], v4 offset:16384
  ds_read_b64_tr_b16 a[66:67], v4 offset:17408
  ds_read_b64_tr_b16 a[68:69], v5 offset:16384
  s_add_u32 m0, s83, 8192
  s_add_u32 s46, s95, 512
  buffer_load_dwordx4 v3, s[8:11], s46 offen lds
  v_mfma_f32_16x16x32_bf16 v[44:47], a[44:47], v[72:75], v[44:47]
  ds_read_b64_tr_b16 a[70:71], v5 offset:17408
  ds_read_b64_tr_b16 a[72:73], v6 offset:16384
  ds_read_b64_tr_b16 a[74:75], v6 offset:17408
  ds_read_b64_tr_b16 a[76:77], v7 offset:16384
  s_add_u32 m0, m0, 1024
  s_add_u32 s46, s95, 16896
  buffer_load_dwordx4 v3, s[8:11], s46 offen lds
  v_mfma_f32_16x16x32_bf16 v[32:35], a[48:51], v[76:79], v[32:35]
  ds_read_b64_tr_b16 a[78:79], v7 offset:17408
  ds_read_b128 v[68:71], v17 offset:4096
  ds_read_b64_tr_b16 a[80:81], v4 offset:20480
  ds_read_b64_tr_b16 a[82:83], v4 offset:21504
  v_mfma_f32_16x16x32_bf16 v[36:39], a[52:55], v[76:79], v[36:39]
  ds_read_b64_tr_b16 a[84:85], v5 offset:20480
  ds_read_b64_tr_b16 a[86:87], v5 offset:21504
  ds_read_b64_tr_b16 a[88:89], v6 offset:20480
  ds_read_b64_tr_b16 a[90:91], v6 offset:21504
  v_mfma_f32_16x16x32_bf16 v[40:43], a[56:59], v[76:79], v[40:43]
  ds_read_b64_tr_b16 a[92:93], v7 offset:20480
  ds_read_b64_tr_b16 a[94:95], v7 offset:21504
  v_mfma_f32_16x16x32_bf16 v[44:47], a[60:63], v[76:79], v[44:47]
  s_waitcnt lgkmcnt(9)
  v_mfma_f32_16x16x32_bf16 v[32:35], a[64:67], v[64:67], v[32:35]
  s_add_u32 m0, s7, 40960
  s_add_u32 s46, s94, 655360
  buffer_load_dwordx4 v2, s[16:19], s46 offen lds
  v_mfma_f32_16x16x32_bf16 v[36:39], a[68:71], v[64:67], v[36:39]
  s_waitcnt lgkmcnt(0)
  s_add_u32 m0, m0, 1024
  s_add_u32 s46, s94, 663552
  buffer_load_dwordx4 v2, s[16:19], s46 offen lds
  v_mfma_f32_16x16x32_bf16 v[40:43], a[72:75], v[64:67], v[40:43]
  s_waitcnt vmcnt(6)
  s_barrier
  ds_read_b128 v[72:75], v16 offset:6144
  ds_read_b64_tr_b16 a[96:97], v4 offset:24576
  ds_read_b64_tr_b16 a[98:99], v4 offset:25600
  ds_read_b64_tr_b16 a[100:101], v5 offset:24576
  s_add_u32 m0, s83, 10240
  s_add_u32 s46, s95, 640
  buffer_load_dwordx4 v3, s[8:11], s46 offen lds
  v_mfma_f32_16x16x32_bf16 v[44:47], a[76:79], v[64:67], v[44:47]
  ds_read_b64_tr_b16 a[102:103], v5 offset:25600
  ds_read_b64_tr_b16 a[104:105], v6 offset:24576
  ds_read_b64_tr_b16 a[106:107], v6 offset:25600
  ds_read_b64_tr_b16 a[108:109], v7 offset:24576
  s_add_u32 m0, m0, 1024
  s_add_u32 s46, s95, 17024
  buffer_load_dwordx4 v3, s[8:11], s46 offen lds
  v_mfma_f32_16x16x32_bf16 v[32:35], a[80:83], v[68:71], v[32:35]
  ds_read_b64_tr_b16 a[110:111], v7 offset:25600
  ds_read_b128 v[76:79], v17 offset:6144
  ds_read_b64_tr_b16 a[112:113], v4 offset:28672
  ds_read_b64_tr_b16 a[114:115], v4 offset:29696
  v_mfma_f32_16x16x32_bf16 v[36:39], a[84:87], v[68:71], v[36:39]
  ds_read_b64_tr_b16 a[116:117], v5 offset:28672
  ds_read_b64_tr_b16 a[118:119], v5 offset:29696
  ds_read_b64_tr_b16 a[120:121], v6 offset:28672
  ds_read_b64_tr_b16 a[122:123], v6 offset:29696
  v_mfma_f32_16x16x32_bf16 v[40:43], a[88:91], v[68:71], v[40:43]
  ds_read_b64_tr_b16 a[124:125], v7 offset:28672
  ds_read_b64_tr_b16 a[126:127], v7 offset:29696
  v_mfma_f32_16x16x32_bf16 v[44:47], a[92:95], v[68:71], v[44:47]
  s_waitcnt lgkmcnt(9)
  v_mfma_f32_16x16x32_bf16 v[32:35], a[96:99], v[72:75], v[32:35]
  s_add_u32 m0, s7, 49152
  s_add_u32 s46, s94, 786432
  buffer_load_dwordx4 v2, s[16:19], s46 offen lds
  v_mfma_f32_16x16x32_bf16 v[36:39], a[100:103], v[72:75], v[36:39]
  s_waitcnt lgkmcnt(0)
  s_add_u32 m0, m0, 1024
  s_add_u32 s46, s94, 794624
  buffer_load_dwordx4 v2, s[16:19], s46 offen lds
  v_mfma_f32_16x16x32_bf16 v[40:43], a[104:107], v[72:75], v[40:43]
  s_waitcnt vmcnt(6)
  s_barrier
  ds_read_b128 v[64:67], v16 offset:8192
  ds_read_b64_tr_b16 a[128:129], v4 offset:32768
  ds_read_b64_tr_b16 a[130:131], v4 offset:33792
  ds_read_b64_tr_b16 a[132:133], v5 offset:32768
  s_add_u32 m0, s83, 12288
  s_add_u32 s46, s95, 768
  buffer_load_dwordx4 v3, s[8:11], s46 offen lds
  v_mfma_f32_16x16x32_bf16 v[44:47], a[108:111], v[72:75], v[44:47]
  ds_read_b64_tr_b16 a[134:135], v5 offset:33792
  ds_read_b64_tr_b16 a[136:137], v6 offset:32768
  ds_read_b64_tr_b16 a[138:139], v6 offset:33792
  ds_read_b64_tr_b16 a[140:141], v7 offset:32768
  s_add_u32 m0, m0, 1024
  s_add_u32 s46, s95, 17152
  buffer_load_dwordx4 v3, s[8:11], s46 offen lds
  v_mfma_f32_16x16x32_bf16 v[32:35], a[112:115], v[76:79], v[32:35]
  ds_read_b64_tr_b16 a[142:143], v7 offset:33792
  ds_read_b128 v[68:71], v17 offset:8192
  ds_read_b64_tr_b16 a[144:145], v4 offset:36864
  ds_read_b64_tr_b16 a[146:147], v4 offset:37888
  v_mfma_f32_16x16x32_bf16 v[36:39], a[116:119], v[76:79], v[36:39]
  ds_read_b64_tr_b16 a[148:149], v5 offset:36864
  ds_read_b64_tr_b16 a[150:151], v5 offset:37888
  ds_read_b64_tr_b16 a[152:153], v6 offset:36864
  ds_read_b64_tr_b16 a[154:155], v6 offset:37888
  v_mfma_f32_16x16x32_bf16 v[40:43], a[120:123], v[76:79], v[40:43]
  ds_read_b64_tr_b16 a[156:157], v7 offset:36864
  ds_read_b64_tr_b16 a[158:159], v7 offset:37888
  v_mfma_f32_16x16x32_bf16 v[44:47], a[124:127], v[76:79], v[44:47]
  s_waitcnt lgkmcnt(9)
  v_mfma_f32_16x16x32_bf16 v[32:35], a[128:131], v[64:67], v[32:35]
  s_add_u32 m0, s7, 57344
  s_add_u32 s46, s94, 917504
  buffer_load_dwordx4 v2, s[16:19], s46 offen lds
  v_mfma_f32_16x16x32_bf16 v[36:39], a[132:135], v[64:67], v[36:39]
  s_waitcnt lgkmcnt(0)
  s_add_u32 m0, m0, 1024
  s_add_u32 s46, s94, 925696
  buffer_load_dwordx4 v2, s[16:19], s46 offen lds
  v_mfma_f32_16x16x32_bf16 v[40:43], a[136:139], v[64:67], v[40:43]
  s_waitcnt vmcnt(6)
  s_barrier
  ds_read_b128 v[72:75], v16 offset:10240
  ds_read_b64_tr_b16 a[160:161], v4 offset:40960
  ds_read_b64_tr_b16 a[162:163], v4 offset:41984
  ds_read_b64_tr_b16 a[164:165], v5 offset:40960
  s_add_u32 m0, s83, 14336
  s_add_u32 s46, s95, 896
  buffer_load_dwordx4 v3, s[8:11], s46 offen lds
  v_mfma_f32_16x16x32_bf16 v[44:47], a[140:143], v[64:67], v[44:47]
  ds_read_b64_tr_b16 a[166:167], v5 offset:41984
  ds_read_b64_tr_b16 a[168:169], v6 offset:40960
  ds_read_b64_tr_b16 a[170:171], v6 offset:41984
  ds_read_b64_tr_b16 a[172:173], v7 offset:40960
  s_add_u32 m0, m0, 1024
  s_add_u32 s46, s95, 17280
  buffer_load_dwordx4 v3, s[8:11], s46 offen lds
  v_mfma_f32_16x16x32_bf16 v[32:35], a[144:147], v[68:71], v[32:35]
  ds_read_b64_tr_b16 a[174:175], v7 offset:41984
  ds_read_b128 v[76:79], v17 offset:10240
  ds_read_b64_tr_b16 a[176:177], v4 offset:45056
  ds_read_b64_tr_b16 a[178:179], v4 offset:46080
  v_mfma_f32_16x16x32_bf16 v[36:39], a[148:151], v[68:71], v[36:39]
  ds_read_b64_tr_b16 a[180:181], v5 offset:45056
  ds_read_b64_tr_b16 a[182:183], v5 offset:46080
  ds_read_b64_tr_b16 a[184:185], v6 offset:45056
  ds_read_b64_tr_b16 a[186:187], v6 offset:46080
  v_mfma_f32_16x16x32_bf16 v[40:43], a[152:155], v[68:71], v[40:43]
  ds_read_b64_tr_b16 a[188:189], v7 offset:45056
  ds_read_b64_tr_b16 a[190:191], v7 offset:46080
  v_mfma_f32_16x16x32_bf16 v[44:47], a[156:159], v[68:71], v[44:47]
  s_waitcnt lgkmcnt(9)
  v_mfma_f32_16x16x32_bf16 v[32:35], a[160:163], v[72:75], v[32:35]
  s_add_u32 m0, s7, 0
  s_add_u32 s46, s94, 1048576
  buffer_load_dwordx4 v2, s[16:19], s46 offen lds
  v_mfma_f32_16x16x32_bf16 v[36:39], a[164:167], v[72:75], v[36:39]
  s_waitcnt lgkmcnt(0)
  s_add_u32 m0, m0, 1024
  s_add_u32 s46, s94, 1056768
  buffer_load_dwordx4 v2, s[16:19], s46 offen lds
  v_mfma_f32_16x16x32_bf16 v[40:43], a[168:171], v[72:75], v[40:43]
  s_waitcnt vmcnt(6)
  s_barrier
  ds_read_b128 v[64:67], v16 offset:12288
  ds_read_b64_tr_b16 a[192:193], v4 offset:49152
  ds_read_b64_tr_b16 a[194:195], v4 offset:50176
  ds_read_b64_tr_b16 a[196:197], v5 offset:49152
  s_add_u32 m0, s83, 16384
  s_add_u32 s46, s95, 1024
  buffer_load_dwordx4 v3, s[8:11], s46 offen lds
  v_mfma_f32_16x16x32_bf16 v[44:47], a[172:175], v[72:75], v[44:47]
  ds_read_b64_tr_b16 a[198:199], v5 offset:50176
  ds_read_b64_tr_b16 a[200:201], v6 offset:49152
  ds_read_b64_tr_b16 a[202:203], v6 offset:50176
  ds_read_b64_tr_b16 a[204:205], v7 offset:49152
  s_add_u32 m0, m0, 1024
  s_add_u32 s46, s95, 17408
  buffer_load_dwordx4 v3, s[8:11], s46 offen lds
  v_mfma_f32_16x16x32_bf16 v[32:35], a[176:179], v[76:79], v[32:35]
  ds_read_b64_tr_b16 a[206:207], v7 offset:50176
  ds_read_b128 v[68:71], v17 offset:12288
  ds_read_b64_tr_b16 a[208:209], v4 offset:53248
  ds_read_b64_tr_b16 a[210:211], v4 offset:54272
  v_mfma_f32_16x16x32_bf16 v[36:39], a[180:183], v[76:79], v[36:39]
  ds_read_b64_tr_b16 a[212:213], v5 offset:53248
  ds_read_b64_tr_b16 a[214:215], v5 offset:54272
  ds_read_b64_tr_b16 a[216:217], v6 offset:53248
  ds_read_b64_tr_b16 a[218:219], v6 offset:54272
  v_mfma_f32_16x16x32_bf16 v[40:43], a[184:187], v[76:79], v[40:43]
  ds_read_b64_tr_b16 a[220:221], v7 offset:53248
  ds_read_b64_tr_b16 a[222:223], v7 offset:54272
  v_mfma_f32_16x16x32_bf16 v[44:47], a[188:191], v[76:79], v[44:47]
  s_waitcnt lgkmcnt(9)
  v_mfma_f32_16x16x32_bf16 v[32:35], a[192:195], v[64:67], v[32:35]
  s_add_u32 m0, s7, 8192
  s_add_u32 s46, s94, 1179648
  buffer_load_dwordx4 v2, s[16:19], s46 offen lds
  v_mfma_f32_16x16x32_bf16 v[36:39], a[196:199], v[64:67], v[36:39]
  s_waitcnt lgkmcnt(0)
  s_add_u32 m0, m0, 1024
  s_add_u32 s46, s94, 1187840
  buffer_load_dwordx4 v2, s[16:19], s46 offen lds
  v_mfma_f32_16x16x32_bf16 v[40:43], a[200:203], v[64:67], v[40:43]
  s_waitcnt vmcnt(6)
  s_barrier
  ds_read_b128 v[72:75], v16 offset:14336
  ds_read_b64_tr_b16 a[224:225], v4 offset:57344
  ds_read_b64_tr_b16 a[226:227], v4 offset:58368
  ds_read_b64_tr_b16 a[228:229], v5 offset:57344
  s_add_u32 m0, s83, 18432
  s_add_u32 s46, s95, 1152
  buffer_load_dwordx4 v3, s[8:11], s46 offen lds
  v_mfma_f32_16x16x32_bf16 v[44:47], a[204:207], v[64:67], v[44:47]
  ds_read_b64_tr_b16 a[230:231], v5 offset:58368
  ds_read_b64_tr_b16 a[232:233], v6 offset:57344
  ds_read_b64_tr_b16 a[234:235], v6 offset:58368
  ds_read_b64_tr_b16 a[236:237], v7 offset:57344
  s_add_u32 m0, m0, 1024
  s_add_u32 s46, s95, 17536
  buffer_load_dwordx4 v3, s[8:11], s46 offen lds
  v_mfma_f32_16x16x32_bf16 v[32:35], a[208:211], v[68:71], v[32:35]
  ds_read_b64_tr_b16 a[238:239], v7 offset:58368
  ds_read_b128 v[76:79], v17 offset:14336
  ds_read_b64_tr_b16 a[240:241], v4 offset:61440
  ds_read_b64_tr_b16 a[242:243], v4 offset:62464
  v_mfma_f32_16x16x32_bf16 v[36:39], a[212:215], v[68:71], v[36:39]
  ds_read_b64_tr_b16 a[244:245], v5 offset:61440
  ds_read_b64_tr_b16 a[246:247], v5 offset:62464
  ds_read_b64_tr_b16 a[248:249], v6 offset:61440
  ds_read_b64_tr_b16 a[250:251], v6 offset:62464
  v_mfma_f32_16x16x32_bf16 v[40:43], a[216:219], v[68:71], v[40:43]
  ds_read_b64_tr_b16 a[252:253], v7 offset:61440
  ds_read_b64_tr_b16 a[254:255], v7 offset:62464
  v_mfma_f32_16x16x32_bf16 v[44:47], a[220:223], v[68:71], v[44:47]
  s_waitcnt lgkmcnt(9)
  v_mfma_f32_16x16x32_bf16 v[32:35], a[224:227], v[72:75], v[32:35]
  s_add_u32 m0, s7, 16384
  s_add_u32 s46, s94, 1310720
  buffer_load_dwordx4 v2, s[16:19], s46 offen lds
  v_mfma_f32_16x16x32_bf16 v[36:39], a[228:231], v[72:75], v[36:39]
  s_waitcnt lgkmcnt(0)
  s_add_u32 m0, m0, 1024
  s_add_u32 s46, s94, 1318912
  buffer_load_dwordx4 v2, s[16:19], s46 offen lds
  v_mfma_f32_16x16x32_bf16 v[40:43], a[232:235], v[72:75], v[40:43]
  s_waitcnt vmcnt(6)
  s_barrier
  ds_read_b128 v[64:67], v16 offset:16384
  ds_read_b64_tr_b16 v[160:161], v4 offset:0
  ds_read_b64_tr_b16 v[162:163], v4 offset:1024
  ds_read_b64_tr_b16 v[164:165], v5 offset:0
  s_add_u32 m0, s83, 20480
  s_add_u32 s46, s95, 1280
  buffer_load_dwordx4 v3, s[8:11], s46 offen lds
  v_mfma_f32_16x16x32_bf16 v[44:47], a[236:239], v[72:75], v[44:47]
  ds_read_b64_tr_b16 v[166:167], v5 offset:1024
  ds_read_b64_tr_b16 v[168:169], v6 offset:0
  ds_read_b64_tr_b16 v[170:171], v6 offset:1024
  ds_read_b64_tr_b16 v[172:173], v7 offset:0
  s_add_u32 m0, m0, 1024
  s_add_u32 s46, s95, 17664
  buffer_load_dwordx4 v3, s[8:11], s46 offen lds
  v_mfma_f32_16x16x32_bf16 v[32:35], a[240:243], v[76:79], v[32:35]
  ds_read_b64_tr_b16 v[174:175], v7 offset:1024
  ds_read_b128 v[68:71], v17 offset:16384
  ds_read_b64_tr_b16 v[176:177], v4 offset:4096
  ds_read_b64_tr_b16 v[178:179], v4 offset:5120
  v_mfma_f32_16x16x32_bf16 v[36:39], a[244:247], v[76:79], v[36:39]
  ds_read_b64_tr_b16 v[180:181], v5 offset:4096
  ds_read_b64_tr_b16 v[182:183], v5 offset:5120
  ds_read_b64_tr_b16 v[184:185], v6 offset:4096
  ds_read_b64_tr_b16 v[186:187], v6 offset:5120
  v_mfma_f32_16x16x32_bf16 v[40:43], a[248:251], v[76:79], v[40:43]
  ds_read_b64_tr_b16 v[188:189], v7 offset:4096
  ds_read_b64_tr_b16 v[190:191], v7 offset:5120
  v_mfma_f32_16x16x32_bf16 v[44:47], a[252:255], v[76:79], v[44:47]
  s_waitcnt lgkmcnt(9)
  v_mfma_f32_16x16x32_bf16 v[32:35], v[160:163], v[64:67], v[32:35]
  s_add_u32 m0, s7, 24576
  s_add_u32 s46, s94, 1441792
  buffer_load_dwordx4 v2, s[16:19], s46 offen lds
  v_mfma_f32_16x16x32_bf16 v[36:39], v[164:167], v[64:67], v[36:39]
  s_waitcnt lgkmcnt(0)
  s_add_u32 m0, m0, 1024
  s_add_u32 s46, s94, 1449984
  buffer_load_dwordx4 v2, s[16:19], s46 offen lds
  v_mfma_f32_16x16x32_bf16 v[40:43], v[168:171], v[64:67], v[40:43]
  s_waitcnt vmcnt(6)
  s_barrier
  ds_read_b128 v[72:75], v16 offset:18432
  ds_read_b64_tr_b16 v[192:193], v4 offset:8192
  ds_read_b64_tr_b16 v[194:195], v4 offset:9216
  ds_read_b64_tr_b16 v[196:197], v5 offset:8192
  s_add_u32 m0, s83, 22528
  s_add_u32 s46, s95, 1408
  buffer_load_dwordx4 v3, s[8:11], s46 offen lds
  v_mfma_f32_16x16x32_bf16 v[44:47], v[172:175], v[64:67], v[44:47]
  ds_read_b64_tr_b16 v[198:199], v5 offset:9216
  ds_read_b64_tr_b16 v[200:201], v6 offset:8192
  ds_read_b64_tr_b16 v[202:203], v6 offset:9216
  ds_read_b64_tr_b16 v[204:205], v7 offset:8192
  s_add_u32 m0, m0, 1024
  s_add_u32 s46, s95, 17792
  buffer_load_dwordx4 v3, s[8:11], s46 offen lds
  v_mfma_f32_16x16x32_bf16 v[32:35], v[176:179], v[68:71], v[32:35]
  ds_read_b64_tr_b16 v[206:207], v7 offset:9216
  ds_read_b128 v[76:79], v17 offset:18432
  ds_read_b64_tr_b16 v[208:209], v4 offset:12288
  ds_read_b64_tr_b16 v[210:211], v4 offset:13312
  v_mfma_f32_16x16x32_bf16 v[36:39], v[180:183], v[68:71], v[36:39]
  ds_read_b64_tr_b16 v[212:213], v5 offset:12288
  ds_read_b64_tr_b16 v[214:215], v5 offset:13312
  ds_read_b64_tr_b16 v[216:217], v6 offset:12288
  ds_read_b64_tr_b16 v[218:219], v6 offset:13312
  v_mfma_f32_16x16x32_bf16 v[40:43], v[184:187], v[68:71], v[40:43]
  ds_read_b64_tr_b16 v[220:221], v7 offset:12288
  ds_read_b64_tr_b16 v[222:223], v7 offset:13312
  v_mfma_f32_16x16x32_bf16 v[44:47], v[188:191], v[68:71], v[44:47]
  s_waitcnt lgkmcnt(9)
  v_mfma_f32_16x16x32_bf16 v[32:35], v[192:195], v[72:75], v[32:35]
  s_add_u32 m0, s7, 32768
  s_add_u32 s46, s94, 1572864
  buffer_load_dwordx4 v2, s[16:19], s46 offen lds
  v_mfma_f32_16x16x32_bf16 v[36:39], v[196:199], v[72:75], v[36:39]
  s_waitcnt lgkmcnt(0)
  s_add_u32 m0, m0, 1024
  s_add_u32 s46, s94, 1581056
  buffer_load_dwordx4 v2, s[16:19], s46 offen lds
  v_mfma_f32_16x16x32_bf16 v[40:43], v[200:203], v[72:75], v[40:43]
  s_waitcnt vmcnt(6)
  s_barrier
  ds_read_b128 v[64:67], v16 offset:20480
  ds_read_b64_tr_b16 v[224:225], v4 offset:16384
  ds_read_b64_tr_b16 v[226:227], v4 offset:17408
  ds_read_b64_tr_b16 v[228:229], v5 offset:16384
  s_add_u32 m0, s83, 0
  s_add_u32 s46, s95, 1536
  buffer_load_dwordx4 v3, s[8:11], s46 offen lds
  v_mfma_f32_16x16x32_bf16 v[44:47], v[204:207], v[72:75], v[44:47]
  ds_read_b64_tr_b16 v[230:231], v5 offset:17408
  ds_read_b64_tr_b16 v[232:233], v6 offset:16384
  ds_read_b64_tr_b16 v[234:235], v6 offset:17408
  ds_read_b64_tr_b16 v[236:237], v7 offset:16384
  s_add_u32 m0, m0, 1024
  s_add_u32 s46, s95, 17920
  buffer_load_dwordx4 v3, s[8:11], s46 offen lds
  v_mfma_f32_16x16x32_bf16 v[32:35], v[208:211], v[76:79], v[32:35]
  ds_read_b64_tr_b16 v[238:239], v7 offset:17408
  ds_read_b128 v[68:71], v17 offset:20480
  ds_read_b64_tr_b16 v[240:241], v4 offset:20480
  ds_read_b64_tr_b16 v[242:243], v4 offset:21504
  v_mfma_f32_16x16x32_bf16 v[36:39], v[212:215], v[76:79], v[36:39]
  ds_read_b64_tr_b16 v[244:245], v5 offset:20480
  ds_read_b64_tr_b16 v[246:247], v5 offset:21504
  ds_read_b64_tr_b16 v[248:249], v6 offset:20480
  ds_read_b64_tr_b16 v[250:251], v6 offset:21504
  v_mfma_f32_16x16x32_bf16 v[40:43], v[216:219], v[76:79], v[40:43]
  ds_read_b64_tr_b16 v[252:253], v7 offset:20480
  ds_read_b64_tr_b16 v[254:255], v7 offset:21504
  v_mfma_f32_16x16x32_bf16 v[44:47], v[220:223], v[76:79], v[44:47]
  s_waitcnt lgkmcnt(9)
  v_mfma_f32_16x16x32_bf16 v[32:35], v[224:227], v[64:67], v[32:35]
  s_add_u32 m0, s7, 40960
  s_add_u32 s46, s94, 1703936
  buffer_load_dwordx4 v2, s[16:19], s46 offen lds
  v_mfma_f32_16x16x32_bf16 v[36:39], v[228:231], v[64:67], v[36:39]
  s_waitcnt lgkmcnt(0)
  s_add_u32 m0, m0, 1024
  s_add_u32 s46, s94, 1712128
  buffer_load_dwordx4 v2, s[16:19], s46 offen lds
  v_mfma_f32_16x16x32_bf16 v[40:43], v[232:235], v[64:67], v[40:43]
  s_waitcnt vmcnt(6)
  s_barrier
  ds_read_b128 v[72:75], v16 offset:22528
  ds_read_b64_tr_b16 v[96:97], v4 offset:24576
  ds_read_b64_tr_b16 v[98:99], v4 offset:25600
  ds_read_b64_tr_b16 v[100:101], v5 offset:24576
  s_add_u32 m0, s83, 2048
  s_add_u32 s46, s95, 1664
  buffer_load_dwordx4 v3, s[8:11], s46 offen lds
  v_mfma_f32_16x16x32_bf16 v[44:47], v[236:239], v[64:67], v[44:47]
  ds_read_b64_tr_b16 v[102:103], v5 offset:25600
  ds_read_b64_tr_b16 v[104:105], v6 offset:24576
  ds_read_b64_tr_b16 v[106:107], v6 offset:25600
  ds_read_b64_tr_b16 v[108:109], v7 offset:24576
  s_add_u32 m0, m0, 1024
  s_add_u32 s46, s95, 18048
  buffer_load_dwordx4 v3, s[8:11], s46 offen lds
  v_mfma_f32_16x16x32_bf16 v[32:35], v[240:243], v[68:71], v[32:35]
  ds_read_b64_tr_b16 v[110:111], v7 offset:25600
  ds_read_b128 v[76:79], v17 offset:22528
  ds_read_b64_tr_b16 v[112:113], v4 offset:28672
  ds_read_b64_tr_b16 v[114:115], v4 offset:29696
  v_mfma_f32_16x16x32_bf16 v[36:39], v[244:247], v[68:71], v[36:39]
  ds_read_b64_tr_b16 v[116:117], v5 offset:28672
  ds_read_b64_tr_b16 v[118:119], v5 offset:29696
  ds_read_b64_tr_b16 v[120:121], v6 offset:28672
  ds_read_b64_tr_b16 v[122:123], v6 offset:29696
  v_mfma_f32_16x16x32_bf16 v[40:43], v[248:251], v[68:71], v[40:43]
  ds_read_b64_tr_b16 v[124:125], v7 offset:28672
  ds_read_b64_tr_b16 v[126:127], v7 offset:29696
  v_mfma_f32_16x16x32_bf16 v[44:47], v[252:255], v[68:71], v[44:47]
  s_waitcnt lgkmcnt(9)
  v_mfma_f32_16x16x32_bf16 v[32:35], v[96:99], v[72:75], v[32:35]
  s_add_u32 m0, s7, 49152
  s_add_u32 s46, s94, 1835008
  buffer_load_dwordx4 v2, s[16:19], s46 offen lds
  v_mfma_f32_16x16x32_bf16 v[36:39], v[100:103], v[72:75], v[36:39]
  s_waitcnt lgkmcnt(0)
  s_add_u32 m0, m0, 1024
  s_add_u32 s46, s94, 1843200
  buffer_load_dwordx4 v2, s[16:19], s46 offen lds
  v_mfma_f32_16x16x32_bf16 v[40:43], v[104:107], v[72:75], v[40:43]
  s_waitcnt vmcnt(6)
  s_barrier
  ds_read_b128 v[64:67], v16 offset:0
  ds_read_b64_tr_b16 v[128:129], v4 offset:32768
  ds_read_b64_tr_b16 v[130:131], v4 offset:33792
  ds_read_b64_tr_b16 v[132:133], v5 offset:32768
  s_add_u32 m0, s83, 4096
  s_add_u32 s46, s95, 1792
  buffer_load_dwordx4 v3, s[8:11], s46 offen lds
  v_mfma_f32_16x16x32_bf16 v[44:47], v[108:111], v[72:75], v[44:47]
  ds_read_b64_tr_b16 v[134:135], v5 offset:33792
  ds_read_b64_tr_b16 v[136:137], v6 offset:32768
  ds_read_b64_tr_b16 v[138:139], v6 offset:33792
  ds_read_b64_tr_b16 v[140:141], v7 offset:32768
  s_add_u32 m0, m0, 1024
  s_add_u32 s46, s95, 18176
  buffer_load_dwordx4 v3, s[8:11], s46 offen lds
  v_mfma_f32_16x16x32_bf16 v[32:35], v[112:115], v[76:79], v[32:35]
  ds_read_b64_tr_b16 v[142:143], v7 offset:33792
  ds_read_b128 v[68:71], v17 offset:0
  ds_read_b64_tr_b16 v[144:145], v4 offset:36864
  ds_read_b64_tr_b16 v[146:147], v4 offset:37888
  v_mfma_f32_16x16x32_bf16 v[36:39], v[116:119], v[76:79], v[36:39]
  ds_read_b64_tr_b16 v[148:149], v5 offset:36864
  ds_read_b64_tr_b16 v[150:151], v5 offset:37888
  ds_read_b64_tr_b16 v[152:153], v6 offset:36864
  ds_read_b64_tr_b16 v[154:155], v6 offset:37888
  v_mfma_f32_16x16x32_bf16 v[40:43], v[120:123], v[76:79], v[40:43]
  ds_read_b64_tr_b16 v[156:157], v7 offset:36864
  ds_read_b64_tr_b16 v[158:159], v7 offset:37888
  v_mfma_f32_16x16x32_bf16 v[44:47], v[124:127], v[76:79], v[44:47]
  s_waitcnt lgkmcnt(9)
  v_mfma_f32_16x16x32_bf16 v[32:35], v[128:131], v[64:67], v[32:35]
  s_add_u32 m0, s7, 57344
  s_add_u32 s46, s94, 1966080
  buffer_load_dwordx4 v2, s[16:19], s46 offen lds
  v_mfma_f32_16x16x32_bf16 v[36:39], v[132:135], v[64:67], v[36:39]
  s_waitcnt lgkmcnt(0)
  s_add_u32 m0, m0, 1024
  s_add_u32 s46, s94, 1974272
  buffer_load_dwordx4 v2, s[16:19], s46 offen lds
  v_mfma_f32_16x16x32_bf16 v[40:43], v[136:139], v[64:67], v[40:43]
  s_waitcnt vmcnt(6)
  s_barrier
  ds_read_b128 v[72:75], v16 offset:2048
  ds_read_b64_tr_b16 v[160:161], v4 offset:40960
  ds_read_b64_tr_b16 v[162:163], v4 offset:41984
  ds_read_b64_tr_b16 v[164:165], v5 offset:40960
  s_add_u32 m0, s83, 6144
  s_add_u32 s46, s95, 1920
  buffer_load_dwordx4 v3, s[8:11], s46 offen lds
  v_mfma_f32_16x16x32_bf16 v[44:47], v[140:143], v[64:67], v[44:47]
  ds_read_b64_tr_b16 v[166:167], v5 offset:41984
  ds_read_b64_tr_b16 v[168:169], v6 offset:40960
  ds_read_b64_tr_b16 v[170:171], v6 offset:41984
  ds_read_b64_tr_b16 v[172:173], v7 offset:40960
  s_add_u32 m0, m0, 1024
  s_add_u32 s46, s95, 18304
  buffer_load_dwordx4 v3, s[8:11], s46 offen lds
  v_mfma_f32_16x16x32_bf16 v[32:35], v[144:147], v[68:71], v[32:35]
  ds_read_b64_tr_b16 v[174:175], v7 offset:41984
  ds_read_b128 v[76:79], v17 offset:2048
  ds_read_b64_tr_b16 v[176:177], v4 offset:45056
  ds_read_b64_tr_b16 v[178:179], v4 offset:46080
  v_mfma_f32_16x16x32_bf16 v[36:39], v[148:151], v[68:71], v[36:39]
  ds_read_b64_tr_b16 v[180:181], v5 offset:45056
  ds_read_b64_tr_b16 v[182:183], v5 offset:46080
  ds_read_b64_tr_b16 v[184:185], v6 offset:45056
  ds_read_b64_tr_b16 v[186:187], v6 offset:46080
  v_mfma_f32_16x16x32_bf16 v[40:43], v[152:155], v[68:71], v[40:43]
  ds_read_b64_tr_b16 v[188:189], v7 offset:45056
  ds_read_b64_tr_b16 v[190:191], v7 offset:46080
  v_mfma_f32_16x16x32_bf16 v[44:47], v[156:159], v[68:71], v[44:47]
  s_waitcnt lgkmcnt(9)
  v_lshlrev_b32 v0, 2, v1
  buffer_load_dword v14, v0, s[40:43], 0 offen sc1
  v_mfma_f32_16x16x32_bf16 v[32:35], v[160:163], v[72:75], v[32:35]
  s_add_u32 m0, s83, 8192
  s_add_u32 s46, s95, 132480
  buffer_load_dwordx4 v3, s[8:11], s46 offen lds
  v_mfma_f32_16x16x32_bf16 v[36:39], v[164:167], v[72:75], v[36:39]
  s_waitcnt lgkmcnt(0)
  s_add_u32 m0, m0, 1024
  s_add_u32 s46, s95, 148864
  buffer_load_dwordx4 v3, s[8:11], s46 offen lds
  v_mfma_f32_16x16x32_bf16 v[40:43], v[168:171], v[72:75], v[40:43]
  s_waitcnt vmcnt(7)
  s_barrier
  ds_read_b128 v[64:67], v16 offset:4096
  ds_read_b64_tr_b16 v[192:193], v4 offset:49152
  ds_read_b64_tr_b16 v[194:195], v4 offset:50176
  ds_read_b64_tr_b16 v[196:197], v5 offset:49152
  s_add_u32 m0, s83, 10240
  s_add_u32 s46, s95, 132608
  buffer_load_dwordx4 v3, s[8:11], s46 offen lds
  v_mfma_f32_16x16x32_bf16 v[44:47], v[172:175], v[72:75], v[44:47]
  ds_read_b64_tr_b16 v[198:199], v5 offset:50176
  ds_read_b64_tr_b16 v[200:201], v6 offset:49152
  ds_read_b64_tr_b16 v[202:203], v6 offset:50176
  ds_read_b64_tr_b16 v[204:205], v7 offset:49152
  s_add_u32 m0, m0, 1024
  s_add_u32 s46, s95, 148992
  buffer_load_dwordx4 v3, s[8:11], s46 offen lds
  v_mfma_f32_16x16x32_bf16 v[32:35], v[176:179], v[76:79], v[32:35]
  ds_read_b64_tr_b16 v[206:207], v7 offset:50176
  ds_read_b128 v[68:71], v17 offset:4096
  ds_read_b64_tr_b16 v[208:209], v4 offset:53248
  ds_read_b64_tr_b16 v[210:211], v4 offset:54272
  v_mfma_f32_16x16x32_bf16 v[36:39], v[180:183], v[76:79], v[36:39]
  ds_read_b64_tr_b16 v[212:213], v5 offset:53248
  ds_read_b64_tr_b16 v[214:215], v5 offset:54272
  ds_read_b64_tr_b16 v[216:217], v6 offset:53248
  ds_read_b64_tr_b16 v[218:219], v6 offset:54272
  v_mfma_f32_16x16x32_bf16 v[40:43], v[184:187], v[76:79], v[40:43]
  ds_read_b64_tr_b16 v[220:221], v7 offset:53248
  ds_read_b64_tr_b16 v[222:223], v7 offset:54272
  v_mfma_f32_16x16x32_bf16 v[44:47], v[188:191], v[76:79], v[44:47]
  s_waitcnt lgkmcnt(9)
  v_mfma_f32_16x16x32_bf16 v[32:35], v[192:195], v[64:67], v[32:35]
  s_add_u32 m0, s83, 12288
  s_add_u32 s46, s95, 132736
  buffer_load_dwordx4 v3, s[8:11], s46 offen lds
  v_mfma_f32_16x16x32_bf16 v[36:39], v[196:199], v[64:67], v[36:39]
  s_waitcnt lgkmcnt(0)
  s_add_u32 m0, m0, 1024
  s_add_u32 s46, s95, 149120
  buffer_load_dwordx4 v3, s[8:11], s46 offen lds
  v_mfma_f32_16x16x32_bf16 v[40:43], v[200:203], v[64:67], v[40:43]
  s_waitcnt vmcnt(7)
  s_barrier
  ds_read_b128 v[72:75], v16 offset:6144
  ds_read_b64_tr_b16 v[224:225], v4 offset:57344
  ds_read_b64_tr_b16 v[226:227], v4 offset:58368
  ds_read_b64_tr_b16 v[228:229], v5 offset:57344
  s_add_u32 m0, s83, 14336
  s_add_u32 s46, s95, 132864
  buffer_load_dwordx4 v3, s[8:11], s46 offen lds
  v_mfma_f32_16x16x32_bf16 v[44:47], v[204:207], v[64:67], v[44:47]
  ds_read_b64_tr_b16 v[230:231], v5 offset:58368
  ds_read_b64_tr_b16 v[232:233], v6 offset:57344
  ds_read_b64_tr_b16 v[234:235], v6 offset:58368
  ds_read_b64_tr_b16 v[236:237], v7 offset:57344
  s_add_u32 m0, m0, 1024
  s_add_u32 s46, s95, 149248
  buffer_load_dwordx4 v3, s[8:11], s46 offen lds
  v_mfma_f32_16x16x32_bf16 v[32:35], v[208:211], v[68:71], v[32:35]
  ds_read_b64_tr_b16 v[238:239], v7 offset:58368
  ds_read_b128 v[76:79], v17 offset:6144
  ds_read_b64_tr_b16 v[240:241], v4 offset:61440
  ds_read_b64_tr_b16 v[242:243], v4 offset:62464
  v_mfma_f32_16x16x32_bf16 v[36:39], v[212:215], v[68:71], v[36:39]
  ds_read_b64_tr_b16 v[244:245], v5 offset:61440
  ds_read_b64_tr_b16 v[246:247], v5 offset:62464
  ds_read_b64_tr_b16 v[248:249], v6 offset:61440
  ds_read_b64_tr_b16 v[250:251], v6 offset:62464
  v_mfma_f32_16x16x32_bf16 v[40:43], v[216:219], v[68:71], v[40:43]
  ds_read_b64_tr_b16 v[252:253], v7 offset:61440
  ds_read_b64_tr_b16 v[254:255], v7 offset:62464
  v_mfma_f32_16x16x32_bf16 v[44:47], v[220:223], v[68:71], v[44:47]
  s_waitcnt lgkmcnt(0)
  v_mfma_f32_16x16x32_bf16 v[32:35], v[224:227], v[72:75], v[32:35]
  s_waitcnt vmcnt(6)
  ds_read_b128 v[64:67], v16 offset:8192
  ds_read_b128 v[68:71], v17 offset:8192
  v_mfma_f32_16x16x32_bf16 v[32:35], v[240:243], v[76:79], v[32:35]
  s_add_u32 m0, s83, 16384
  s_add_u32 s46, s95, 132992
  buffer_load_dwordx4 v3, s[8:11], s46 offen lds
  v_mfma_f32_16x16x32_bf16 v[36:39], v[228:231], v[72:75], v[36:39]
  s_add_u32 m0, m0, 1024
  s_add_u32 s46, s95, 149376
  buffer_load_dwordx4 v3, s[8:11], s46 offen lds
  v_mfma_f32_16x16x32_bf16 v[36:39], v[244:247], v[76:79], v[36:39]
  s_add_u32 m0, s83, 18432
  s_add_u32 s46, s95, 131072
  buffer_load_dwordx4 v3, s[8:11], s46 offen lds
  v_mfma_f32_16x16x32_bf16 v[40:43], v[232:235], v[72:75], v[40:43]
  s_add_u32 m0, m0, 1024
  s_add_u32 s46, s95, 147456
  buffer_load_dwordx4 v3, s[8:11], s46 offen lds
  v_mfma_f32_16x16x32_bf16 v[40:43], v[248:251], v[76:79], v[40:43]
  v_mfma_f32_16x16x32_bf16 v[44:47], v[236:239], v[72:75], v[44:47]
  v_mfma_f32_16x16x32_bf16 v[44:47], v[252:255], v[76:79], v[44:47]
  s_waitcnt lgkmcnt(0)
  v_mfma_f32_16x16x32_bf16 v[48:51], v[96:99], v[64:67], 0
  s_waitcnt vmcnt(8)
  ds_read_b128 v[72:75], v16 offset:10240
  ds_read_b128 v[76:79], v17 offset:10240
  v_mfma_f32_16x16x32_bf16 v[52:55], v[100:103], v[64:67], 0
  v_cmp_ne_u32 s[50:51], 0, v14
  v_readfirstlane_b32 s48, v14
  s_or_b32 s50, s50, -2
  s_cmp_eq_u64 s[50:51], -1
  s_cbranch_scc0 L_aslow_3
L_aok_2:
  v_mov_b32 v13, s48
  v_mfma_f32_16x16x32_bf16 v[56:59], v[104:107], v[64:67], 0
  v_cvt_pk_bf16_f32 v80, v32, v33
  v_cvt_pk_bf16_f32 v81, v34, v35
  v_cvt_pk_bf16_f32 v82, v36, v37
  v_mfma_f32_16x16x32_bf16 v[60:63], v[108:111], v[64:67], 0
  v_cvt_pk_bf16_f32 v83, v38, v39
  buffer_store_dwordx4 v[80:83], v8, s[24:27], s92 offen offset:0 sc1
  v_cvt_pk_bf16_f32 v84, v40, v41
  v_mfma_f32_16x16x32_bf16 v[48:51], v[112:115], v[68:71], v[48:51]
  v_cvt_pk_bf16_f32 v85, v42, v43
  v_cvt_pk_bf16_f32 v86, v44, v45
  v_cvt_pk_bf16_f32 v87, v46, v47
  s_add_u32 m0, s83, 20480
  s_add_u32 s46, s95, 131200
  buffer_load_dwordx4 v3, s[8:11], s46 offen lds
  v_mfma_f32_16x16x32_bf16 v[52:55], v[116:119], v[68:71], v[52:55]
  buffer_store_dwordx4 v[84:87], v8, s[24:27], s92 offen offset:1024 sc1
  s_add_u32 m0, m0, 1024
  s_add_u32 s46, s95, 147584
  buffer_load_dwordx4 v3, s[8:11], s46 offen lds
  v_mfma_f32_16x16x32_bf16 v[56:59], v[120:123], v[68:71], v[56:59]
  v_mfma_f32_16x16x32_bf16 v[60:63], v[124:127], v[68:71], v[60:63]
  s_waitcnt lgkmcnt(0)
  v_mfma_f32_16x16x32_bf16 v[48:51], v[128:131], v[72:75], v[48:51]
  s_waitcnt vmcnt(10)
  ds_read_b128 v[64:67], v16 offset:12288
  ds_read_b128 v[68:71], v17 offset:12288
  v_mfma_f32_16x16x32_bf16 v[52:55], v[132:135], v[72:75], v[52:55]
  s_add_u32 m0, s83, 22528
  s_add_u32 s46, s95, 131328
  buffer_load_dwordx4 v3, s[8:11], s46 offen lds
  v_mfma_f32_16x16x32_bf16 v[56:59], v[136:139], v[72:75], v[56:59]
  s_add_u32 m0, m0, 1024
  s_add_u32 s46, s95, 147712
  buffer_load_dwordx4 v3, s[8:11], s46 offen lds
  v_mfma_f32_16x16x32_bf16 v[60:63], v[140:143], v[72:75], v[60:63]
  v_mfma_f32_16x16x32_bf16 v[48:51], v[144:147], v[76:79], v[48:51]
  v_mfma_f32_16x16x32_bf16 v[52:55], v[148:151], v[76:79], v[52:55]
  v_mfma_f32_16x16x32_bf16 v[56:59], v[152:155], v[76:79], v[56:59]
  v_mfma_f32_16x16x32_bf16 v[60:63], v[156:159], v[76:79], v[60:63]
  s_waitcnt lgkmcnt(0)
  v_mfma_f32_16x16x32_bf16 v[48:51], v[160:163], v[64:67], v[48:51]
  s_waitcnt vmcnt(10)
  ds_read_b128 v[72:75], v16 offset:14336
  ds_read_b128 v[76:79], v17 offset:14336
  v_mfma_f32_16x16x32_bf16 v[52:55], v[164:167], v[64:67], v[52:55]
  s_add_u32 m0, s83, 0
  s_add_u32 s46, s95, 131456
  buffer_load_dwordx4 v3, s[8:11], s46 offen lds
  v_mfma_f32_16x16x32_bf16 v[56:59], v[168:171], v[64:67], v[56:59]
  s_add_u32 m0, m0, 1024
  s_add_u32 s46, s95, 147840
  buffer_load_dwordx4 v3, s[8:11], s46 offen lds
  v_mfma_f32_16x16x32_bf16 v[60:63], v[172:175], v[64:67], v[60:63]
  v_mfma_f32_16x16x32_bf16 v[48:51], v[176:179], v[68:71], v[48:51]
  v_mfma_f32_16x16x32_bf16 v[52:55], v[180:183], v[68:71], v[52:55]
  v_mfma_f32_16x16x32_bf16 v[56:59], v[184:187], v[68:71], v[56:59]
  v_mfma_f32_16x16x32_bf16 v[60:63], v[188:191], v[68:71], v[60:63]
  s_waitcnt lgkmcnt(0)
  v_mfma_f32_16x16x32_bf16 v[48:51], v[192:195], v[72:75], v[48:51]
  s_waitcnt vmcnt(10)
  ds_read_b128 v[64:67], v16 offset:16384
  ds_read_b128 v[68:71], v17 offset:16384
  v_mfma_f32_16x16x32_bf16 v[52:55], v[196:199], v[72:75], v[52:55]
  s_add_u32 m0, s83, 2048
  s_add_u32 s46, s95, 131584
  buffer_load_dwordx4 v3, s[8:11], s46 offen lds
  v_mfma_f32_16x16x32_bf16 v[56:59], v[200:203], v[72:75], v[56:59]
  s_add_u32 m0, m0, 1024
  s_add_u32 s46, s95, 147968
  buffer_load_dwordx4 v3, s[8:11], s46 offen lds
  v_mfma_f32_16x16x32_bf16 v[60:63], v[204:207], v[72:75], v[60:63]
  v_mfma_f32_16x16x32_bf16 v[48:51], v[208:211], v[76:79], v[48:51]
  v_mfma_f32_16x16x32_bf16 v[52:55], v[212:215], v[76:79], v[52:55]
  v_mfma_f32_16x16x32_bf16 v[56:59], v[216:219], v[76:79], v[56:59]
  v_mfma_f32_16x16x32_bf16 v[60:63], v[220:223], v[76:79], v[60:63]
  s_waitcnt lgkmcnt(0)
  v_mfma_f32_16x16x32_bf16 v[48:51], v[224:227], v[64:67], v[48:51]
  s_waitcnt vmcnt(10)
  ds_read_b128 v[72:75], v16 offset:18432
  ds_read_b128 v[76:79], v17 offset:18432
  v_mfma_f32_16x16x32_bf16 v[52:55], v[228:231], v[64:67], v[52:55]
  s_add_u32 m0, s83, 4096
  s_add_u32 s46, s95, 131712
  buffer_load_dwordx4 v3, s[8:11], s46 offen lds
  v_mfma_f32_16x16x32_bf16 v[56:59], v[232:235], v[64:67], v[56:59]
  s_add_u32 m0, m0, 1024
  s_add_u32 s46, s95, 148096
  buffer_load_dwordx4 v3, s[8:11], s46 offen lds
  v_mfma_f32_16x16x32_bf16 v[60:63], v[236:239], v[64:67], v[60:63]
  v_mfma_f32_16x16x32_bf16 v[48:51], v[240:243], v[68:71], v[48:51]
  v_mfma_f32_16x16x32_bf16 v[52:55], v[244:247], v[68:71], v[52:55]
  v_mfma_f32_16x16x32_bf16 v[56:59], v[248:251], v[68:71], v[56:59]
  v_mfma_f32_16x16x32_bf16 v[60:63], v[252:255], v[68:71], v[60:63]
  s_waitcnt lgkmcnt(0)
  v_mfma_f32_16x16x32_bf16 v[48:51], a[0:3], v[72:75], v[48:51]
  s_waitcnt vmcnt(8)
  ds_read_b128 v[64:67], v16 offset:20480
  ds_read_b128 v[68:71], v17 offset:20480
  v_mfma_f32_16x16x32_bf16 v[52:55], a[4:7], v[72:75], v[52:55]
  s_add_u32 m0, s83, 6144
  s_add_u32 s46, s95, 131840
  buffer_load_dwordx4 v3, s[8:11], s46 offen lds
  v_mfma_f32_16x16x32_bf16 v[56:59], a[8:11], v[72:75], v[56:59]
  s_add_u32 m0, m0, 1024
  s_add_u32 s46, s95, 148224
  buffer_load_dwordx4 v3, s[8:11], s46 offen lds
  v_mfma_f32_16x16x32_bf16 v[60:63], a[12:15], v[72:75], v[60:63]
  ds_read_b64_tr_b16 v[160:161], v4 offset:0
  ds_read_b64_tr_b16 v[162:163], v4 offset:1024
  v_mfma_f32_16x16x32_bf16 v[48:51], a[16:19], v[76:79], v[48:51]
  ds_read_b64_tr_b16 v[164:165], v5 offset:0
  ds_read_b64_tr_b16 v[166:167], v5 offset:1024
  v_mfma_f32_16x16x32_bf16 v[52:55], a[20:23], v[76:79], v[52:55]
  ds_read_b64_tr_b16 v[168:169], v6 offset:0
  ds_read_b64_tr_b16 v[170:171], v6 offset:1024
  v_mfma_f32_16x16x32_bf16 v[56:59], a[24:27], v[76:79], v[56:59]
  ds_read_b64_tr_b16 v[172:173], v7 offset:0
  ds_read_b64_tr_b16 v[174:175], v7 offset:1024
  v_mfma_f32_16x16x32_bf16 v[60:63], a[28:31], v[76:79], v[60:63]
  s_waitcnt lgkmcnt(8)
  v_mfma_f32_16x16x32_bf16 v[48:51], a[32:35], v[64:67], v[48:51]
  s_waitcnt vmcnt(8)
  ds_read_b128 v[72:75], v16 offset:22528
  ds_read_b128 v[76:79], v17 offset:22528
  v_mfma_f32_16x16x32_bf16 v[52:55], a[36:39], v[64:67], v[52:55]
  s_add_u32 m0, s83, 8192
  s_add_u32 s46, s95, 131968
  buffer_load_dwordx4 v3, s[8:11], s46 offen lds
  v_mfma_f32_16x16x32_bf16 v[56:59], a[40:43], v[64:67], v[56:59]
  s_add_u32 m0, m0, 1024
  s_add_u32 s46, s95, 148352
  buffer_load_dwordx4 v3, s[8:11], s46 offen lds
  v_mfma_f32_16x16x32_bf16 v[60:63], a[44:47], v[64:67], v[60:63]
  ds_read_b64_tr_b16 v[176:177], v4 offset:4096
  ds_read_b64_tr_b16 v[178:179], v4 offset:5120
  v_mfma_f32_16x16x32_bf16 v[48:51], a[48:51], v[68:71], v[48:51]
  ds_read_b64_tr_b16 v[180:181], v5 offset:4096
  ds_read_b64_tr_b16 v[182:183], v5 offset:5120
  v_mfma_f32_16x16x32_bf16 v[52:55], a[52:55], v[68:71], v[52:55]
  ds_read_b64_tr_b16 v[184:185], v6 offset:4096
  ds_read_b64_tr_b16 v[186:187], v6 offset:5120
  v_mfma_f32_16x16x32_bf16 v[56:59], a[56:59], v[68:71], v[56:59]
  ds_read_b64_tr_b16 v[188:189], v7 offset:4096
  ds_read_b64_tr_b16 v[190:191], v7 offset:5120
  v_mfma_f32_16x16x32_bf16 v[60:63], a[60:63], v[68:71], v[60:63]
  s_waitcnt lgkmcnt(8)
  v_mfma_f32_16x16x32_bf16 v[48:51], a[64:67], v[72:75], v[48:51]
  s_waitcnt vmcnt(8)
  ds_read_b128 v[64:67], v16 offset:0
  ds_read_b128 v[68:71], v17 offset:0
  v_mfma_f32_16x16x32_bf16 v[52:55], a[68:71], v[72:75], v[52:55]
  s_add_u32 m0, s83, 10240
  s_add_u32 s46, s95, 132096
  buffer_load_dwordx4 v3, s[8:11], s46 offen lds
  v_mfma_f32_16x16x32_bf16 v[56:59], a[72:75], v[72:75], v[56:59]
  s_add_u32 m0, m0, 1024
  s_add_u32 s46, s95, 148480
  buffer_load_dwordx4 v3, s[8:11], s46 offen lds
  v_mfma_f32_16x16x32_bf16 v[60:63], a[76:79], v[72:75], v[60:63]
  ds_read_b64_tr_b16 v[192:193], v4 offset:8192
  ds_read_b64_tr_b16 v[194:195], v4 offset:9216
  v_mfma_f32_16x16x32_bf16 v[48:51], a[80:83], v[76:79], v[48:51]
  ds_read_b64_tr_b16 v[196:197], v5 offset:8192
  ds_read_b64_tr_b16 v[198:199], v5 offset:9216
  v_mfma_f32_16x16x32_bf16 v[52:55], a[84:87], v[76:79], v[52:55]
  ds_read_b64_tr_b16 v[200:201], v6 offset:8192
  ds_read_b64_tr_b16 v[202:203], v6 offset:9216
  v_mfma_f32_16x16x32_bf16 v[56:59], a[88:91], v[76:79], v[56:59]
  ds_read_b64_tr_b16 v[204:205], v7 offset:8192
  ds_read_b64_tr_b16 v[206:207], v7 offset:9216
  v_mfma_f32_16x16x32_bf16 v[60:63], a[92:95], v[76:79], v[60:63]
  s_waitcnt lgkmcnt(8)
  v_mfma_f32_16x16x32_bf16 v[48:51], a[96:99], v[64:67], v[48:51]
  s_waitcnt vmcnt(8)
  ds_read_b128 v[72:75], v16 offset:2048
  ds_read_b128 v[76:79], v17 offset:2048
  v_mfma_f32_16x16x32_bf16 v[52:55], a[100:103], v[64:67], v[52:55]
  s_add_u32 m0, s83, 12288
  s_add_u32 s46, s95, 132224
  buffer_load_dwordx4 v3, s[8:11], s46 offen lds
  v_mfma_f32_16x16x32_bf16 v[56:59], a[104:107], v[64:67], v[56:59]
  s_add_u32 m0, m0, 1024
  s_add_u32 s46, s95, 148608
  buffer_load_dwordx4 v3, s[8:11], s46 offen lds
  v_mfma_f32_16x16x32_bf16 v[60:63], a[108:111], v[64:67], v[60:63]
  ds_read_b64_tr_b16 v[208:209], v4 offset:12288
  ds_read_b64_tr_b16 v[210:211], v4 offset:13312
  v_mfma_f32_16x16x32_bf16 v[48:51], a[112:115], v[68:71], v[48:51]
  ds_read_b64_tr_b16 v[212:213], v5 offset:12288
  ds_read_b64_tr_b16 v[214:215], v5 offset:13312
  v_mfma_f32_16x16x32_bf16 v[52:55], a[116:119], v[68:71], v[52:55]
  ds_read_b64_tr_b16 v[216:217], v6 offset:12288
  ds_read_b64_tr_b16 v[218:219], v6 offset:13312
  v_mfma_f32_16x16x32_bf16 v[56:59], a[120:123], v[68:71], v[56:59]
  ds_read_b64_tr_b16 v[220:221], v7 offset:12288
  ds_read_b64_tr_b16 v[222:223], v7 offset:13312
  v_mfma_f32_16x16x32_bf16 v[60:63], a[124:127], v[68:71], v[60:63]
  s_waitcnt lgkmcnt(8)
  v_mfma_f32_16x16x32_bf16 v[48:51], a[128:131], v[72:75], v[48:51]
  s_waitcnt vmcnt(8)
  ds_read_b128 v[64:67], v16 offset:4096
  ds_read_b128 v[68:71], v17 offset:4096
  v_mfma_f32_16x16x32_bf16 v[52:55], a[132:135], v[72:75], v[52:55]
  s_add_u32 m0, s83, 14336
  s_add_u32 s46, s95, 132352
  buffer_load_dwordx4 v3, s[8:11], s46 offen lds
  v_mfma_f32_16x16x32_bf16 v[56:59], a[136:139], v[72:75], v[56:59]
  s_add_u32 m0, m0, 1024
  s_add_u32 s46, s95, 148736
  buffer_load_dwordx4 v3, s[8:11], s46 offen lds
  v_mfma_f32_16x16x32_bf16 v[60:63], a[140:143], v[72:75], v[60:63]
  ds_read_b64_tr_b16 v[224:225], v4 offset:16384
  ds_read_b64_tr_b16 v[226:227], v4 offset:17408
  v_mfma_f32_16x16x32_bf16 v[48:51], a[144:147], v[76:79], v[48:51]
  ds_read_b64_tr_b16 v[228:229], v5 offset:16384
  ds_read_b64_tr_b16 v[230:231], v5 offset:17408
  v_mfma_f32_16x16x32_bf16 v[52:55], a[148:151], v[76:79], v[52:55]
  ds_read_b64_tr_b16 v[232:233], v6 offset:16384
  ds_read_b64_tr_b16 v[234:235], v6 offset:17408
  v_mfma_f32_16x16x32_bf16 v[56:59], a[152:155], v[76:79], v[56:59]
  ds_read_b64_tr_b16 v[236:237], v7 offset:16384
  ds_read_b64_tr_b16 v[238:239], v7 offset:17408
  v_mfma_f32_16x16x32_bf16 v[60:63], a[156:159], v[76:79], v[60:63]
  s_waitcnt lgkmcnt(8)
  v_mfma_f32_16x16x32_bf16 v[48:51], a[160:163], v[64:67], v[48:51]
  s_waitcnt vmcnt(8)
  ds_read_b128 v[72:75], v16 offset:6144
  ds_read_b128 v[76:79], v17 offset:6144
  v_mfma_f32_16x16x32_bf16 v[52:55], a[164:167], v[64:67], v[52:55]
  v_mfma_f32_16x16x32_bf16 v[56:59], a[168:171], v[64:67], v[56:59]
  v_mfma_f32_16x16x32_bf16 v[60:63], a[172:175], v[64:67], v[60:63]
  ds_read_b64_tr_b16 v[240:241], v4 offset:20480
  ds_read_b64_tr_b16 v[242:243], v4 offset:21504
  v_mfma_f32_16x16x32_bf16 v[48:51], a[176:179], v[68:71], v[48:51]
  ds_read_b64_tr_b16 v[244:245], v5 offset:20480
  ds_read_b64_tr_b16 v[246:247], v5 offset:21504
  v_mfma_f32_16x16x32_bf16 v[52:55], a[180:183], v[68:71], v[52:55]
  ds_read_b64_tr_b16 v[248:249], v6 offset:20480
  ds_read_b64_tr_b16 v[250:251], v6 offset:21504
  v_mfma_f32_16x16x32_bf16 v[56:59], a[184:187], v[68:71], v[56:59]
  ds_read_b64_tr_b16 v[252:253], v7 offset:20480
  ds_read_b64_tr_b16 v[254:255], v7 offset:21504
  v_mfma_f32_16x16x32_bf16 v[60:63], a[188:191], v[68:71], v[60:63]
  s_waitcnt lgkmcnt(8)
  v_mfma_f32_16x16x32_bf16 v[48:51], a[192:195], v[72:75], v[48:51]
  s_waitcnt vmcnt(6)
  ds_read_b128 v[64:67], v16 offset:8192
  ds_read_b128 v[68:71], v17 offset:8192
  v_mfma_f32_16x16x32_bf16 v[52:55], a[196:199], v[72:75], v[52:55]
  v_mfma_f32_16x16x32_bf16 v[56:59], a[200:203], v[72:75], v[56:59]
  v_mfma_f32_16x16x32_bf16 v[60:63], a[204:207], v[72:75], v[60:63]
  v_mfma_f32_16x16x32_bf16 v[48:51], a[208:211], v[76:79], v[48:51]
  v_mfma_f32_16x16x32_bf16 v[52:55], a[212:215], v[76:79], v[52:55]
  v_mfma_f32_16x16x32_bf16 v[56:59], a[216:219], v[76:79], v[56:59]
  v_mfma_f32_16x16x32_bf16 v[60:63], a[220:223], v[76:79], v[60:63]
  s_waitcnt lgkmcnt(0)
  v_mfma_f32_16x16x32_bf16 v[48:51], a[224:227], v[64:67], v[48:51]
  s_waitcnt vmcnt(4)
  ds_read_b128 v[72:75], v16 offset:10240
  ds_read_b128 v[76:79], v17 offset:10240
  v_mfma_f32_16x16x32_bf16 v[52:55], a[228:231], v[64:67], v[52:55]
  v_mfma_f32_16x16x32_bf16 v[56:59], a[232:235], v[64:67], v[56:59]
  v_mfma_f32_16x16x32_bf16 v[60:63], a[236:239], v[64:67], v[60:63]
  v_mfma_f32_16x16x32_bf16 v[48:51], a[240:243], v[68:71], v[48:51]
  v_mfma_f32_16x16x32_bf16 v[52:55], a[244:247], v[68:71], v[52:55]
  v_mfma_f32_16x16x32_bf16 v[56:59], a[248:251], v[68:71], v[56:59]
  v_mfma_f32_16x16x32_bf16 v[60:63], a[252:255], v[68:71], v[60:63]
  s_waitcnt lgkmcnt(0)
  v_mfma_f32_16x16x32_bf16 v[48:51], v[160:163], v[72:75], v[48:51]
  s_waitcnt vmcnt(2)
  ds_read_b128 v[64:67], v16 offset:12288
  ds_read_b128 v[68:71], v17 offset:12288
  v_mfma_f32_16x16x32_bf16 v[52:55], v[164:167], v[72:75], v[52:55]
  v_mfma_f32_16x16x32_bf16 v[56:59], v[168:171], v[72:75], v[56:59]
  v_mfma_f32_16x16x32_bf16 v[60:63], v[172:175], v[72:75], v[60:63]
  v_mfma_f32_16x16x32_bf16 v[48:51], v[176:179], v[76:79], v[48:51]
  v_mfma_f32_16x16x32_bf16 v[52:55], v[180:183], v[76:79], v[52:55]
  v_mfma_f32_16x16x32_bf16 v[56:59], v[184:187], v[76:79], v[56:59]
  v_mfma_f32_16x16x32_bf16 v[60:63], v[188:191], v[76:79], v[60:63]
  s_waitcnt lgkmcnt(0)
  v_mfma_f32_16x16x32_bf16 v[48:51], v[192:195], v[64:67], v[48:51]
  s_waitcnt vmcnt(0)
  ds_read_b128 v[72:75], v16 offset:14336
  ds_read_b128 v[76:79], v17 offset:14336
  v_mfma_f32_16x16x32_bf16 v[52:55], v[196:199], v[64:67], v[52:55]
  v_mfma_f32_16x16x32_bf16 v[56:59], v[200:203], v[64:67], v[56:59]
  v_mfma_f32_16x16x32_bf16 v[60:63], v[204:207], v[64:67], v[60:63]
  v_mfma_f32_16x16x32_bf16 v[48:51], v[208:211], v[68:71], v[48:51]
  v_mfma_f32_16x16x32_bf16 v[52:55], v[212:215], v[68:71], v[52:55]
  v_mfma_f32_16x16x32_bf16 v[56:59], v[216:219], v[68:71], v[56:59]
  v_mfma_f32_16x16x32_bf16 v[60:63], v[220:223], v[68:71], v[60:63]
  s_waitcnt lgkmcnt(0)
  v_mfma_f32_16x16x32_bf16 v[48:51], v[224:227], v[72:75], v[48:51]
  v_mfma_f32_16x16x32_bf16 v[48:51], v[240:243], v[76:79], v[48:51]
  v_mfma_f32_16x16x32_bf16 v[52:55], v[228:231], v[72:75], v[52:55]
  v_mfma_f32_16x16x32_bf16 v[52:55], v[244:247], v[76:79], v[52:55]
  v_mfma_f32_16x16x32_bf16 v[56:59], v[232:235], v[72:75], v[56:59]
  v_mfma_f32_16x16x32_bf16 v[56:59], v[248:251], v[76:79], v[56:59]
  v_mfma_f32_16x16x32_bf16 v[60:63], v[236:239], v[72:75], v[60:63]
  v_mfma_f32_16x16x32_bf16 v[60:63], v[252:255], v[76:79], v[60:63]
  s_nop 5
  v_cvt_pk_bf16_f32 v88, v48, v49
  v_cvt_pk_bf16_f32 v89, v50, v51
  v_cvt_pk_bf16_f32 v90, v52, v53
  v_cvt_pk_bf16_f32 v91, v54, v55
  buffer_store_dwordx4 v[88:91], v8, s[24:27], s96 offen offset:0 sc1
  v_cvt_pk_bf16_f32 v92, v56, v57
  v_cvt_pk_bf16_f32 v93, v58, v59
  v_cvt_pk_bf16_f32 v94, v60, v61
  v_cvt_pk_bf16_f32 v95, v62, v63
  buffer_store_dwordx4 v[92:95], v8, s[24:27], s96 offen offset:1024 sc1
  s_waitcnt vmcnt(0)
  s_mov_b64 exec, 0x1
  buffer_store_dword v13, v18, s[24:27], s93 offen offset:128 sc1
  s_mov_b64 exec, -1
  s_mov_b64 exec, 0x1
  buffer_store_dword v13, v18, s[24:27], s93 offen offset:0 sc1
  s_mov_b64 exec, -1
  s_mov_b32 s20, s74
  s_mov_b32 s21, s75
  s_mov_b32 s22, 25690112
  s_mov_b32 s23, 0x20000
  s_and_b32 s62, s4, 3
  s_lshr_b32 s82, s4, 2
  s_lshl_b32 s6, s82, 1
  s_add_u32 s62, s62, s6
  s_add_u32 s62, s62, 1
  s_and_b32 s62, s62, 3
  s_mul_i32 s6, s62, 28
  s_mul_i32 s7, s3, 7
  s_add_u32 s96, s6, s7
  v_lshrrev_b32 v2, 2, v1
  v_lshlrev_b32 v2, 2, v2
  v_bfe_u32 v3, v1, 1, 1
  v_add_u32 v2, v2, v3
  v_mul_u32_u24 v2, 7168, v2
  v_and_b32 v3, 1, v1
  v_lshl_add_u32 v2, v3, 7, v2
  s_waitcnt vmcnt(0)
  s_barrier
  s_lshl_b32 s97, s5, 2
  s_add_u32 s97, s97, s3
  s_lshl_b32 s46, s82, 4
  s_lshl_b32 s6, s5, 2
  s_add_u32 s46, s46, s6
  s_add_u32 s46, s46, 1
  s_cmp_eq_u32 s46, 29
  s_cselect_b32 s46, 15, s46
  s_lshl_b32 s46, s46, 8
  s_add_u32 s6, s96, 4
  s_lshr_b32 s44, s6, 1
  s_lshl_b32 s44, s44, 5
  s_and_b32 s6, s6, 1
  s_add_u32 s44, s44, s6
  s_mul_i32 s44, s44, 14336
  s_add_u32 s44, s44, s46
  buffer_load_dword v32, v2, s[20:23], s44 offen
  s_add_u32 s6, s96, 5
  s_lshr_b32 s44, s6, 1
  s_lshl_b32 s44, s44, 5
  s_and_b32 s6, s6, 1
  s_add_u32 s44, s44, s6
  s_mul_i32 s44, s44, 14336
  s_add_u32 s44, s44, s46
  buffer_load_dword v33, v2, s[20:23], s44 offen
  s_add_u32 s6, s96, 6
  s_lshr_b32 s44, s6, 1
  s_lshl_b32 s44, s44, 5
  s_and_b32 s6, s6, 1
  s_add_u32 s44, s44, s6
  s_mul_i32 s44, s44, 14336
  s_add_u32 s44, s44, s46
  buffer_load_dword v34, v2, s[20:23], s44 offen
  s_waitcnt vmcnt(0)
  s_endpgm
L_w3:
  s_cmp_eq_u32 s63, 1
  s_cbranch_scc1 L_typeB
  v_lshlrev_b32 v26, 7, v1
  buffer_load_dword v27, v26, s[36:39], s80 offen
  s_bfe_u32 s6, s94, 0x40008
  s_add_u32 s6, s6, s95
  s_mul_i32 s45, s6, 458752
  buffer_load_dwordx4 v[96:99], v2, s[12:15], s45 offen
  s_waitcnt vmcnt(18)
  v_lshlrev_b32 v16, 16, v18
  v_and_b32 v17, 0xffff0000, v18
  v_lshlrev_b32 v18, 16, v19
  v_and_b32 v19, 0xffff0000, v19
  s_waitcnt vmcnt(10)
  v_cvt_f32_i32 v32, v32
  v_cvt_f32_i32 v33, v33
  v_cvt_f32_i32 v34, v34
  v_cvt_f32_i32 v35, v35
  v_pk_add_f32 v[32:33], v[32:33], v[16:17] neg_lo:[0,1] neg_hi:[0,1]
  v_pk_add_f32 v[34:35], v[34:35], v[18:19] neg_lo:[0,1] neg_hi:[0,1]
  s_add_u32 s44, s45, 14336
  buffer_load_dwordx4 v[100:103], v2, s[12:15], s44 offen
  v_cvt_f32_i32 v36, v36
  v_cvt_f32_i32 v37, v37
  v_cvt_f32_i32 v38, v38
  v_cvt_f32_i32 v39, v39
  v_pk_add_f32 v[36:37], v[36:37], v[16:17] neg_lo:[0,1] neg_hi:[0,1]
  v_pk_add_f32 v[38:39], v[38:39], v[18:19] neg_lo:[0,1] neg_hi:[0,1]
  v_cvt_pk_bf16_f32 v128, v32, v36
  v_cvt_pk_bf16_f32 v132, v33, v37
  s_add_u32 s44, s45, 28672
  buffer_load_dwordx4 v[104:107], v2, s[12:15], s44 offen
  v_cvt_pk_bf16_f32 v136, v34, v38
  v_cvt_pk_bf16_f32 v140, v35, v39
  v_cvt_f32_i32 v40, v40
  v_cvt_f32_i32 v41, v41
  v_cvt_f32_i32 v42, v42
  v_cvt_f32_i32 v43, v43
  v_pk_add_f32 v[40:41], v[40:41], v[16:17] neg_lo:[0,1] neg_hi:[0,1]
  v_pk_add_f32 v[42:43], v[42:43], v[18:19] neg_lo:[0,1] neg_hi:[0,1]
  s_add_u32 s44, s45, 43008
  buffer_load_dwordx4 v[108:111], v2, s[12:15], s44 offen
  v_cvt_f32_i32 v44, v44
  v_cvt_f32_i32 v45, v45
  v_cvt_f32_i32 v46, v46
  v_cvt_f32_i32 v47, v47
  v_pk_add_f32 v[44:45], v[44:45], v[16:17] neg_lo:[0,1] neg_hi:[0,1]
  v_pk_add_f32 v[46:47], v[46:47], v[18:19] neg_lo:[0,1] neg_hi:[0,1]
  v_cvt_pk_bf16_f32 v129, v40, v44
  v_cvt_pk_bf16_f32 v133, v41, v45
  s_add_u32 s44, s45, 229376
  buffer_load_dwordx4 v[112:115], v2, s[12:15], s44 offen
  v_cvt_pk_bf16_f32 v137, v42, v46
  v_cvt_pk_bf16_f32 v141, v43, v47
  v_cvt_f32_i32 v48, v48
  v_cvt_f32_i32 v49, v49
  v_cvt_f32_i32 v50, v50
  v_cvt_f32_i32 v51, v51
  v_pk_add_f32 v[48:49], v[48:49], v[16:17] neg_lo:[0,1] neg_hi:[0,1]
  v_pk_add_f32 v[50:51], v[50:51], v[18:19] neg_lo:[0,1] neg_hi:[0,1]
  s_add_u32 s44, s45, 243712
  buffer_load_dwordx4 v[116:119], v2, s[12:15], s44 offen
  v_cvt_f32_i32 v52, v52
  v_cvt_f32_i32 v53, v53
  v_cvt_f32_i32 v54, v54
  v_cvt_f32_i32 v55, v55
  v_pk_add_f32 v[52:53], v[52:53], v[16:17] neg_lo:[0,1] neg_hi:[0,1]
  v_pk_add_f32 v[54:55], v[54:55], v[18:19] neg_lo:[0,1] neg_hi:[0,1]
  v_cvt_pk_bf16_f32 v130, v48, v52
  v_cvt_pk_bf16_f32 v134, v49, v53
  s_add_u32 s44, s45, 258048
  buffer_load_dwordx4 v[120:123], v2, s[12:15], s44 offen
  v_cvt_pk_bf16_f32 v138, v50, v54
  v_cvt_pk_bf16_f32 v142, v51, v55
  v_cvt_f32_i32 v56, v56
  v_cvt_f32_i32 v57, v57
  v_cvt_f32_i32 v58, v58
  v_cvt_f32_i32 v59, v59
  v_pk_add_f32 v[56:57], v[56:57], v[16:17] neg_lo:[0,1] neg_hi:[0,1]
  v_pk_add_f32 v[58:59], v[58:59], v[18:19] neg_lo:[0,1] neg_hi:[0,1]
  s_add_u32 s44, s45, 272384
  buffer_load_dwordx4 v[124:127], v2, s[12:15], s44 offen
  v_cvt_f32_i32 v60, v60
  v_cvt_f32_i32 v61, v61
  v_cvt_f32_i32 v62, v62
  v_cvt_f32_i32 v63, v63
  v_pk_add_f32 v[60:61], v[60:61], v[16:17] neg_lo:[0,1] neg_hi:[0,1]
  v_pk_add_f32 v[62:63], v[62:63], v[18:19] neg_lo:[0,1] neg_hi:[0,1]
  v_cvt_pk_bf16_f32 v131, v56, v60
  v_cvt_pk_bf16_f32 v135, v57, v61
  v_cvt_pk_bf16_f32 v139, v58, v62
  v_cvt_pk_bf16_f32 v143, v59, v63
  s_bfe_u32 s6, s94, 0x4000c
  s_add_u32 s6, s6, s95
  s_mul_i32 s45, s6, 458752
  buffer_load_dwordx4 v[32:35], v2, s[12:15], s45 offen
  s_waitcnt vmcnt(10)
  v_cvt_f32_i32 v64, v64
  v_cvt_f32_i32 v65, v65
  v_cvt_f32_i32 v66, v66
  v_cvt_f32_i32 v67, v67
  v_pk_add_f32 v[64:65], v[64:65], v[16:17] neg_lo:[0,1] neg_hi:[0,1]
  v_pk_add_f32 v[66:67], v[66:67], v[18:19] neg_lo:[0,1] neg_hi:[0,1]
  v_cvt_f32_i32 v68, v68
  s_add_u32 s44, s45, 14336
  buffer_load_dwordx4 v[36:39], v2, s[12:15], s44 offen
  v_cvt_f32_i32 v69, v69
  v_cvt_f32_i32 v70, v70
  v_cvt_f32_i32 v71, v71
  v_pk_add_f32 v[68:69], v[68:69], v[16:17] neg_lo:[0,1] neg_hi:[0,1]
  v_pk_add_f32 v[70:71], v[70:71], v[18:19] neg_lo:[0,1] neg_hi:[0,1]
  v_cvt_pk_bf16_f32 v144, v64, v68
  v_cvt_pk_bf16_f32 v148, v65, v69
  v_cvt_pk_bf16_f32 v152, v66, v70
  s_add_u32 s44, s45, 28672
  buffer_load_dwordx4 v[40:43], v2, s[12:15], s44 offen
  v_cvt_pk_bf16_f32 v156, v67, v71
  v_cvt_f32_i32 v72, v72
  v_cvt_f32_i32 v73, v73
  v_cvt_f32_i32 v74, v74
  v_cvt_f32_i32 v75, v75
  v_pk_add_f32 v[72:73], v[72:73], v[16:17] neg_lo:[0,1] neg_hi:[0,1]
  v_pk_add_f32 v[74:75], v[74:75], v[18:19] neg_lo:[0,1] neg_hi:[0,1]
  v_cvt_f32_i32 v76, v76
  s_add_u32 s44, s45, 43008
  buffer_load_dwordx4 v[44:47], v2, s[12:15], s44 offen
  v_cvt_f32_i32 v77, v77
  v_cvt_f32_i32 v78, v78
  v_cvt_f32_i32 v79, v79
  v_pk_add_f32 v[76:77], v[76:77], v[16:17] neg_lo:[0,1] neg_hi:[0,1]
  v_pk_add_f32 v[78:79], v[78:79], v[18:19] neg_lo:[0,1] neg_hi:[0,1]
  v_cvt_pk_bf16_f32 v145, v72, v76
  v_cvt_pk_bf16_f32 v149, v73, v77
  v_cvt_pk_bf16_f32 v153, v74, v78
  s_add_u32 s44, s45, 229376
  buffer_load_dwordx4 v[48:51], v2, s[12:15], s44 offen
  v_cvt_pk_bf16_f32 v157, v75, v79
  v_cvt_f32_i32 v80, v80
  v_cvt_f32_i32 v81, v81
  v_cvt_f32_i32 v82, v82
  v_cvt_f32_i32 v83, v83
  v_pk_add_f32 v[80:81], v[80:81], v[16:17] neg_lo:[0,1] neg_hi:[0,1]
  v_pk_add_f32 v[82:83], v[82:83], v[18:19] neg_lo:[0,1] neg_hi:[0,1]
  v_cvt_f32_i32 v84, v84
  s_add_u32 s44, s45, 243712
  buffer_load_dwordx4 v[52:55], v2, s[12:15], s44 offen
  v_cvt_f32_i32 v85, v85
  v_cvt_f32_i32 v86, v86
  v_cvt_f32_i32 v87, v87
  v_pk_add_f32 v[84:85], v[84:85], v[16:17] neg_lo:[0,1] neg_hi:[0,1]
  v_pk_add_f32 v[86:87], v[86:87], v[18:19] neg_lo:[0,1] neg_hi:[0,1]
  v_cvt_pk_bf16_f32 v146, v80, v84
  v_cvt_pk_bf16_f32 v150, v81, v85
  v_cvt_pk_bf16_f32 v154, v82, v86
  s_add_u32 s44, s45, 258048
  buffer_load_dwordx4 v[56:59], v2, s[12:15], s44 offen
  v_cvt_pk_bf16_f32 v158, v83, v87
  v_cvt_f32_i32 v88, v88
  v_cvt_f32_i32 v89, v89
  v_cvt_f32_i32 v90, v90
  v_cvt_f32_i32 v91, v91
  v_pk_add_f32 v[88:89], v[88:89], v[16:17] neg_lo:[0,1] neg_hi:[0,1]
  v_pk_add_f32 v[90:91], v[90:91], v[18:19] neg_lo:[0,1] neg_hi:[0,1]
  v_cvt_f32_i32 v92, v92
  s_add_u32 s44, s45, 272384
  buffer_load_dwordx4 v[60:63], v2, s[12:15], s44 offen
  v_cvt_f32_i32 v93, v93
  v_cvt_f32_i32 v94, v94
  v_cvt_f32_i32 v95, v95
  v_pk_add_f32 v[92:93], v[92:93], v[16:17] neg_lo:[0,1] neg_hi:[0,1]
  v_pk_add_f32 v[94:95], v[94:95], v[18:19] neg_lo:[0,1] neg_hi:[0,1]
  v_cvt_pk_bf16_f32 v147, v88, v92
  v_cvt_pk_bf16_f32 v151, v89, v93
  v_cvt_pk_bf16_f32 v155, v90, v94
  v_cvt_pk_bf16_f32 v159, v91, v95
  s_bfe_u32 s6, s94, 0x40010
  s_add_u32 s6, s6, s95
  s_mul_i32 s45, s6, 458752
  buffer_load_dwordx4 v[64:67], v2, s[12:15], s45 offen
  s_waitcnt vmcnt(9)
  v_cvt_f32_i32 v96, v96
  v_cvt_f32_i32 v97, v97
  v_cvt_f32_i32 v98, v98
  v_cvt_f32_i32 v99, v99
  v_pk_add_f32 v[96:97], v[96:97], v[16:17] neg_lo:[0,1] neg_hi:[0,1]
  v_pk_add_f32 v[98:99], v[98:99], v[18:19] neg_lo:[0,1] neg_hi:[0,1]
  v_cvt_f32_i32 v100, v100
  s_add_u32 s44, s45, 14336
  buffer_load_dwordx4 v[68:71], v2, s[12:15], s44 offen
  v_cvt_f32_i32 v101, v101
  v_cvt_f32_i32 v102, v102
  v_cvt_f32_i32 v103, v103
  v_pk_add_f32 v[100:101], v[100:101], v[16:17] neg_lo:[0,1] neg_hi:[0,1]
  v_pk_add_f32 v[102:103], v[102:103], v[18:19] neg_lo:[0,1] neg_hi:[0,1]
  v_cvt_pk_bf16_f32 v160, v96, v100
  v_cvt_pk_bf16_f32 v164, v97, v101
  v_cvt_pk_bf16_f32 v168, v98, v102
  s_add_u32 s44, s45, 28672
  buffer_load_dwordx4 v[72:75], v2, s[12:15], s44 offen
  v_cvt_pk_bf16_f32 v172, v99, v103
  v_cvt_f32_i32 v104, v104
  v_cvt_f32_i32 v105, v105
  v_cvt_f32_i32 v106, v106
  v_cvt_f32_i32 v107, v107
  v_pk_add_f32 v[104:105], v[104:105], v[16:17] neg_lo:[0,1] neg_hi:[0,1]
  v_pk_add_f32 v[106:107], v[106:107], v[18:19] neg_lo:[0,1] neg_hi:[0,1]
  v_cvt_f32_i32 v108, v108
  s_add_u32 s44, s45, 43008
  buffer_load_dwordx4 v[76:79], v2, s[12:15], s44 offen
  v_cvt_f32_i32 v109, v109
  v_cvt_f32_i32 v110, v110
  v_cvt_f32_i32 v111, v111
  v_pk_add_f32 v[108:109], v[108:109], v[16:17] neg_lo:[0,1] neg_hi:[0,1]
  v_pk_add_f32 v[110:111], v[110:111], v[18:19] neg_lo:[0,1] neg_hi:[0,1]
  v_cvt_pk_bf16_f32 v161, v104, v108
  v_cvt_pk_bf16_f32 v165, v105, v109
  v_cvt_pk_bf16_f32 v169, v106, v110
  s_add_u32 s44, s45, 229376
  buffer_load_dwordx4 v[80:83], v2, s[12:15], s44 offen
  v_cvt_pk_bf16_f32 v173, v107, v111
  v_cvt_f32_i32 v112, v112
  v_cvt_f32_i32 v113, v113
  v_cvt_f32_i32 v114, v114
  v_cvt_f32_i32 v115, v115
  v_pk_add_f32 v[112:113], v[112:113], v[16:17] neg_lo:[0,1] neg_hi:[0,1]
  v_pk_add_f32 v[114:115], v[114:115], v[18:19] neg_lo:[0,1] neg_hi:[0,1]
  v_cvt_f32_i32 v116, v116
  s_add_u32 s44, s45, 243712
  buffer_load_dwordx4 v[84:87], v2, s[12:15], s44 offen
  v_cvt_f32_i32 v117, v117
  v_cvt_f32_i32 v118, v118
  v_cvt_f32_i32 v119, v119
  v_pk_add_f32 v[116:117], v[116:117], v[16:17] neg_lo:[0,1] neg_hi:[0,1]
  v_pk_add_f32 v[118:119], v[118:119], v[18:19] neg_lo:[0,1] neg_hi:[0,1]
  v_cvt_pk_bf16_f32 v162, v112, v116
  v_cvt_pk_bf16_f32 v166, v113, v117
  v_cvt_pk_bf16_f32 v170, v114, v118
  s_add_u32 s44, s45, 258048
  buffer_load_dwordx4 v[88:91], v2, s[12:15], s44 offen
  v_cvt_pk_bf16_f32 v174, v115, v119
  v_cvt_f32_i32 v120, v120
  v_cvt_f32_i32 v121, v121
  v_cvt_f32_i32 v122, v122
  v_cvt_f32_i32 v123, v123
  v_pk_add_f32 v[120:121], v[120:121], v[16:17] neg_lo:[0,1] neg_hi:[0,1]
  v_pk_add_f32 v[122:123], v[122:123], v[18:19] neg_lo:[0,1] neg_hi:[0,1]
  v_cvt_f32_i32 v124, v124
  s_add_u32 s44, s45, 272384
  buffer_load_dwordx4 v[92:95], v2, s[12:15], s44 offen
  v_cvt_f32_i32 v125, v125
  v_cvt_f32_i32 v126, v126
  v_cvt_f32_i32 v127, v127
  v_pk_add_f32 v[124:125], v[124:125], v[16:17] neg_lo:[0,1] neg_hi:[0,1]
  v_pk_add_f32 v[126:127], v[126:127], v[18:19] neg_lo:[0,1] neg_hi:[0,1]
  v_cvt_pk_bf16_f32 v163, v120, v124
  v_cvt_pk_bf16_f32 v167, v121, v125
  v_cvt_pk_bf16_f32 v171, v122, v126
  v_cvt_pk_bf16_f32 v175, v123, v127
  s_bfe_u32 s6, s94, 0x40014
  s_add_u32 s6, s6, s95
  s_mul_i32 s45, s6, 458752
  buffer_load_dwordx4 v[96:99], v2, s[12:15], s45 offen
  s_waitcnt vmcnt(9)
  v_cvt_f32_i32 v32, v32
  v_cvt_f32_i32 v33, v33
  v_cvt_f32_i32 v34, v34
  v_cvt_f32_i32 v35, v35
  v_pk_add_f32 v[32:33], v[32:33], v[16:17] neg_lo:[0,1] neg_hi:[0,1]
  v_pk_add_f32 v[34:35], v[34:35], v[18:19] neg_lo:[0,1] neg_hi:[0,1]
  v_cvt_f32_i32 v36, v36
  s_add_u32 s44, s45, 14336
  buffer_load_dwordx4 v[100:103], v2, s[12:15], s44 offen
  v_cvt_f32_i32 v37, v37
  v_cvt_f32_i32 v38, v38
  v_cvt_f32_i32 v39, v39
  v_pk_add_f32 v[36:37], v[36:37], v[16:17] neg_lo:[0,1] neg_hi:[0,1]
  v_pk_add_f32 v[38:39], v[38:39], v[18:19] neg_lo:[0,1] neg_hi:[0,1]
  v_cvt_pk_bf16_f32 v176, v32, v36
  v_cvt_pk_bf16_f32 v180, v33, v37
  v_cvt_pk_bf16_f32 v184, v34, v38
  s_add_u32 s44, s45, 28672
  buffer_load_dwordx4 v[104:107], v2, s[12:15], s44 offen
  v_cvt_pk_bf16_f32 v188, v35, v39
  v_cvt_f32_i32 v40, v40
  v_cvt_f32_i32 v41, v41
  v_cvt_f32_i32 v42, v42
  v_cvt_f32_i32 v43, v43
  v_pk_add_f32 v[40:41], v[40:41], v[16:17] neg_lo:[0,1] neg_hi:[0,1]
  v_pk_add_f32 v[42:43], v[42:43], v[18:19] neg_lo:[0,1] neg_hi:[0,1]
  v_cvt_f32_i32 v44, v44
  s_add_u32 s44, s45, 43008
  buffer_load_dwordx4 v[108:111], v2, s[12:15], s44 offen
  v_cvt_f32_i32 v45, v45
  v_cvt_f32_i32 v46, v46
  v_cvt_f32_i32 v47, v47
  v_pk_add_f32 v[44:45], v[44:45], v[16:17] neg_lo:[0,1] neg_hi:[0,1]
  v_pk_add_f32 v[46:47], v[46:47], v[18:19] neg_lo:[0,1] neg_hi:[0,1]
  v_cvt_pk_bf16_f32 v177, v40, v44
  v_cvt_pk_bf16_f32 v181, v41, v45
  v_cvt_pk_bf16_f32 v185, v42, v46
  s_add_u32 s44, s45, 229376
  buffer_load_dwordx4 v[112:115], v2, s[12:15], s44 offen
  v_cvt_pk_bf16_f32 v189, v43, v47
  v_cvt_f32_i32 v48, v48
  v_cvt_f32_i32 v49, v49
  v_cvt_f32_i32 v50, v50
  v_cvt_f32_i32 v51, v51
  v_pk_add_f32 v[48:49], v[48:49], v[16:17] neg_lo:[0,1] neg_hi:[0,1]
  v_pk_add_f32 v[50:51], v[50:51], v[18:19] neg_lo:[0,1] neg_hi:[0,1]
  v_cvt_f32_i32 v52, v52
  s_add_u32 s44, s45, 243712
  buffer_load_dwordx4 v[116:119], v2, s[12:15], s44 offen
  v_cvt_f32_i32 v53, v53
  v_cvt_f32_i32 v54, v54
  v_cvt_f32_i32 v55, v55
  v_pk_add_f32 v[52:53], v[52:53], v[16:17] neg_lo:[0,1] neg_hi:[0,1]
  v_pk_add_f32 v[54:55], v[54:55], v[18:19] neg_lo:[0,1] neg_hi:[0,1]
  v_cvt_pk_bf16_f32 v178, v48, v52
  v_cvt_pk_bf16_f32 v182, v49, v53
  v_cvt_pk_bf16_f32 v186, v50, v54
  s_add_u32 s44, s45, 258048
  buffer_load_dwordx4 v[120:123], v2, s[12:15], s44 offen
  v_cvt_pk_bf16_f32 v190, v51, v55
  v_cvt_f32_i32 v56, v56
  v_cvt_f32_i32 v57, v57
  v_cvt_f32_i32 v58, v58
  v_cvt_f32_i32 v59, v59
  v_pk_add_f32 v[56:57], v[56:57], v[16:17] neg_lo:[0,1] neg_hi:[0,1]
  v_pk_add_f32 v[58:59], v[58:59], v[18:19] neg_lo:[0,1] neg_hi:[0,1]
  v_cvt_f32_i32 v60, v60
  s_add_u32 s44, s45, 272384
  buffer_load_dwordx4 v[124:127], v2, s[12:15], s44 offen
  v_cvt_f32_i32 v61, v61
  v_cvt_f32_i32 v62, v62
  v_cvt_f32_i32 v63, v63
  v_pk_add_f32 v[60:61], v[60:61], v[16:17] neg_lo:[0,1] neg_hi:[0,1]
  v_pk_add_f32 v[62:63], v[62:63], v[18:19] neg_lo:[0,1] neg_hi:[0,1]
  v_cvt_pk_bf16_f32 v179, v56, v60
  v_cvt_pk_bf16_f32 v183, v57, v61
  v_cvt_pk_bf16_f32 v187, v58, v62
  v_cvt_pk_bf16_f32 v191, v59, v63
  v_lshlrev_b32 v0, 2, v1
  buffer_load_dword v14, v0, s[40:43], 0 offen sc1
  s_waitcnt vmcnt(9)
  v_cvt_f32_i32 v64, v64
  v_cvt_f32_i32 v65, v65
  v_cvt_f32_i32 v66, v66
  v_cvt_f32_i32 v67, v67
  v_pk_add_f32 v[64:65], v[64:65], v[16:17] neg_lo:[0,1] neg_hi:[0,1]
  s_lshl_b32 s6, s60, 7
  s_and_b32 s44, s3, 1
  s_lshl_b32 s44, s44, 2
  s_add_u32 s6, s6, s44
  v_lshrrev_b32 v26, 4, v1
  v_lshlrev_b32 v26, 5, v26
  buffer_load_dword v20, v26, s[32:35], s6 offen offset:0
  buffer_load_dword v21, v26, s[32:35], s6 offen offset:8
  buffer_load_dword v22, v26, s[32:35], s6 offen offset:16
  buffer_load_dword v23, v26, s[32:35], s6 offen offset:24
  v_pk_add_f32 v[66:67], v[66:67], v[18:19] neg_lo:[0,1] neg_hi:[0,1]
  v_cvt_f32_i32 v68, v68
  v_cvt_f32_i32 v69, v69
  v_cvt_f32_i32 v70, v70
  v_cvt_f32_i32 v71, v71
  v_pk_add_f32 v[68:69], v[68:69], v[16:17] neg_lo:[0,1] neg_hi:[0,1]
  s_bfe_u32 s6, s94, 0x40018
  s_add_u32 s6, s6, s95
  s_mul_i32 s45, s6, 458752
  buffer_load_dwordx4 v[32:35], v2, s[12:15], s45 offen
  v_pk_add_f32 v[70:71], v[70:71], v[18:19] neg_lo:[0,1] neg_hi:[0,1]
  v_cvt_pk_bf16_f32 v192, v64, v68
  v_cvt_pk_bf16_f32 v196, v65, v69
  v_cvt_pk_bf16_f32 v200, v66, v70
  v_cvt_pk_bf16_f32 v204, v67, v71
  v_cvt_f32_i32 v72, v72
  s_add_u32 s44, s45, 14336
  buffer_load_dwordx4 v[36:39], v2, s[12:15], s44 offen
  v_cvt_f32_i32 v73, v73
  v_cvt_f32_i32 v74, v74
  v_cvt_f32_i32 v75, v75
  v_pk_add_f32 v[72:73], v[72:73], v[16:17] neg_lo:[0,1] neg_hi:[0,1]
  v_pk_add_f32 v[74:75], v[74:75], v[18:19] neg_lo:[0,1] neg_hi:[0,1]
  v_cvt_f32_i32 v76, v76
  s_add_u32 s44, s45, 28672
  buffer_load_dwordx4 v[40:43], v2, s[12:15], s44 offen
  v_cvt_f32_i32 v77, v77
  v_cvt_f32_i32 v78, v78
  v_cvt_f32_i32 v79, v79
  v_pk_add_f32 v[76:77], v[76:77], v[16:17] neg_lo:[0,1] neg_hi:[0,1]
  v_pk_add_f32 v[78:79], v[78:79], v[18:19] neg_lo:[0,1] neg_hi:[0,1]
  v_cvt_pk_bf16_f32 v193, v72, v76
  s_add_u32 s44, s45, 43008
  buffer_load_dwordx4 v[44:47], v2, s[12:15], s44 offen
  v_cvt_pk_bf16_f32 v197, v73, v77
  v_cvt_pk_bf16_f32 v201, v74, v78
  v_cvt_pk_bf16_f32 v205, v75, v79
  v_cvt_f32_i32 v80, v80
  v_cvt_f32_i32 v81, v81
  v_cvt_f32_i32 v82, v82
  s_add_u32 s44, s45, 229376
  buffer_load_dwordx4 v[48:51], v2, s[12:15], s44 offen
  v_cvt_f32_i32 v83, v83
  v_pk_add_f32 v[80:81], v[80:81], v[16:17] neg_lo:[0,1] neg_hi:[0,1]
  v_pk_add_f32 v[82:83], v[82:83], v[18:19] neg_lo:[0,1] neg_hi:[0,1]
  v_cvt_f32_i32 v84, v84
  v_cvt_f32_i32 v85, v85
  v_cvt_f32_i32 v86, v86
  s_add_u32 s44, s45, 243712
  buffer_load_dwordx4 v[52:55], v2, s[12:15], s44 offen
  v_cvt_f32_i32 v87, v87
  v_pk_add_f32 v[84:85], v[84:85], v[16:17] neg_lo:[0,1] neg_hi:[0,1]
  v_pk_add_f32 v[86:87], v[86:87], v[18:19] neg_lo:[0,1] neg_hi:[0,1]
  v_cvt_pk_bf16_f32 v194, v80, v84
  v_cvt_pk_bf16_f32 v198, v81, v85
  v_cvt_pk_bf16_f32 v202, v82, v86
  s_add_u32 s44, s45, 258048
  buffer_load_dwordx4 v[56:59], v2, s[12:15], s44 offen
  v_cvt_pk_bf16_f32 v206, v83, v87
  v_cvt_f32_i32 v88, v88
  v_cvt_f32_i32 v89, v89
  v_cvt_f32_i32 v90, v90
  v_cvt_f32_i32 v91, v91
  v_pk_add_f32 v[88:89], v[88:89], v[16:17] neg_lo:[0,1] neg_hi:[0,1]
  s_add_u32 s44, s45, 272384
  buffer_load_dwordx4 v[60:63], v2, s[12:15], s44 offen
  v_pk_add_f32 v[90:91], v[90:91], v[18:19] neg_lo:[0,1] neg_hi:[0,1]
  v_cvt_f32_i32 v92, v92
  v_cvt_f32_i32 v93, v93
  v_cvt_f32_i32 v94, v94
  v_cvt_f32_i32 v95, v95
  v_pk_add_f32 v[92:93], v[92:93], v[16:17] neg_lo:[0,1] neg_hi:[0,1]
  v_pk_add_f32 v[94:95], v[94:95], v[18:19] neg_lo:[0,1] neg_hi:[0,1]
  v_cvt_pk_bf16_f32 v195, v88, v92
  v_cvt_pk_bf16_f32 v199, v89, v93
  v_cvt_pk_bf16_f32 v203, v90, v94
  v_cvt_pk_bf16_f32 v207, v91, v95
  s_bfe_u32 s6, s94, 0x4001c
  s_add_u32 s6, s6, s95
  s_mul_i32 s45, s6, 458752
  buffer_load_dwordx4 v[64:67], v2, s[12:15], s45 offen
  s_waitcnt vmcnt(14)
  v_cvt_f32_i32 v96, v96
  v_cvt_f32_i32 v97, v97
  v_cvt_f32_i32 v98, v98
  v_cvt_f32_i32 v99, v99
  v_pk_add_f32 v[96:97], v[96:97], v[16:17] neg_lo:[0,1] neg_hi:[0,1]
  v_pk_add_f32 v[98:99], v[98:99], v[18:19] neg_lo:[0,1] neg_hi:[0,1]
  v_cvt_f32_i32 v100, v100
  s_add_u32 s44, s45, 14336
  buffer_load_dwordx4 v[68:71], v2, s[12:15], s44 offen
  v_cvt_f32_i32 v101, v101
  v_cvt_f32_i32 v102, v102
  v_cvt_f32_i32 v103, v103
  v_pk_add_f32 v[100:101], v[100:101], v[16:17] neg_lo:[0,1] neg_hi:[0,1]
  v_pk_add_f32 v[102:103], v[102:103], v[18:19] neg_lo:[0,1] neg_hi:[0,1]
  v_cvt_pk_bf16_f32 v208, v96, v100
  v_cvt_pk_bf16_f32 v212, v97, v101
  v_cvt_pk_bf16_f32 v216, v98, v102
  s_add_u32 s44, s45, 28672
  buffer_load_dwordx4 v[72:75], v2, s[12:15], s44 offen
  v_cvt_pk_bf16_f32 v220, v99, v103
  v_cvt_f32_i32 v104, v104
  v_cvt_f32_i32 v105, v105
  v_cvt_f32_i32 v106, v106
  v_cvt_f32_i32 v107, v107
  v_pk_add_f32 v[104:105], v[104:105], v[16:17] neg_lo:[0,1] neg_hi:[0,1]
  v_pk_add_f32 v[106:107], v[106:107], v[18:19] neg_lo:[0,1] neg_hi:[0,1]
  v_cvt_f32_i32 v108, v108
  s_add_u32 s44, s45, 43008
  buffer_load_dwordx4 v[76:79], v2, s[12:15], s44 offen
  v_cvt_f32_i32 v109, v109
  v_cvt_f32_i32 v110, v110
  v_cvt_f32_i32 v111, v111
  v_pk_add_f32 v[108:109], v[108:109], v[16:17] neg_lo:[0,1] neg_hi:[0,1]
  v_pk_add_f32 v[110:111], v[110:111], v[18:19] neg_lo:[0,1] neg_hi:[0,1]
  v_cvt_pk_bf16_f32 v209, v104, v108
  v_cvt_pk_bf16_f32 v213, v105, v109
  v_cvt_pk_bf16_f32 v217, v106, v110
  s_add_u32 s44, s45, 229376
  buffer_load_dwordx4 v[80:83], v2, s[12:15], s44 offen
  v_cvt_pk_bf16_f32 v221, v107, v111
  v_cvt_f32_i32 v112, v112
  v_cvt_f32_i32 v113, v113
  v_cvt_f32_i32 v114, v114
  v_cvt_f32_i32 v115, v115
  v_pk_add_f32 v[112:113], v[112:113], v[16:17] neg_lo:[0,1] neg_hi:[0,1]
  v_pk_add_f32 v[114:115], v[114:115], v[18:19] neg_lo:[0,1] neg_hi:[0,1]
  v_cvt_f32_i32 v116, v116
  s_add_u32 s44, s45, 243712
  buffer_load_dwordx4 v[84:87], v2, s[12:15], s44 offen
  v_cvt_f32_i32 v117, v117
  v_cvt_f32_i32 v118, v118
  v_cvt_f32_i32 v119, v119
  v_pk_add_f32 v[116:117], v[116:117], v[16:17] neg_lo:[0,1] neg_hi:[0,1]
  v_pk_add_f32 v[118:119], v[118:119], v[18:19] neg_lo:[0,1] neg_hi:[0,1]
  v_cvt_pk_bf16_f32 v210, v112, v116
  v_cvt_pk_bf16_f32 v214, v113, v117
  v_cvt_pk_bf16_f32 v218, v114, v118
  s_add_u32 s44, s45, 258048
  buffer_load_dwordx4 v[88:91], v2, s[12:15], s44 offen
  v_cvt_pk_bf16_f32 v222, v115, v119
  v_cvt_f32_i32 v120, v120
  v_cvt_f32_i32 v121, v121
  v_cvt_f32_i32 v122, v122
  v_cvt_f32_i32 v123, v123
  v_pk_add_f32 v[120:121], v[120:121], v[16:17] neg_lo:[0,1] neg_hi:[0,1]
  v_pk_add_f32 v[122:123], v[122:123], v[18:19] neg_lo:[0,1] neg_hi:[0,1]
  v_cvt_f32_i32 v124, v124
  s_add_u32 s44, s45, 272384
  buffer_load_dwordx4 v[92:95], v2, s[12:15], s44 offen
  v_cvt_f32_i32 v125, v125
  v_cvt_f32_i32 v126, v126
  v_cvt_f32_i32 v127, v127
  v_pk_add_f32 v[124:125], v[124:125], v[16:17] neg_lo:[0,1] neg_hi:[0,1]
  v_pk_add_f32 v[126:127], v[126:127], v[18:19] neg_lo:[0,1] neg_hi:[0,1]
  v_cvt_pk_bf16_f32 v211, v120, v124
  v_cvt_pk_bf16_f32 v215, v121, v125
  v_cvt_pk_bf16_f32 v219, v122, v126
  v_cvt_pk_bf16_f32 v223, v123, v127
  s_add_u32 m0, s83, 0
  s_add_u32 s44, s64, 0
  buffer_load_dwordx4 v3, s[20:23], s44 offen lds
  s_waitcnt vmcnt(9)
  v_cvt_f32_i32 v32, v32
  v_cvt_f32_i32 v33, v33
  v_cvt_f32_i32 v34, v34
  v_cvt_f32_i32 v35, v35
  v_pk_add_f32 v[32:33], v[32:33], v[16:17] neg_lo:[0,1] neg_hi:[0,1]
  v_pk_add_f32 v[34:35], v[34:35], v[18:19] neg_lo:[0,1] neg_hi:[0,1]
  v_cvt_f32_i32 v36, v36
  s_add_u32 m0, m0, 1024
  s_add_u32 s44, s64, 7168
  buffer_load_dwordx4 v3, s[20:23], s44 offen lds
  v_cvt_f32_i32 v37, v37
  v_cvt_f32_i32 v38, v38
  v_cvt_f32_i32 v39, v39
  v_pk_add_f32 v[36:37], v[36:37], v[16:17] neg_lo:[0,1] neg_hi:[0,1]
  v_pk_add_f32 v[38:39], v[38:39], v[18:19] neg_lo:[0,1] neg_hi:[0,1]
  v_cvt_pk_bf16_f32 v224, v32, v36
  v_cvt_pk_bf16_f32 v228, v33, v37
  v_cvt_pk_bf16_f32 v232, v34, v38
  s_add_u32 m0, m0, 1024
  s_add_u32 s44, s64, 114688
  buffer_load_dwordx4 v3, s[20:23], s44 offen lds
  v_cvt_pk_bf16_f32 v236, v35, v39
  v_cvt_f32_i32 v40, v40
  v_cvt_f32_i32 v41, v41
  v_cvt_f32_i32 v42, v42
  v_cvt_f32_i32 v43, v43
  v_pk_add_f32 v[40:41], v[40:41], v[16:17] neg_lo:[0,1] neg_hi:[0,1]
  v_pk_add_f32 v[42:43], v[42:43], v[18:19] neg_lo:[0,1] neg_hi:[0,1]
  v_cvt_f32_i32 v44, v44
  s_add_u32 m0, m0, 1024
  s_add_u32 s44, s64, 121856
  buffer_load_dwordx4 v3, s[20:23], s44 offen lds
  v_cvt_f32_i32 v45, v45
  v_cvt_f32_i32 v46, v46
  v_cvt_f32_i32 v47, v47
  v_pk_add_f32 v[44:45], v[44:45], v[16:17] neg_lo:[0,1] neg_hi:[0,1]
  v_pk_add_f32 v[46:47], v[46:47], v[18:19] neg_lo:[0,1] neg_hi:[0,1]
  v_cvt_pk_bf16_f32 v225, v40, v44
  v_cvt_pk_bf16_f32 v229, v41, v45
  v_cvt_pk_bf16_f32 v233, v42, v46
  s_add_u32 m0, m0, 1024
  s_add_u32 s44, s64, 229376
  buffer_load_dwordx4 v3, s[20:23], s44 offen lds
  v_cvt_pk_bf16_f32 v237, v43, v47
  v_cvt_f32_i32 v48, v48
  v_cvt_f32_i32 v49, v49
  v_cvt_f32_i32 v50, v50
  v_cvt_f32_i32 v51, v51
  v_pk_add_f32 v[48:49], v[48:49], v[16:17] neg_lo:[0,1] neg_hi:[0,1]
  v_pk_add_f32 v[50:51], v[50:51], v[18:19] neg_lo:[0,1] neg_hi:[0,1]
  v_cvt_f32_i32 v52, v52
  s_add_u32 m0, m0, 1024
  s_add_u32 s44, s64, 236544
  buffer_load_dwordx4 v3, s[20:23], s44 offen lds
  v_cvt_f32_i32 v53, v53
  v_cvt_f32_i32 v54, v54
  v_cvt_f32_i32 v55, v55
  v_pk_add_f32 v[52:53], v[52:53], v[16:17] neg_lo:[0,1] neg_hi:[0,1]
  v_pk_add_f32 v[54:55], v[54:55], v[18:19] neg_lo:[0,1] neg_hi:[0,1]
  v_cvt_pk_bf16_f32 v226, v48, v52
  v_cvt_pk_bf16_f32 v230, v49, v53
  v_cvt_pk_bf16_f32 v234, v50, v54
  s_add_u32 m0, m0, 1024
  s_add_u32 s44, s64, 344064
  buffer_load_dwordx4 v3, s[20:23], s44 offen lds
  v_cvt_pk_bf16_f32 v238, v51, v55
  v_cvt_f32_i32 v56, v56
  v_cvt_f32_i32 v57, v57
  v_cvt_f32_i32 v58, v58
  v_cvt_f32_i32 v59, v59
  v_pk_add_f32 v[56:57], v[56:57], v[16:17] neg_lo:[0,1] neg_hi:[0,1]
  v_pk_add_f32 v[58:59], v[58:59], v[18:19] neg_lo:[0,1] neg_hi:[0,1]
  v_cvt_f32_i32 v60, v60
  s_add_u32 m0, m0, 1024
  s_add_u32 s44, s64, 351232
  buffer_load_dwordx4 v3, s[20:23], s44 offen lds
  v_cvt_f32_i32 v61, v61
  v_cvt_f32_i32 v62, v62
  v_cvt_f32_i32 v63, v63
  v_pk_add_f32 v[60:61], v[60:61], v[16:17] neg_lo:[0,1] neg_hi:[0,1]
  v_pk_add_f32 v[62:63], v[62:63], v[18:19] neg_lo:[0,1] neg_hi:[0,1]
  v_cvt_pk_bf16_f32 v227, v56, v60
  v_cvt_pk_bf16_f32 v231, v57, v61
  v_cvt_pk_bf16_f32 v235, v58, v62
  v_cvt_pk_bf16_f32 v239, v59, v63
  s_add_u32 m0, s83, 8192
  s_add_u32 s44, s65, 0
  buffer_load_dwordx4 v3, s[20:23], s44 offen lds
  s_waitcnt vmcnt(9)
  v_cvt_f32_i32 v64, v64
  v_cvt_f32_i32 v65, v65
  v_cvt_f32_i32 v66, v66
  v_cvt_f32_i32 v67, v67
  v_pk_add_f32 v[64:65], v[64:65], v[16:17] neg_lo:[0,1] neg_hi:[0,1]
  v_pk_add_f32 v[66:67], v[66:67], v[18:19] neg_lo:[0,1] neg_hi:[0,1]
  v_cvt_f32_i32 v68, v68
  s_add_u32 m0, m0, 1024
  s_add_u32 s44, s65, 7168
  buffer_load_dwordx4 v3, s[20:23], s44 offen lds
  v_cvt_f32_i32 v69, v69
  v_cvt_f32_i32 v70, v70
  v_cvt_f32_i32 v71, v71
  v_pk_add_f32 v[68:69], v[68:69], v[16:17] neg_lo:[0,1] neg_hi:[0,1]
  v_pk_add_f32 v[70:71], v[70:71], v[18:19] neg_lo:[0,1] neg_hi:[0,1]
  v_cvt_pk_bf16_f32 v240, v64, v68
  v_cvt_pk_bf16_f32 v244, v65, v69
  v_cvt_pk_bf16_f32 v248, v66, v70
  s_add_u32 m0, m0, 1024
  s_add_u32 s44, s65, 114688
  buffer_load_dwordx4 v3, s[20:23], s44 offen lds
  v_cvt_pk_bf16_f32 v252, v67, v71
  v_cvt_f32_i32 v72, v72
  v_cvt_f32_i32 v73, v73
  v_cvt_f32_i32 v74, v74
  v_cvt_f32_i32 v75, v75
  v_pk_add_f32 v[72:73], v[72:73], v[16:17] neg_lo:[0,1] neg_hi:[0,1]
  v_pk_add_f32 v[74:75], v[74:75], v[18:19] neg_lo:[0,1] neg_hi:[0,1]
  v_cvt_f32_i32 v76, v76
  s_add_u32 m0, m0, 1024
  s_add_u32 s44, s65, 121856
  buffer_load_dwordx4 v3, s[20:23], s44 offen lds
  v_cvt_f32_i32 v77, v77
  v_cvt_f32_i32 v78, v78
  v_cvt_f32_i32 v79, v79
  v_pk_add_f32 v[76:77], v[76:77], v[16:17] neg_lo:[0,1] neg_hi:[0,1]
  v_pk_add_f32 v[78:79], v[78:79], v[18:19] neg_lo:[0,1] neg_hi:[0,1]
  v_cvt_pk_bf16_f32 v241, v72, v76
  v_cvt_pk_bf16_f32 v245, v73, v77
  v_cvt_pk_bf16_f32 v249, v74, v78
  s_add_u32 m0, m0, 1024
  s_add_u32 s44, s65, 229376
  buffer_load_dwordx4 v3, s[20:23], s44 offen lds
  v_cvt_pk_bf16_f32 v253, v75, v79
  v_cvt_f32_i32 v80, v80
  v_cvt_f32_i32 v81, v81
  v_cvt_f32_i32 v82, v82
  v_cvt_f32_i32 v83, v83
  v_pk_add_f32 v[80:81], v[80:81], v[16:17] neg_lo:[0,1] neg_hi:[0,1]
  v_pk_add_f32 v[82:83], v[82:83], v[18:19] neg_lo:[0,1] neg_hi:[0,1]
  v_cvt_f32_i32 v84, v84
  s_add_u32 m0, m0, 1024
  s_add_u32 s44, s65, 236544
  buffer_load_dwordx4 v3, s[20:23], s44 offen lds
  v_cvt_f32_i32 v85, v85
  v_cvt_f32_i32 v86, v86
  v_cvt_f32_i32 v87, v87
  v_pk_add_f32 v[84:85], v[84:85], v[16:17] neg_lo:[0,1] neg_hi:[0,1]
  v_pk_add_f32 v[86:87], v[86:87], v[18:19] neg_lo:[0,1] neg_hi:[0,1]
  v_cvt_pk_bf16_f32 v242, v80, v84
  v_cvt_pk_bf16_f32 v246, v81, v85
  v_cvt_pk_bf16_f32 v250, v82, v86
  s_add_u32 m0, m0, 1024
  s_add_u32 s44, s65, 344064
  buffer_load_dwordx4 v3, s[20:23], s44 offen lds
  v_cvt_pk_bf16_f32 v254, v83, v87
  v_cvt_f32_i32 v88, v88
  v_cvt_f32_i32 v89, v89
  v_cvt_f32_i32 v90, v90
  v_cvt_f32_i32 v91, v91
  v_pk_add_f32 v[88:89], v[88:89], v[16:17] neg_lo:[0,1] neg_hi:[0,1]
  v_pk_add_f32 v[90:91], v[90:91], v[18:19] neg_lo:[0,1] neg_hi:[0,1]
  v_cvt_f32_i32 v92, v92
  s_add_u32 m0, m0, 1024
  s_add_u32 s44, s65, 351232
  buffer_load_dwordx4 v3, s[20:23], s44 offen lds
  v_cvt_f32_i32 v93, v93
  v_cvt_f32_i32 v94, v94
  v_cvt_f32_i32 v95, v95
  v_pk_add_f32 v[92:93], v[92:93], v[16:17] neg_lo:[0,1] neg_hi:[0,1]
  v_pk_add_f32 v[94:95], v[94:95], v[18:19] neg_lo:[0,1] neg_hi:[0,1]
  v_cvt_pk_bf16_f32 v243, v88, v92
  v_cvt_pk_bf16_f32 v247, v89, v93
  v_cvt_pk_bf16_f32 v251, v90, v94
  v_cvt_pk_bf16_f32 v255, v91, v95
  s_waitcnt vmcnt(8)
  ds_read_b64_tr_b16 a[0:1], v4 offset:0
  ds_read_b64_tr_b16 a[2:3], v4 offset:1024
  ds_read_b64_tr_b16 a[4:5], v4 offset:8
  ds_read_b64_tr_b16 a[6:7], v4 offset:1032
  ds_read_b64_tr_b16 a[8:9], v5 offset:0
  ds_read_b64_tr_b16 a[10:11], v5 offset:1024
  ds_read_b64_tr_b16 a[12:13], v5 offset:8
  ds_read_b64_tr_b16 a[14:15], v5 offset:1032
  ds_read_b64_tr_b16 a[16:17], v6 offset:0
  ds_read_b64_tr_b16 a[18:19], v6 offset:1024
  ds_read_b64_tr_b16 a[20:21], v6 offset:8
  ds_read_b64_tr_b16 a[22:23], v6 offset:1032
  ds_read_b64_tr_b16 a[24:25], v7 offset:0
  ds_read_b64_tr_b16 a[26:27], v7 offset:1024
  ds_read_b64_tr_b16 a[28:29], v7 offset:8
  ds_read_b64_tr_b16 a[30:31], v7 offset:1032
  v_cmp_ne_u32 s[50:51], 0, v14
  v_readfirstlane_b32 s48, v14
  s_or_b32 s50, s50, -2
  s_cmp_eq_u64 s[50:51], -1
  s_cbranch_scc0 L_aslow_5
L_aok_4:
  v_mov_b32 v13, s48
  v_and_b32 v24, 0xffff0000, v20
  v_lshlrev_b32 v20, 16, v20
  v_and_b32 v25, 0xffff0000, v21
  v_lshlrev_b32 v21, 16, v21
  v_and_b32 v26, 0xffff0000, v22
  v_lshlrev_b32 v22, 16, v22
  v_and_b32 v27, 0xffff0000, v23
  v_lshlrev_b32 v23, 16, v23
  s_and_b32 s56, s48, 0xff
  s_bfe_u32 s57, s48, 0x80008
  s_bfe_u32 s58, s48, 0x80010
  s_lshr_b32 s59, s48, 24
  s_add_u32 s6, s49, 0
  s_and_b32 s6, s6, 3
  s_lshl_b32 s7, s61, 2
  s_add_u32 s6, s6, s7
  s_lshl_b32 s6, s6, 15
  s_lshl_b32 s7, s3, 13
  s_add_u32 s6, s6, s7
  s_add_u32 s6, s6, 1048576
  v_add_u32 v30, s6, v8
  buffer_load_dwordx4 a[96:99], v30, s[24:27], s8 offen sc1
  buffer_load_dwordx4 a[100:103], v30, s[24:27], s9 offen sc1
  buffer_load_dwordx4 a[104:107], v30, s[24:27], s10 offen sc1
  buffer_load_dwordx4 a[108:111], v30, s[24:27], s11 offen sc1
  buffer_load_dwordx4 a[112:115], v30, s[24:27], s16 offen sc1
  buffer_load_dwordx4 a[116:119], v30, s[24:27], s17 offen sc1
  buffer_load_dwordx4 a[120:123], v30, s[24:27], s18 offen sc1
  buffer_load_dwordx4 a[124:127], v30, s[24:27], s19 offen sc1
  s_add_u32 s6, s49, 1
  s_and_b32 s6, s6, 3
  s_lshl_b32 s7, s61, 2
  s_add_u32 s6, s6, s7
  s_lshl_b32 s6, s6, 15
  s_lshl_b32 s7, s3, 13
  s_add_u32 s6, s6, s7
  s_add_u32 s6, s6, 1048576
  v_add_u32 v30, s6, v8
  buffer_load_dwordx4 a[128:131], v30, s[24:27], s8 offen sc1
  buffer_load_dwordx4 a[132:135], v30, s[24:27], s9 offen sc1
  buffer_load_dwordx4 a[136:139], v30, s[24:27], s10 offen sc1
  buffer_load_dwordx4 a[140:143], v30, s[24:27], s11 offen sc1
  buffer_load_dwordx4 a[144:147], v30, s[24:27], s16 offen sc1
  buffer_load_dwordx4 a[148:151], v30, s[24:27], s17 offen sc1
  buffer_load_dwordx4 a[152:155], v30, s[24:27], s18 offen sc1
  buffer_load_dwordx4 a[156:159], v30, s[24:27], s19 offen sc1
  s_waitcnt vmcnt(16)
  ds_read_b64_tr_b16 a[32:33], v4 offset:8192
  ds_read_b64_tr_b16 a[34:35], v4 offset:9216
  ds_read_b64_tr_b16 a[36:37], v4 offset:8200
  ds_read_b64_tr_b16 a[38:39], v4 offset:9224
  ds_read_b64_tr_b16 a[40:41], v5 offset:8192
  ds_read_b64_tr_b16 a[42:43], v5 offset:9216
  ds_read_b64_tr_b16 a[44:45], v5 offset:8200
  ds_read_b64_tr_b16 a[46:47], v5 offset:9224
  ds_read_b64_tr_b16 a[48:49], v6 offset:8192
  ds_read_b64_tr_b16 a[50:51], v6 offset:9216
  ds_read_b64_tr_b16 a[52:53], v6 offset:8200
  ds_read_b64_tr_b16 a[54:55], v6 offset:9224
  ds_read_b64_tr_b16 a[56:57], v7 offset:8192
  ds_read_b64_tr_b16 a[58:59], v7 offset:9216
  ds_read_b64_tr_b16 a[60:61], v7 offset:8200
  ds_read_b64_tr_b16 a[62:63], v7 offset:9224
  s_waitcnt vmcnt(8)
  v_mfma_f32_16x16x32_bf16 a[224:227], v[128:131], a[96:99], 0
  s_add_u32 s6, s49, 2
  s_and_b32 s6, s6, 3
  s_lshl_b32 s7, s61, 2
  s_add_u32 s6, s6, s7
  s_lshl_b32 s6, s6, 15
  s_lshl_b32 s7, s3, 13
  s_add_u32 s6, s6, s7
  s_add_u32 s6, s6, 1048576
  v_add_u32 v30, s6, v8
  buffer_load_dwordx4 a[160:163], v30, s[24:27], s8 offen sc1
  v_mfma_f32_16x16x32_bf16 a[224:227], v[144:147], a[100:103], a[224:227]
  v_mfma_f32_16x16x32_bf16 a[224:227], v[160:163], a[104:107], a[224:227]
  v_mfma_f32_16x16x32_bf16 a[224:227], v[176:179], a[108:111], a[224:227]
  buffer_load_dwordx4 a[164:167], v30, s[24:27], s9 offen sc1
  v_mfma_f32_16x16x32_bf16 a[224:227], v[192:195], a[112:115], a[224:227]
  v_mfma_f32_16x16x32_bf16 a[224:227], v[208:211], a[116:119], a[224:227]
  v_mfma_f32_16x16x32_bf16 a[224:227], v[224:227], a[120:123], a[224:227]
  buffer_load_dwordx4 a[168:171], v30, s[24:27], s10 offen sc1
  v_mfma_f32_16x16x32_bf16 a[224:227], v[240:243], a[124:127], a[224:227]
  v_mfma_f32_16x16x32_bf16 a[228:231], v[132:135], a[96:99], 0
  v_mfma_f32_16x16x32_bf16 a[228:231], v[148:151], a[100:103], a[228:231]
  v_mfma_f32_16x16x32_bf16 a[228:231], v[164:167], a[104:107], a[228:231]
  v_mfma_f32_16x16x32_bf16 a[228:231], v[180:183], a[108:111], a[228:231]
  buffer_load_dwordx4 a[172:175], v30, s[24:27], s11 offen sc1
  v_mfma_f32_16x16x32_bf16 a[228:231], v[196:199], a[112:115], a[228:231]
  v_mfma_f32_16x16x32_bf16 a[228:231], v[212:215], a[116:119], a[228:231]
  v_mfma_f32_16x16x32_bf16 a[228:231], v[228:231], a[120:123], a[228:231]
  buffer_load_dwordx4 a[176:179], v30, s[24:27], s16 offen sc1
  v_mfma_f32_16x16x32_bf16 a[228:231], v[244:247], a[124:127], a[228:231]
  v_accvgpr_read_b32 v32, a224
  v_cmp_u_f32 vcc, v32, v32
  s_cbranch_vccnz L_xslow_7
L_xok_6:
  ds_write_b128 v9, a[224:227] offset:0
  v_mfma_f32_16x16x32_bf16 a[232:235], v[136:139], a[96:99], 0
  v_mfma_f32_16x16x32_bf16 a[232:235], v[152:155], a[100:103], a[232:235]
  v_mfma_f32_16x16x32_bf16 a[232:235], v[168:171], a[104:107], a[232:235]
  buffer_load_dwordx4 a[180:183], v30, s[24:27], s17 offen sc1
  v_mfma_f32_16x16x32_bf16 a[232:235], v[184:187], a[108:111], a[232:235]
  v_mfma_f32_16x16x32_bf16 a[232:235], v[200:203], a[112:115], a[232:235]
  v_mfma_f32_16x16x32_bf16 a[232:235], v[216:219], a[116:119], a[232:235]
  buffer_load_dwordx4 a[184:187], v30, s[24:27], s18 offen sc1
  v_mfma_f32_16x16x32_bf16 a[232:235], v[232:235], a[120:123], a[232:235]
  v_mfma_f32_16x16x32_bf16 a[232:235], v[248:251], a[124:127], a[232:235]
  ds_write_b128 v9, a[228:231] offset:1024
  v_mfma_f32_16x16x32_bf16 a[236:239], v[140:143], a[96:99], 0
  v_mfma_f32_16x16x32_bf16 a[236:239], v[156:159], a[100:103], a[236:239]
  buffer_load_dwordx4 a[188:191], v30, s[24:27], s19 offen sc1
  v_mfma_f32_16x16x32_bf16 a[236:239], v[172:175], a[104:107], a[236:239]
  v_mfma_f32_16x16x32_bf16 a[236:239], v[188:191], a[108:111], a[236:239]
  v_mfma_f32_16x16x32_bf16 a[236:239], v[204:207], a[112:115], a[236:239]
  v_mfma_f32_16x16x32_bf16 a[236:239], v[220:223], a[116:119], a[236:239]
  v_mfma_f32_16x16x32_bf16 a[236:239], v[236:239], a[120:123], a[236:239]
  v_mfma_f32_16x16x32_bf16 a[236:239], v[252:255], a[124:127], a[236:239]
  ds_write_b128 v9, a[232:235] offset:2048
  s_waitcnt vmcnt(8)
  v_mfma_f32_16x16x32_bf16 a[240:243], v[128:131], a[128:131], 0
  s_add_u32 s6, s49, 3
  s_and_b32 s6, s6, 3
  s_lshl_b32 s7, s61, 2
  s_add_u32 s6, s6, s7
  s_lshl_b32 s6, s6, 15
  s_lshl_b32 s7, s3, 13
  s_add_u32 s6, s6, s7
  s_add_u32 s6, s6, 1048576
  v_add_u32 v30, s6, v8
  buffer_load_dwordx4 a[192:195], v30, s[24:27], s8 offen sc1
  v_mfma_f32_16x16x32_bf16 a[240:243], v[144:147], a[132:135], a[240:243]
  v_mfma_f32_16x16x32_bf16 a[240:243], v[160:163], a[136:139], a[240:243]
  v_mfma_f32_16x16x32_bf16 a[240:243], v[176:179], a[140:143], a[240:243]
  buffer_load_dwordx4 a[196:199], v30, s[24:27], s9 offen sc1
  v_mfma_f32_16x16x32_bf16 a[240:243], v[192:195], a[144:147], a[240:243]
  v_mfma_f32_16x16x32_bf16 a[240:243], v[208:211], a[148:151], a[240:243]
  v_mfma_f32_16x16x32_bf16 a[240:243], v[224:227], a[152:155], a[240:243]
  buffer_load_dwordx4 a[200:203], v30, s[24:27], s10 offen sc1
  v_mfma_f32_16x16x32_bf16 a[240:243], v[240:243], a[156:159], a[240:243]
  ds_write_b128 v9, a[236:239] offset:3072
  v_mfma_f32_16x16x32_bf16 a[244:247], v[132:135], a[128:131], 0
  v_mfma_f32_16x16x32_bf16 a[244:247], v[148:151], a[132:135], a[244:247]
  v_mfma_f32_16x16x32_bf16 a[244:247], v[164:167], a[136:139], a[244:247]
  v_mfma_f32_16x16x32_bf16 a[244:247], v[180:183], a[140:143], a[244:247]
  buffer_load_dwordx4 a[204:207], v30, s[24:27], s11 offen sc1
  v_mfma_f32_16x16x32_bf16 a[244:247], v[196:199], a[144:147], a[244:247]
  v_mfma_f32_16x16x32_bf16 a[244:247], v[212:215], a[148:151], a[244:247]
  v_mfma_f32_16x16x32_bf16 a[244:247], v[228:231], a[152:155], a[244:247]
  buffer_load_dwordx4 a[208:211], v30, s[24:27], s16 offen sc1
  v_mfma_f32_16x16x32_bf16 a[244:247], v[244:247], a[156:159], a[244:247]
  v_accvgpr_read_b32 v32, a240
  v_cmp_u_f32 vcc, v32, v32
  s_cbranch_vccnz L_xslow_11
L_xok_10:
  ds_write_b128 v9, a[240:243] offset:4096
  v_mfma_f32_16x16x32_bf16 a[248:251], v[136:139], a[128:131], 0
  v_mfma_f32_16x16x32_bf16 a[248:251], v[152:155], a[132:135], a[248:251]
  v_mfma_f32_16x16x32_bf16 a[248:251], v[168:171], a[136:139], a[248:251]
  buffer_load_dwordx4 a[212:215], v30, s[24:27], s17 offen sc1
  v_mfma_f32_16x16x32_bf16 a[248:251], v[184:187], a[140:143], a[248:251]
  v_mfma_f32_16x16x32_bf16 a[248:251], v[200:203], a[144:147], a[248:251]
  v_mfma_f32_16x16x32_bf16 a[248:251], v[216:219], a[148:151], a[248:251]
  buffer_load_dwordx4 a[216:219], v30, s[24:27], s18 offen sc1
  v_mfma_f32_16x16x32_bf16 a[248:251], v[232:235], a[152:155], a[248:251]
  v_mfma_f32_16x16x32_bf16 a[248:251], v[248:251], a[156:159], a[248:251]
  ds_write_b128 v9, a[244:247] offset:5120
  v_mfma_f32_16x16x32_bf16 a[252:255], v[140:143], a[128:131], 0
  v_mfma_f32_16x16x32_bf16 a[252:255], v[156:159], a[132:135], a[252:255]
  buffer_load_dwordx4 a[220:223], v30, s[24:27], s19 offen sc1
  v_mfma_f32_16x16x32_bf16 a[252:255], v[172:175], a[136:139], a[252:255]
  v_mfma_f32_16x16x32_bf16 a[252:255], v[188:191], a[140:143], a[252:255]
  v_mfma_f32_16x16x32_bf16 a[252:255], v[204:207], a[144:147], a[252:255]
  v_mfma_f32_16x16x32_bf16 a[252:255], v[220:223], a[148:151], a[252:255]
  v_mfma_f32_16x16x32_bf16 a[252:255], v[236:239], a[152:155], a[252:255]
  v_mfma_f32_16x16x32_bf16 a[252:255], v[252:255], a[156:159], a[252:255]
  ds_write_b128 v9, a[248:251] offset:6144
  s_waitcnt vmcnt(8)
  v_mfma_f32_16x16x32_bf16 a[224:227], v[128:131], a[160:163], 0
  s_add_u32 m0, s83, 16384
  s_add_u32 s44, s66, 0
  buffer_load_dwordx4 v3, s[20:23], s44 offen lds
  v_mfma_f32_16x16x32_bf16 a[224:227], v[144:147], a[164:167], a[224:227]
  v_mfma_f32_16x16x32_bf16 a[224:227], v[160:163], a[168:171], a[224:227]
  v_mfma_f32_16x16x32_bf16 a[224:227], v[176:179], a[172:175], a[224:227]
  s_add_u32 m0, m0, 1024
  s_add_u32 s44, s66, 7168
  buffer_load_dwordx4 v3, s[20:23], s44 offen lds
  v_mfma_f32_16x16x32_bf16 a[224:227], v[192:195], a[176:179], a[224:227]
  v_mfma_f32_16x16x32_bf16 a[224:227], v[208:211], a[180:183], a[224:227]
  v_mfma_f32_16x16x32_bf16 a[224:227], v[224:227], a[184:187], a[224:227]
  s_add_u32 m0, m0, 1024
  s_add_u32 s44, s66, 114688
  buffer_load_dwordx4 v3, s[20:23], s44 offen lds
  v_mfma_f32_16x16x32_bf16 a[224:227], v[240:243], a[188:191], a[224:227]
  ds_write_b128 v9, a[252:255] offset:7168
  v_mfma_f32_16x16x32_bf16 a[228:231], v[132:135], a[160:163], 0
  v_mfma_f32_16x16x32_bf16 a[228:231], v[148:151], a[164:167], a[228:231]
  s_waitcnt lgkmcnt(0)
  s_barrier
  v_mfma_f32_16x16x32_bf16 a[228:231], v[164:167], a[168:171], a[228:231]
  ds_read_b128 v[96:99], v10 offset:0
  ds_read_b128 v[100:103], v10 offset:1024
  v_mfma_f32_16x16x32_bf16 a[228:231], v[180:183], a[172:175], a[228:231]
  s_add_u32 m0, m0, 1024
  s_add_u32 s44, s66, 121856
  buffer_load_dwordx4 v3, s[20:23], s44 offen lds
  ds_read_b128 v[104:107], v10 offset:8192
  ds_read_b128 v[108:111], v10 offset:9216
  v_mfma_f32_16x16x32_bf16 a[228:231], v[196:199], a[176:179], a[228:231]
  ds_read_b128 v[112:115], v10 offset:16384
  ds_read_b128 v[116:119], v10 offset:17408
  v_mfma_f32_16x16x32_bf16 a[228:231], v[212:215], a[180:183], a[228:231]
  ds_read_b128 v[120:123], v10 offset:24576
  ds_read_b128 v[124:127], v10 offset:25600
  v_mfma_f32_16x16x32_bf16 a[228:231], v[228:231], a[184:187], a[228:231]
  s_add_u32 m0, m0, 1024
  s_add_u32 s44, s66, 229376
  buffer_load_dwordx4 v3, s[20:23], s44 offen lds
  v_mfma_f32_16x16x32_bf16 a[228:231], v[244:247], a[188:191], a[228:231]
  v_accvgpr_read_b32 v32, a224
  v_cmp_u_f32 vcc, v32, v32
  s_cbranch_vccnz L_xslow_15
L_xok_14:
  ds_write_b128 v9, a[224:227] offset:32768
  v_mfma_f32_16x16x32_bf16 a[232:235], v[136:139], a[160:163], 0
  s_waitcnt lgkmcnt(5)
  v_add_f32 v96, v96, v104
  v_add_f32 v97, v97, v105
  v_mfma_f32_16x16x32_bf16 a[232:235], v[152:155], a[164:167], a[232:235]
  v_add_f32 v98, v98, v106
  v_add_f32 v99, v99, v107
  v_add_f32 v100, v100, v108
  v_mfma_f32_16x16x32_bf16 a[232:235], v[168:171], a[168:171], a[232:235]
  s_add_u32 m0, m0, 1024
  s_add_u32 s44, s66, 236544
  buffer_load_dwordx4 v3, s[20:23], s44 offen lds
  v_add_f32 v101, v101, v109
  v_add_f32 v102, v102, v110
  v_add_f32 v103, v103, v111
  v_mfma_f32_16x16x32_bf16 a[232:235], v[184:187], a[172:175], a[232:235]
  s_waitcnt lgkmcnt(1)
  v_add_f32 v112, v112, v120
  v_add_f32 v113, v113, v121
  v_mfma_f32_16x16x32_bf16 a[232:235], v[200:203], a[176:179], a[232:235]
  v_add_f32 v114, v114, v122
  v_add_f32 v115, v115, v123
  v_add_f32 v116, v116, v124
  v_mfma_f32_16x16x32_bf16 a[232:235], v[216:219], a[180:183], a[232:235]
  s_add_u32 m0, m0, 1024
  s_add_u32 s44, s66, 344064
  buffer_load_dwordx4 v3, s[20:23], s44 offen lds
  v_add_f32 v117, v117, v125
  v_add_f32 v118, v118, v126
  v_add_f32 v119, v119, v127
  v_mfma_f32_16x16x32_bf16 a[232:235], v[232:235], a[184:187], a[232:235]
  v_add_f32 v96, v96, v112
  v_add_f32 v97, v97, v113
  v_add_f32 v98, v98, v114
  v_mfma_f32_16x16x32_bf16 a[232:235], v[248:251], a[188:191], a[232:235]
  ds_write_b128 v9, a[228:231] offset:33792
  v_add_f32 v99, v99, v115
  v_add_f32 v100, v100, v116
  v_add_f32 v101, v101, v117
  v_mfma_f32_16x16x32_bf16 a[236:239], v[140:143], a[160:163], 0
  v_add_f32 v102, v102, v118
  v_add_f32 v103, v103, v119
  v_mul_f32 v96, v96, v20
  v_mfma_f32_16x16x32_bf16 a[236:239], v[156:159], a[164:167], a[236:239]
  s_add_u32 m0, m0, 1024
  s_add_u32 s44, s66, 351232
  buffer_load_dwordx4 v3, s[20:23], s44 offen lds
  v_mul_f32 v97, v97, v21
  v_mul_f32 v98, v98, v22
  v_mul_f32 v99, v99, v23
  v_mfma_f32_16x16x32_bf16 a[236:239], v[172:175], a[168:171], a[236:239]
  v_mul_f32 v100, v100, v24
  v_mul_f32 v101, v101, v25
  v_mul_f32 v102, v102, v26
  v_mfma_f32_16x16x32_bf16 a[236:239], v[188:191], a[172:175], a[236:239]
  v_mul_f32 v103, v103, v27
  v_cvt_pk_bf16_f32 v104, v96, v97
  v_cvt_pk_bf16_f32 v105, v98, v99
  v_mfma_f32_16x16x32_bf16 a[236:239], v[204:207], a[176:179], a[236:239]
  v_cvt_pk_bf16_f32 v106, v100, v101
  v_cvt_pk_bf16_f32 v107, v102, v103
  s_lshr_b32 s6, s3, 1
  s_add_u32 s6, s6, s49
  s_add_u32 s6, s6, 0
  s_and_b32 s6, s6, 3
  s_lshl_b32 s7, s61, 2
  s_add_u32 s6, s6, s7
  s_lshr_b32 s7, s6, 1
  s_lshl_b32 s7, s7, 7
  s_and_b32 s44, s6, 1
  s_lshl_b32 s44, s44, 3
  s_add_u32 s7, s7, s44
  v_writelane_b32 v31, s7, 0
  s_mul_i32 s6, s6, 112
  s_lshl_b32 s7, s60, 1
  s_add_u32 s6, s6, s7
  s_and_b32 s7, s3, 1
  s_add_u32 s6, s6, s7
  s_lshl_b32 s6, s6, 10
  s_add_u32 s6, s6, 2097152
  buffer_store_dwordx4 v[104:107], v8, s[24:27], s6 offen sc1
  v_mfma_f32_16x16x32_bf16 a[236:239], v[220:223], a[180:183], a[236:239]
  v_mfma_f32_16x16x32_bf16 a[236:239], v[236:239], a[184:187], a[236:239]
  v_mfma_f32_16x16x32_bf16 a[236:239], v[252:255], a[188:191], a[236:239]
  ds_write_b128 v9, a[232:235] offset:34816
  s_waitcnt vmcnt(9)
  v_mfma_f32_16x16x32_bf16 a[240:243], v[128:131], a[192:195], 0
  s_add_u32 m0, s83, 0
  s_add_u32 s44, s67, 0
  buffer_load_dwordx4 v3, s[20:23], s44 offen lds
  v_mfma_f32_16x16x32_bf16 a[240:243], v[144:147], a[196:199], a[240:243]
  v_mfma_f32_16x16x32_bf16 a[240:243], v[160:163], a[200:203], a[240:243]
  v_mfma_f32_16x16x32_bf16 a[240:243], v[176:179], a[204:207], a[240:243]
  s_add_u32 m0, m0, 1024
  s_add_u32 s44, s67, 7168
  buffer_load_dwordx4 v3, s[20:23], s44 offen lds
  v_mfma_f32_16x16x32_bf16 a[240:243], v[192:195], a[208:211], a[240:243]
  v_mfma_f32_16x16x32_bf16 a[240:243], v[208:211], a[212:215], a[240:243]
  v_mfma_f32_16x16x32_bf16 a[240:243], v[224:227], a[216:219], a[240:243]
  s_add_u32 m0, m0, 1024
  s_add_u32 s44, s67, 114688
  buffer_load_dwordx4 v3, s[20:23], s44 offen lds
  v_mfma_f32_16x16x32_bf16 a[240:243], v[240:243], a[220:223], a[240:243]
  ds_write_b128 v9, a[236:239] offset:35840
  v_mfma_f32_16x16x32_bf16 a[244:247], v[132:135], a[192:195], 0
  v_mfma_f32_16x16x32_bf16 a[244:247], v[148:151], a[196:199], a[244:247]
  v_mfma_f32_16x16x32_bf16 a[244:247], v[164:167], a[200:203], a[244:247]
  v_mfma_f32_16x16x32_bf16 a[244:247], v[180:183], a[204:207], a[244:247]
  s_add_u32 m0, m0, 1024
  s_add_u32 s44, s67, 121856
  buffer_load_dwordx4 v3, s[20:23], s44 offen lds
  v_mfma_f32_16x16x32_bf16 a[244:247], v[196:199], a[208:211], a[244:247]
  v_mfma_f32_16x16x32_bf16 a[244:247], v[212:215], a[212:215], a[244:247]
  v_mfma_f32_16x16x32_bf16 a[244:247], v[228:231], a[216:219], a[244:247]
  s_add_u32 m0, m0, 1024
  s_add_u32 s44, s67, 229376
  buffer_load_dwordx4 v3, s[20:23], s44 offen lds
  v_mfma_f32_16x16x32_bf16 a[244:247], v[244:247], a[220:223], a[244:247]
  v_accvgpr_read_b32 v32, a240
  v_cmp_u_f32 vcc, v32, v32
  s_cbranch_vccnz L_xslow_19
L_xok_18:
  ds_write_b128 v9, a[240:243] offset:36864
  v_mfma_f32_16x16x32_bf16 a[248:251], v[136:139], a[192:195], 0
  v_mfma_f32_16x16x32_bf16 a[248:251], v[152:155], a[196:199], a[248:251]
  v_mfma_f32_16x16x32_bf16 a[248:251], v[168:171], a[200:203], a[248:251]
  s_add_u32 m0, m0, 1024
  s_add_u32 s44, s67, 236544
  buffer_load_dwordx4 v3, s[20:23], s44 offen lds
  v_mfma_f32_16x16x32_bf16 a[248:251], v[184:187], a[204:207], a[248:251]
  v_mfma_f32_16x16x32_bf16 a[248:251], v[200:203], a[208:211], a[248:251]
  v_mfma_f32_16x16x32_bf16 a[248:251], v[216:219], a[212:215], a[248:251]
  s_add_u32 m0, m0, 1024
  s_add_u32 s44, s67, 344064
  buffer_load_dwordx4 v3, s[20:23], s44 offen lds
  v_mfma_f32_16x16x32_bf16 a[248:251], v[232:235], a[216:219], a[248:251]
  v_mfma_f32_16x16x32_bf16 a[248:251], v[248:251], a[220:223], a[248:251]
  ds_write_b128 v9, a[244:247] offset:37888
  v_mfma_f32_16x16x32_bf16 a[252:255], v[140:143], a[192:195], 0
  v_mfma_f32_16x16x32_bf16 a[252:255], v[156:159], a[196:199], a[252:255]
  s_add_u32 m0, m0, 1024
  s_add_u32 s44, s67, 351232
  buffer_load_dwordx4 v3, s[20:23], s44 offen lds
  v_mfma_f32_16x16x32_bf16 a[252:255], v[172:175], a[200:203], a[252:255]
  v_mfma_f32_16x16x32_bf16 a[252:255], v[188:191], a[204:207], a[252:255]
  v_mfma_f32_16x16x32_bf16 a[252:255], v[204:207], a[208:211], a[252:255]
  v_mfma_f32_16x16x32_bf16 a[252:255], v[220:223], a[212:215], a[252:255]
  v_mfma_f32_16x16x32_bf16 a[252:255], v[236:239], a[216:219], a[252:255]
  v_mfma_f32_16x16x32_bf16 a[252:255], v[252:255], a[220:223], a[252:255]
  ds_write_b128 v9, a[248:251] offset:38912
  s_nop 7
  ds_write_b128 v9, a[252:255] offset:39936
  s_waitcnt lgkmcnt(0)
  s_barrier
  ds_read_b128 v[96:99], v10 offset:32768
  ds_read_b128 v[100:103], v10 offset:33792
  ds_read_b128 v[104:107], v10 offset:40960
  ds_read_b128 v[108:111], v10 offset:41984
  ds_read_b128 v[112:115], v10 offset:49152
  ds_read_b128 v[116:119], v10 offset:50176
  ds_read_b128 v[120:123], v10 offset:57344
  ds_read_b128 v[124:127], v10 offset:58368
  s_waitcnt lgkmcnt(4)
  v_add_f32 v96, v96, v104
  v_add_f32 v97, v97, v105
  v_add_f32 v98, v98, v106
  v_add_f32 v99, v99, v107
  v_add_f32 v100, v100, v108
  v_add_f32 v101, v101, v109
  v_add_f32 v102, v102, v110
  v_add_f32 v103, v103, v111
  s_waitcnt lgkmcnt(0)
  v_add_f32 v112, v112, v120
  v_add_f32 v113, v113, v121
  v_add_f32 v114, v114, v122
  v_add_f32 v115, v115, v123
  v_add_f32 v116, v116, v124
  v_add_f32 v117, v117, v125
  v_add_f32 v118, v118, v126
  v_add_f32 v119, v119, v127
  v_add_f32 v96, v96, v112
  v_add_f32 v97, v97, v113
  v_add_f32 v98, v98, v114
  v_add_f32 v99, v99, v115
  v_add_f32 v100, v100, v116
  v_add_f32 v101, v101, v117
  v_add_f32 v102, v102, v118
  v_add_f32 v103, v103, v119
  v_mul_f32 v96, v96, v20
  v_mul_f32 v97, v97, v21
  v_mul_f32 v98, v98, v22
  v_mul_f32 v99, v99, v23
  v_mul_f32 v100, v100, v24
  v_mul_f32 v101, v101, v25
  v_mul_f32 v102, v102, v26
  v_mul_f32 v103, v103, v27
  v_cvt_pk_bf16_f32 v104, v96, v97
  v_cvt_pk_bf16_f32 v105, v98, v99
  v_cvt_pk_bf16_f32 v106, v100, v101
  v_cvt_pk_bf16_f32 v107, v102, v103
  s_lshr_b32 s6, s3, 1
  s_add_u32 s6, s6, s49
  s_add_u32 s6, s6, 2
  s_and_b32 s6, s6, 3
  s_lshl_b32 s7, s61, 2
  s_add_u32 s6, s6, s7
  s_lshr_b32 s7, s6, 1
  s_lshl_b32 s7, s7, 7
  s_and_b32 s44, s6, 1
  s_lshl_b32 s44, s44, 3
  s_add_u32 s7, s7, s44
  v_writelane_b32 v31, s7, 1
  s_mul_i32 s6, s6, 112
  s_lshl_b32 s7, s60, 1
  s_add_u32 s6, s6, s7
  s_and_b32 s7, s3, 1
  s_add_u32 s6, s6, s7
  s_lshl_b32 s6, s6, 10
  s_add_u32 s6, s6, 2097152
  buffer_store_dwordx4 v[104:107], v8, s[24:27], s6 offen sc1
  s_sub_u32 s6, s3, 1
  s_and_b32 s6, s6, 3
  s_lshl_b32 s6, s6, 13
  s_add_u32 s6, s6, 98304
  v_add_u32 v16, s6, v8
  s_sub_u32 s6, s3, 2
  s_and_b32 s6, s6, 3
  s_lshl_b32 s6, s6, 13
  s_add_u32 s6, s6, 100352
  v_add_u32 v17, s6, v8
  s_sub_u32 s6, s3, 3
  s_and_b32 s6, s6, 3
  s_lshl_b32 s6, s6, 13
  s_add_u32 s6, s6, 102400
  v_add_u32 v18, s6, v8
  s_lshl_b32 s7, s62, 15
  s_add_u32 s7, s7, s92
  s_add_u32 s6, s62, 1
  s_and_b32 s6, s6, 3
  s_lshl_b32 s6, s6, 13
  s_add_u32 s8, s6, s7
  s_add_u32 s16, s8, 131072
  s_add_u32 s6, s62, 2
  s_and_b32 s6, s6, 3
  s_lshl_b32 s6, s6, 13
  s_add_u32 s9, s6, s7
  s_add_u32 s17, s9, 131072
  s_add_u32 s6, s62, 3
  s_and_b32 s6, s6, 3
  s_lshl_b32 s6, s6, 13
  s_add_u32 s10, s6, s7
  s_add_u32 s18, s10, 131072
  s_add_u32 m0, s83, 8192
  s_add_u32 s44, s68, 0
  buffer_load_dwordx4 v3, s[20:23], s44 offen lds
  s_waitcnt vmcnt(11)
  ds_read_b64_tr_b16 a[64:65], v4 offset:16384
  s_add_u32 m0, m0, 1024
  s_add_u32 s44, s68, 7168
  buffer_load_dwordx4 v3, s[20:23], s44 offen lds
  ds_read_b64_tr_b16 a[66:67], v4 offset:17408
  ds_read_b64_tr_b16 a[68:69], v4 offset:16392
  s_add_u32 m0, m0, 1024
  s_add_u32 s44, s68, 114688
  buffer_load_dwordx4 v3, s[20:23], s44 offen lds
  ds_read_b64_tr_b16 a[70:71], v4 offset:17416
  ds_read_b64_tr_b16 a[72:73], v5 offset:16384
  s_add_u32 m0, m0, 1024
  s_add_u32 s44, s68, 121856
  buffer_load_dwordx4 v3, s[20:23], s44 offen lds
  ds_read_b64_tr_b16 a[74:75], v5 offset:17408
  ds_read_b64_tr_b16 a[76:77], v5 offset:16392
  s_add_u32 m0, m0, 1024
  s_add_u32 s44, s68, 229376
  buffer_load_dwordx4 v3, s[20:23], s44 offen lds
  ds_read_b64_tr_b16 a[78:79], v5 offset:17416
  ds_read_b64_tr_b16 a[80:81], v6 offset:16384
  s_add_u32 m0, m0, 1024
  s_add_u32 s44, s68, 236544
  buffer_load_dwordx4 v3, s[20:23], s44 offen lds
  ds_read_b64_tr_b16 a[82:83], v6 offset:17408
  ds_read_b64_tr_b16 a[84:85], v6 offset:16392
  s_add_u32 m0, m0, 1024
  s_add_u32 s44, s68, 344064
  buffer_load_dwordx4 v3, s[20:23], s44 offen lds
  ds_read_b64_tr_b16 a[86:87], v6 offset:17416
  ds_read_b64_tr_b16 a[88:89], v7 offset:16384
  s_add_u32 m0, m0, 1024
  s_add_u32 s44, s68, 351232
  buffer_load_dwordx4 v3, s[20:23], s44 offen lds
  ds_read_b64_tr_b16 a[90:91], v7 offset:17408
  ds_read_b64_tr_b16 a[92:93], v7 offset:16392
  ds_read_b64_tr_b16 a[94:95], v7 offset:17416
  s_waitcnt vmcnt(8)
  s_lshl_b32 s6, s60, 10
  s_and_b32 s7, s3, 1
  s_lshl_b32 s7, s7, 2
  s_add_u32 s6, s6, s7
  s_add_u32 s6, s6, 65536
  s_mov_b64 exec, 3
  buffer_store_dword v13, v31, s[24:27], s6 offen sc1
  s_mov_b64 exec, -1
  s_waitcnt lgkmcnt(0)
  s_add_u32 m0, s83, 16384
  s_add_u32 s44, s69, 0
  buffer_load_dwordx4 v3, s[20:23], s44 offen lds
  ds_read_b64_tr_b16 a[96:97], v4 offset:0
  s_add_u32 m0, m0, 1024
  s_add_u32 s44, s69, 7168
  buffer_load_dwordx4 v3, s[20:23], s44 offen lds
  ds_read_b64_tr_b16 a[98:99], v4 offset:1024
  ds_read_b64_tr_b16 a[100:101], v4 offset:8
  s_add_u32 m0, m0, 1024
  s_add_u32 s44, s69, 114688
  buffer_load_dwordx4 v3, s[20:23], s44 offen lds
  ds_read_b64_tr_b16 a[102:103], v4 offset:1032
  ds_read_b64_tr_b16 a[104:105], v5 offset:0
  s_add_u32 m0, m0, 1024
  s_add_u32 s44, s69, 121856
  buffer_load_dwordx4 v3, s[20:23], s44 offen lds
  ds_read_b64_tr_b16 a[106:107], v5 offset:1024
  ds_read_b64_tr_b16 a[108:109], v5 offset:8
  s_add_u32 m0, m0, 1024
  s_add_u32 s44, s69, 229376
  buffer_load_dwordx4 v3, s[20:23], s44 offen lds
  ds_read_b64_tr_b16 a[110:111], v5 offset:1032
  ds_read_b64_tr_b16 a[112:113], v6 offset:0
  s_add_u32 m0, m0, 1024
  s_add_u32 s44, s69, 236544
  buffer_load_dwordx4 v3, s[20:23], s44 offen lds
  ds_read_b64_tr_b16 a[114:115], v6 offset:1024
  ds_read_b64_tr_b16 a[116:117], v6 offset:8
  s_add_u32 m0, m0, 1024
  s_add_u32 s44, s69, 344064
  buffer_load_dwordx4 v3, s[20:23], s44 offen lds
  ds_read_b64_tr_b16 a[118:119], v6 offset:1032
  ds_read_b64_tr_b16 a[120:121], v7 offset:0
  s_add_u32 m0, m0, 1024
  s_add_u32 s44, s69, 351232
  buffer_load_dwordx4 v3, s[20:23], s44 offen lds
  ds_read_b64_tr_b16 a[122:123], v7 offset:1024
  ds_read_b64_tr_b16 a[124:125], v7 offset:8
  ds_read_b64_tr_b16 a[126:127], v7 offset:1032
  buffer_load_dword v14, v12, s[24:27], 0 offen sc1
  s_waitcnt lgkmcnt(0)
  s_add_u32 m0, s83, 0
  s_add_u32 s44, s70, 0
  buffer_load_dwordx4 v3, s[20:23], s44 offen lds
  s_waitcnt vmcnt(11)
  ds_read_b64_tr_b16 a[128:129], v4 offset:8192
  s_add_u32 m0, m0, 1024
  s_add_u32 s44, s70, 7168
  buffer_load_dwordx4 v3, s[20:23], s44 offen lds
  ds_read_b64_tr_b16 a[130:131], v4 offset:9216
  ds_read_b64_tr_b16 a[132:133], v4 offset:8200
  s_add_u32 m0, m0, 1024
  s_add_u32 s44, s70, 114688
  buffer_load_dwordx4 v3, s[20:23], s44 offen lds
  ds_read_b64_tr_b16 a[134:135], v4 offset:9224
  ds_read_b64_tr_b16 a[136:137], v5 offset:8192
  s_add_u32 m0, m0, 1024
  s_add_u32 s44, s70, 121856
  buffer_load_dwordx4 v3, s[20:23], s44 offen lds
  ds_read_b64_tr_b16 a[138:139], v5 offset:9216
  ds_read_b64_tr_b16 a[140:141], v5 offset:8200
  s_add_u32 m0, m0, 1024
  s_add_u32 s44, s70, 229376
  buffer_load_dwordx4 v3, s[20:23], s44 offen lds
  ds_read_b64_tr_b16 a[142:143], v5 offset:9224
  ds_read_b64_tr_b16 a[144:145], v6 offset:8192
  s_add_u32 m0, m0, 1024
  s_add_u32 s44, s70, 236544
  buffer_load_dwordx4 v3, s[20:23], s44 offen lds
  ds_read_b64_tr_b16 a[146:147], v6 offset:9216
  ds_read_b64_tr_b16 a[148:149], v6 offset:8200
  s_add_u32 m0, m0, 1024
  s_add_u32 s44, s70, 344064
  buffer_load_dwordx4 v3, s[20:23], s44 offen lds
  ds_read_b64_tr_b16 a[150:151], v6 offset:9224
  ds_read_b64_tr_b16 a[152:153], v7 offset:8192
  s_add_u32 m0, m0, 1024
  s_add_u32 s44, s70, 351232
  buffer_load_dwordx4 v3, s[20:23], s44 offen lds
  ds_read_b64_tr_b16 a[154:155], v7 offset:9216
  ds_read_b64_tr_b16 a[156:157], v7 offset:8200
  ds_read_b64_tr_b16 a[158:159], v7 offset:9224
  s_waitcnt vmcnt(8)
  v_cmp_eq_u32 s[50:51], v14, v13
  s_nop 1
  s_andn2_b32 s6, 0xff, s50
  s_cbranch_scc1 L_rslow_23
L_rok_22:
  s_mul_i32 s6, s84, 114688
  s_add_u32 s6, s6, s93
  v_add_u32 v30, s6, v8
  buffer_load_dwordx4 v[128:131], v30, s[24:27], s72 offen sc1
  buffer_load_dwordx4 v[132:135], v30, s[24:27], s73 offen sc1
  buffer_load_dwordx4 v[136:139], v30, s[24:27], s74 offen sc1
  buffer_load_dwordx4 v[140:143], v30, s[24:27], s75 offen sc1
  buffer_load_dwordx4 v[144:147], v30, s[24:27], s76 offen sc1
  buffer_load_dwordx4 v[148:151], v30, s[24:27], s77 offen sc1
  buffer_load_dwordx4 v[152:155], v30, s[24:27], s78 offen sc1
  s_andn2_b32 s6, 0xff00, s50
  s_cbranch_scc1 L_rslow_25
L_rok_24:
  s_mul_i32 s6, s85, 114688
  s_add_u32 s6, s6, s93
  v_add_u32 v30, s6, v8
  buffer_load_dwordx4 v[156:159], v30, s[24:27], s72 offen sc1
  buffer_load_dwordx4 v[160:163], v30, s[24:27], s73 offen sc1
  buffer_load_dwordx4 v[164:167], v30, s[24:27], s74 offen sc1
  buffer_load_dwordx4 v[168:171], v30, s[24:27], s75 offen sc1
  buffer_load_dwordx4 v[172:175], v30, s[24:27], s76 offen sc1
  buffer_load_dwordx4 v[176:179], v30, s[24:27], s77 offen sc1
  buffer_load_dwordx4 v[180:183], v30, s[24:27], s78 offen sc1
  ds_read_b64_tr_b16 a[160:161], v4 offset:16384
  ds_read_b64_tr_b16 a[162:163], v4 offset:17408
  ds_read_b64_tr_b16 a[164:165], v4 offset:16392
  ds_read_b64_tr_b16 a[166:167], v4 offset:17416
  ds_read_b64_tr_b16 a[168:169], v5 offset:16384
  ds_read_b64_tr_b16 a[170:171], v5 offset:17408
  ds_read_b64_tr_b16 a[172:173], v5 offset:16392
  ds_read_b64_tr_b16 a[174:175], v5 offset:17416
  ds_read_b64_tr_b16 a[176:177], v6 offset:16384
  ds_read_b64_tr_b16 a[178:179], v6 offset:17408
  ds_read_b64_tr_b16 a[180:181], v6 offset:16392
  ds_read_b64_tr_b16 a[182:183], v6 offset:17416
  ds_read_b64_tr_b16 a[184:185], v7 offset:16384
  ds_read_b64_tr_b16 a[186:187], v7 offset:17408
  ds_read_b64_tr_b16 a[188:189], v7 offset:16392
  ds_read_b64_tr_b16 a[190:191], v7 offset:17416
  s_waitcnt vmcnt(14)
  ds_read_b64_tr_b16 a[192:193], v4 offset:0
  ds_read_b64_tr_b16 a[194:195], v4 offset:1024
  ds_read_b64_tr_b16 a[196:197], v4 offset:8
  ds_read_b64_tr_b16 a[198:199], v4 offset:1032
  ds_read_b64_tr_b16 a[200:201], v5 offset:0
  ds_read_b64_tr_b16 a[202:203], v5 offset:1024
  ds_read_b64_tr_b16 a[204:205], v5 offset:8
  ds_read_b64_tr_b16 a[206:207], v5 offset:1032
  ds_read_b64_tr_b16 a[208:209], v6 offset:0
  ds_read_b64_tr_b16 a[210:211], v6 offset:1024
  ds_read_b64_tr_b16 a[212:213], v6 offset:8
  ds_read_b64_tr_b16 a[214:215], v6 offset:1032
  ds_read_b64_tr_b16 a[216:217], v7 offset:0
  ds_read_b64_tr_b16 a[218:219], v7 offset:1024
  ds_read_b64_tr_b16 a[220:221], v7 offset:8
  ds_read_b64_tr_b16 a[222:223], v7 offset:1032
  s_waitcnt lgkmcnt(0)
  s_branch L_g3
L_typeB:
  v_lshlrev_b32 v26, 7, v1
  buffer_load_dword v27, v26, s[36:39], s80 offen
  s_bfe_u32 s6, s94, 0x40008
  s_add_u32 s6, s6, s95
  s_mul_i32 s45, s6, 458752
  buffer_load_dwordx4 v[96:99], v2, s[12:15], s45 offen
  s_waitcnt vmcnt(18)
  v_lshlrev_b32 v16, 16, v18
  v_and_b32 v17, 0xffff0000, v18
  v_lshlrev_b32 v18, 16, v19
  v_and_b32 v19, 0xffff0000, v19
  s_waitcnt vmcnt(10)
  v_cvt_f32_i32 v32, v32
  v_cvt_f32_i32 v33, v33
  v_cvt_f32_i32 v34, v34
  v_cvt_f32_i32 v35, v35
  v_pk_add_f32 v[32:33], v[32:33], v[16:17] neg_lo:[0,1] neg_hi:[0,1]
  v_pk_add_f32 v[34:35], v[34:35], v[18:19] neg_lo:[0,1] neg_hi:[0,1]
  s_add_u32 s44, s45, 14336
  buffer_load_dwordx4 v[100:103], v2, s[12:15], s44 offen
  v_cvt_f32_i32 v36, v36
  v_cvt_f32_i32 v37, v37
  v_cvt_f32_i32 v38, v38
  v_cvt_f32_i32 v39, v39
  v_pk_add_f32 v[36:37], v[36:37], v[16:17] neg_lo:[0,1] neg_hi:[0,1]
  v_pk_add_f32 v[38:39], v[38:39], v[18:19] neg_lo:[0,1] neg_hi:[0,1]
  v_cvt_pk_bf16_f32 v128, v32, v36
  v_cvt_pk_bf16_f32 v132, v33, v37
  s_add_u32 s44, s45, 28672
  buffer_load_dwordx4 v[104:107], v2, s[12:15], s44 offen
  v_cvt_pk_bf16_f32 v136, v34, v38
  v_cvt_pk_bf16_f32 v140, v35, v39
  v_cvt_f32_i32 v40, v40
  v_cvt_f32_i32 v41, v41
  v_cvt_f32_i32 v42, v42
  v_cvt_f32_i32 v43, v43
  v_pk_add_f32 v[40:41], v[40:41], v[16:17] neg_lo:[0,1] neg_hi:[0,1]
  v_pk_add_f32 v[42:43], v[42:43], v[18:19] neg_lo:[0,1] neg_hi:[0,1]
  s_add_u32 s44, s45, 43008
  buffer_load_dwordx4 v[108:111], v2, s[12:15], s44 offen
  v_cvt_f32_i32 v44, v44
  v_cvt_f32_i32 v45, v45
  v_cvt_f32_i32 v46, v46
  v_cvt_f32_i32 v47, v47
  v_pk_add_f32 v[44:45], v[44:45], v[16:17] neg_lo:[0,1] neg_hi:[0,1]
  v_pk_add_f32 v[46:47], v[46:47], v[18:19] neg_lo:[0,1] neg_hi:[0,1]
  v_cvt_pk_bf16_f32 v129, v40, v44
  v_cvt_pk_bf16_f32 v133, v41, v45
  s_add_u32 s44, s45, 229376
  buffer_load_dwordx4 v[112:115], v2, s[12:15], s44 offen
  v_cvt_pk_bf16_f32 v137, v42, v46
  v_cvt_pk_bf16_f32 v141, v43, v47
  v_cvt_f32_i32 v48, v48
  v_cvt_f32_i32 v49, v49
  v_cvt_f32_i32 v50, v50
  v_cvt_f32_i32 v51, v51
  v_pk_add_f32 v[48:49], v[48:49], v[16:17] neg_lo:[0,1] neg_hi:[0,1]
  v_pk_add_f32 v[50:51], v[50:51], v[18:19] neg_lo:[0,1] neg_hi:[0,1]
  s_add_u32 s44, s45, 243712
  buffer_load_dwordx4 v[116:119], v2, s[12:15], s44 offen
  v_cvt_f32_i32 v52, v52
  v_cvt_f32_i32 v53, v53
  v_cvt_f32_i32 v54, v54
  v_cvt_f32_i32 v55, v55
  v_pk_add_f32 v[52:53], v[52:53], v[16:17] neg_lo:[0,1] neg_hi:[0,1]
  v_pk_add_f32 v[54:55], v[54:55], v[18:19] neg_lo:[0,1] neg_hi:[0,1]
  v_cvt_pk_bf16_f32 v130, v48, v52
  v_cvt_pk_bf16_f32 v134, v49, v53
  s_add_u32 s44, s45, 258048
  buffer_load_dwordx4 v[120:123], v2, s[12:15], s44 offen
  v_cvt_pk_bf16_f32 v138, v50, v54
  v_cvt_pk_bf16_f32 v142, v51, v55
  v_cvt_f32_i32 v56, v56
  v_cvt_f32_i32 v57, v57
  v_cvt_f32_i32 v58, v58
  v_cvt_f32_i32 v59, v59
  v_pk_add_f32 v[56:57], v[56:57], v[16:17] neg_lo:[0,1] neg_hi:[0,1]
  v_pk_add_f32 v[58:59], v[58:59], v[18:19] neg_lo:[0,1] neg_hi:[0,1]
  s_add_u32 s44, s45, 272384
  buffer_load_dwordx4 v[124:127], v2, s[12:15], s44 offen
  v_cvt_f32_i32 v60, v60
  v_cvt_f32_i32 v61, v61
  v_cvt_f32_i32 v62, v62
  v_cvt_f32_i32 v63, v63
  v_pk_add_f32 v[60:61], v[60:61], v[16:17] neg_lo:[0,1] neg_hi:[0,1]
  v_pk_add_f32 v[62:63], v[62:63], v[18:19] neg_lo:[0,1] neg_hi:[0,1]
  v_cvt_pk_bf16_f32 v131, v56, v60
  v_cvt_pk_bf16_f32 v135, v57, v61
  v_cvt_pk_bf16_f32 v139, v58, v62
  v_cvt_pk_bf16_f32 v143, v59, v63
  s_bfe_u32 s6, s94, 0x4000c
  s_add_u32 s6, s6, s95
  s_mul_i32 s45, s6, 458752
  buffer_load_dwordx4 v[32:35], v2, s[12:15], s45 offen
  s_waitcnt vmcnt(10)
  v_cvt_f32_i32 v64, v64
  v_cvt_f32_i32 v65, v65
  v_cvt_f32_i32 v66, v66
  v_cvt_f32_i32 v67, v67
  v_pk_add_f32 v[64:65], v[64:65], v[16:17] neg_lo:[0,1] neg_hi:[0,1]
  v_pk_add_f32 v[66:67], v[66:67], v[18:19] neg_lo:[0,1] neg_hi:[0,1]
  v_cvt_f32_i32 v68, v68
  s_add_u32 s44, s45, 14336
  buffer_load_dwordx4 v[36:39], v2, s[12:15], s44 offen
  v_cvt_f32_i32 v69, v69
  v_cvt_f32_i32 v70, v70
  v_cvt_f32_i32 v71, v71
  v_pk_add_f32 v[68:69], v[68:69], v[16:17] neg_lo:[0,1] neg_hi:[0,1]
  v_pk_add_f32 v[70:71], v[70:71], v[18:19] neg_lo:[0,1] neg_hi:[0,1]
  v_cvt_pk_bf16_f32 v144, v64, v68
  v_cvt_pk_bf16_f32 v148, v65, v69
  v_cvt_pk_bf16_f32 v152, v66, v70
  s_add_u32 s44, s45, 28672
  buffer_load_dwordx4 v[40:43], v2, s[12:15], s44 offen
  v_cvt_pk_bf16_f32 v156, v67, v71
  v_cvt_f32_i32 v72, v72
  v_cvt_f32_i32 v73, v73
  v_cvt_f32_i32 v74, v74
  v_cvt_f32_i32 v75, v75
  v_pk_add_f32 v[72:73], v[72:73], v[16:17] neg_lo:[0,1] neg_hi:[0,1]
  v_pk_add_f32 v[74:75], v[74:75], v[18:19] neg_lo:[0,1] neg_hi:[0,1]
  v_cvt_f32_i32 v76, v76
  s_add_u32 s44, s45, 43008
  buffer_load_dwordx4 v[44:47], v2, s[12:15], s44 offen
  v_cvt_f32_i32 v77, v77
  v_cvt_f32_i32 v78, v78
  v_cvt_f32_i32 v79, v79
  v_pk_add_f32 v[76:77], v[76:77], v[16:17] neg_lo:[0,1] neg_hi:[0,1]
  v_pk_add_f32 v[78:79], v[78:79], v[18:19] neg_lo:[0,1] neg_hi:[0,1]
  v_cvt_pk_bf16_f32 v145, v72, v76
  v_cvt_pk_bf16_f32 v149, v73, v77
  v_cvt_pk_bf16_f32 v153, v74, v78
  s_add_u32 s44, s45, 229376
  buffer_load_dwordx4 v[48:51], v2, s[12:15], s44 offen
  v_cvt_pk_bf16_f32 v157, v75, v79
  v_cvt_f32_i32 v80, v80
  v_cvt_f32_i32 v81, v81
  v_cvt_f32_i32 v82, v82
  v_cvt_f32_i32 v83, v83
  v_pk_add_f32 v[80:81], v[80:81], v[16:17] neg_lo:[0,1] neg_hi:[0,1]
  v_pk_add_f32 v[82:83], v[82:83], v[18:19] neg_lo:[0,1] neg_hi:[0,1]
  v_cvt_f32_i32 v84, v84
  s_add_u32 s44, s45, 243712
  buffer_load_dwordx4 v[52:55], v2, s[12:15], s44 offen
  v_cvt_f32_i32 v85, v85
  v_cvt_f32_i32 v86, v86
  v_cvt_f32_i32 v87, v87
  v_pk_add_f32 v[84:85], v[84:85], v[16:17] neg_lo:[0,1] neg_hi:[0,1]
  v_pk_add_f32 v[86:87], v[86:87], v[18:19] neg_lo:[0,1] neg_hi:[0,1]
  v_cvt_pk_bf16_f32 v146, v80, v84
  v_cvt_pk_bf16_f32 v150, v81, v85
  v_cvt_pk_bf16_f32 v154, v82, v86
  s_add_u32 s44, s45, 258048
  buffer_load_dwordx4 v[56:59], v2, s[12:15], s44 offen
  v_cvt_pk_bf16_f32 v158, v83, v87
  v_cvt_f32_i32 v88, v88
  v_cvt_f32_i32 v89, v89
  v_cvt_f32_i32 v90, v90
  v_cvt_f32_i32 v91, v91
  v_pk_add_f32 v[88:89], v[88:89], v[16:17] neg_lo:[0,1] neg_hi:[0,1]
  v_pk_add_f32 v[90:91], v[90:91], v[18:19] neg_lo:[0,1] neg_hi:[0,1]
  v_cvt_f32_i32 v92, v92
  s_add_u32 s44, s45, 272384
  buffer_load_dwordx4 v[60:63], v2, s[12:15], s44 offen
  v_cvt_f32_i32 v93, v93
  v_cvt_f32_i32 v94, v94
  v_cvt_f32_i32 v95, v95
  v_pk_add_f32 v[92:93], v[92:93], v[16:17] neg_lo:[0,1] neg_hi:[0,1]
  v_pk_add_f32 v[94:95], v[94:95], v[18:19] neg_lo:[0,1] neg_hi:[0,1]
  v_cvt_pk_bf16_f32 v147, v88, v92
  v_cvt_pk_bf16_f32 v151, v89, v93
  v_cvt_pk_bf16_f32 v155, v90, v94
  v_cvt_pk_bf16_f32 v159, v91, v95
  s_bfe_u32 s6, s94, 0x40010
  s_add_u32 s6, s6, s95
  s_mul_i32 s45, s6, 458752
  buffer_load_dwordx4 v[64:67], v2, s[12:15], s45 offen
  s_waitcnt vmcnt(9)
  v_cvt_f32_i32 v96, v96
  v_cvt_f32_i32 v97, v97
  v_cvt_f32_i32 v98, v98
  v_cvt_f32_i32 v99, v99
  v_pk_add_f32 v[96:97], v[96:97], v[16:17] neg_lo:[0,1] neg_hi:[0,1]
  v_pk_add_f32 v[98:99], v[98:99], v[18:19] neg_lo:[0,1] neg_hi:[0,1]
  v_cvt_f32_i32 v100, v100
  s_add_u32 s44, s45, 14336
  buffer_load_dwordx4 v[68:71], v2, s[12:15], s44 offen
  v_cvt_f32_i32 v101, v101
  v_cvt_f32_i32 v102, v102
  v_cvt_f32_i32 v103, v103
  v_pk_add_f32 v[100:101], v[100:101], v[16:17] neg_lo:[0,1] neg_hi:[0,1]
  v_pk_add_f32 v[102:103], v[102:103], v[18:19] neg_lo:[0,1] neg_hi:[0,1]
  v_cvt_pk_bf16_f32 v160, v96, v100
  v_cvt_pk_bf16_f32 v164, v97, v101
  v_cvt_pk_bf16_f32 v168, v98, v102
  s_add_u32 s44, s45, 28672
  buffer_load_dwordx4 v[72:75], v2, s[12:15], s44 offen
  v_cvt_pk_bf16_f32 v172, v99, v103
  v_cvt_f32_i32 v104, v104
  v_cvt_f32_i32 v105, v105
  v_cvt_f32_i32 v106, v106
  v_cvt_f32_i32 v107, v107
  v_pk_add_f32 v[104:105], v[104:105], v[16:17] neg_lo:[0,1] neg_hi:[0,1]
  v_pk_add_f32 v[106:107], v[106:107], v[18:19] neg_lo:[0,1] neg_hi:[0,1]
  v_cvt_f32_i32 v108, v108
  s_add_u32 s44, s45, 43008
  buffer_load_dwordx4 v[76:79], v2, s[12:15], s44 offen
  v_cvt_f32_i32 v109, v109
  v_cvt_f32_i32 v110, v110
  v_cvt_f32_i32 v111, v111
  v_pk_add_f32 v[108:109], v[108:109], v[16:17] neg_lo:[0,1] neg_hi:[0,1]
  v_pk_add_f32 v[110:111], v[110:111], v[18:19] neg_lo:[0,1] neg_hi:[0,1]
  v_cvt_pk_bf16_f32 v161, v104, v108
  v_cvt_pk_bf16_f32 v165, v105, v109
  v_cvt_pk_bf16_f32 v169, v106, v110
  s_add_u32 s44, s45, 229376
  buffer_load_dwordx4 v[80:83], v2, s[12:15], s44 offen
  v_cvt_pk_bf16_f32 v173, v107, v111
  v_cvt_f32_i32 v112, v112
  v_cvt_f32_i32 v113, v113
  v_cvt_f32_i32 v114, v114
  v_cvt_f32_i32 v115, v115
  v_pk_add_f32 v[112:113], v[112:113], v[16:17] neg_lo:[0,1] neg_hi:[0,1]
  v_pk_add_f32 v[114:115], v[114:115], v[18:19] neg_lo:[0,1] neg_hi:[0,1]
  v_cvt_f32_i32 v116, v116
  s_add_u32 s44, s45, 243712
  buffer_load_dwordx4 v[84:87], v2, s[12:15], s44 offen
  v_cvt_f32_i32 v117, v117
  v_cvt_f32_i32 v118, v118
  v_cvt_f32_i32 v119, v119
  v_pk_add_f32 v[116:117], v[116:117], v[16:17] neg_lo:[0,1] neg_hi:[0,1]
  v_pk_add_f32 v[118:119], v[118:119], v[18:19] neg_lo:[0,1] neg_hi:[0,1]
  v_cvt_pk_bf16_f32 v162, v112, v116
  v_cvt_pk_bf16_f32 v166, v113, v117
  v_cvt_pk_bf16_f32 v170, v114, v118
  s_add_u32 s44, s45, 258048
  buffer_load_dwordx4 v[88:91], v2, s[12:15], s44 offen
  v_cvt_pk_bf16_f32 v174, v115, v119
  v_cvt_f32_i32 v120, v120
  v_cvt_f32_i32 v121, v121
  v_cvt_f32_i32 v122, v122
  v_cvt_f32_i32 v123, v123
  v_pk_add_f32 v[120:121], v[120:121], v[16:17] neg_lo:[0,1] neg_hi:[0,1]
  v_pk_add_f32 v[122:123], v[122:123], v[18:19] neg_lo:[0,1] neg_hi:[0,1]
  v_cvt_f32_i32 v124, v124
  s_add_u32 s44, s45, 272384
  buffer_load_dwordx4 v[92:95], v2, s[12:15], s44 offen
  v_cvt_f32_i32 v125, v125
  v_cvt_f32_i32 v126, v126
  v_cvt_f32_i32 v127, v127
  v_pk_add_f32 v[124:125], v[124:125], v[16:17] neg_lo:[0,1] neg_hi:[0,1]
  v_pk_add_f32 v[126:127], v[126:127], v[18:19] neg_lo:[0,1] neg_hi:[0,1]
  v_cvt_pk_bf16_f32 v163, v120, v124
  v_cvt_pk_bf16_f32 v167, v121, v125
  v_cvt_pk_bf16_f32 v171, v122, v126
  v_cvt_pk_bf16_f32 v175, v123, v127
  s_bfe_u32 s6, s94, 0x40014
  s_add_u32 s6, s6, s95
  s_mul_i32 s45, s6, 458752
  buffer_load_dwordx4 v[96:99], v2, s[12:15], s45 offen
  s_waitcnt vmcnt(9)
  v_cvt_f32_i32 v32, v32
  v_cvt_f32_i32 v33, v33
  v_cvt_f32_i32 v34, v34
  v_cvt_f32_i32 v35, v35
  v_pk_add_f32 v[32:33], v[32:33], v[16:17] neg_lo:[0,1] neg_hi:[0,1]
  v_pk_add_f32 v[34:35], v[34:35], v[18:19] neg_lo:[0,1] neg_hi:[0,1]
  v_cvt_f32_i32 v36, v36
  s_add_u32 s44, s45, 14336
  buffer_load_dwordx4 v[100:103], v2, s[12:15], s44 offen
  v_cvt_f32_i32 v37, v37
  v_cvt_f32_i32 v38, v38
  v_cvt_f32_i32 v39, v39
  v_pk_add_f32 v[36:37], v[36:37], v[16:17] neg_lo:[0,1] neg_hi:[0,1]
  v_pk_add_f32 v[38:39], v[38:39], v[18:19] neg_lo:[0,1] neg_hi:[0,1]
  v_cvt_pk_bf16_f32 v176, v32, v36
  v_cvt_pk_bf16_f32 v180, v33, v37
  v_cvt_pk_bf16_f32 v184, v34, v38
  s_add_u32 s44, s45, 28672
  buffer_load_dwordx4 v[104:107], v2, s[12:15], s44 offen
  v_cvt_pk_bf16_f32 v188, v35, v39
  v_cvt_f32_i32 v40, v40
  v_cvt_f32_i32 v41, v41
  v_cvt_f32_i32 v42, v42
  v_cvt_f32_i32 v43, v43
  v_pk_add_f32 v[40:41], v[40:41], v[16:17] neg_lo:[0,1] neg_hi:[0,1]
  v_pk_add_f32 v[42:43], v[42:43], v[18:19] neg_lo:[0,1] neg_hi:[0,1]
  v_cvt_f32_i32 v44, v44
  s_add_u32 s44, s45, 43008
  buffer_load_dwordx4 v[108:111], v2, s[12:15], s44 offen
  v_cvt_f32_i32 v45, v45
  v_cvt_f32_i32 v46, v46
  v_cvt_f32_i32 v47, v47
  v_pk_add_f32 v[44:45], v[44:45], v[16:17] neg_lo:[0,1] neg_hi:[0,1]
  v_pk_add_f32 v[46:47], v[46:47], v[18:19] neg_lo:[0,1] neg_hi:[0,1]
  v_cvt_pk_bf16_f32 v177, v40, v44
  v_cvt_pk_bf16_f32 v181, v41, v45
  v_cvt_pk_bf16_f32 v185, v42, v46
  s_add_u32 s44, s45, 229376
  buffer_load_dwordx4 v[112:115], v2, s[12:15], s44 offen
  v_cvt_pk_bf16_f32 v189, v43, v47
  v_cvt_f32_i32 v48, v48
  v_cvt_f32_i32 v49, v49
  v_cvt_f32_i32 v50, v50
  v_cvt_f32_i32 v51, v51
  v_pk_add_f32 v[48:49], v[48:49], v[16:17] neg_lo:[0,1] neg_hi:[0,1]
  v_pk_add_f32 v[50:51], v[50:51], v[18:19] neg_lo:[0,1] neg_hi:[0,1]
  v_cvt_f32_i32 v52, v52
  s_add_u32 s44, s45, 243712
  buffer_load_dwordx4 v[116:119], v2, s[12:15], s44 offen
  v_cvt_f32_i32 v53, v53
  v_cvt_f32_i32 v54, v54
  v_cvt_f32_i32 v55, v55
  v_pk_add_f32 v[52:53], v[52:53], v[16:17] neg_lo:[0,1] neg_hi:[0,1]
  v_pk_add_f32 v[54:55], v[54:55], v[18:19] neg_lo:[0,1] neg_hi:[0,1]
  v_cvt_pk_bf16_f32 v178, v48, v52
  v_cvt_pk_bf16_f32 v182, v49, v53
  v_cvt_pk_bf16_f32 v186, v50, v54
  s_add_u32 s44, s45, 258048
  buffer_load_dwordx4 v[120:123], v2, s[12:15], s44 offen
  v_cvt_pk_bf16_f32 v190, v51, v55
  v_cvt_f32_i32 v56, v56
  v_cvt_f32_i32 v57, v57
  v_cvt_f32_i32 v58, v58
  v_cvt_f32_i32 v59, v59
  v_pk_add_f32 v[56:57], v[56:57], v[16:17] neg_lo:[0,1] neg_hi:[0,1]
  v_pk_add_f32 v[58:59], v[58:59], v[18:19] neg_lo:[0,1] neg_hi:[0,1]
  v_cvt_f32_i32 v60, v60
  s_add_u32 s44, s45, 272384
  buffer_load_dwordx4 v[124:127], v2, s[12:15], s44 offen
  v_cvt_f32_i32 v61, v61
  v_cvt_f32_i32 v62, v62
  v_cvt_f32_i32 v63, v63
  v_pk_add_f32 v[60:61], v[60:61], v[16:17] neg_lo:[0,1] neg_hi:[0,1]
  v_pk_add_f32 v[62:63], v[62:63], v[18:19] neg_lo:[0,1] neg_hi:[0,1]
  v_cvt_pk_bf16_f32 v179, v56, v60
  v_cvt_pk_bf16_f32 v183, v57, v61
  v_cvt_pk_bf16_f32 v187, v58, v62
  v_cvt_pk_bf16_f32 v191, v59, v63
  v_lshlrev_b32 v0, 2, v1
  buffer_load_dword v14, v0, s[40:43], 0 offen sc1
  s_waitcnt vmcnt(9)
  v_cvt_f32_i32 v64, v64
  v_cvt_f32_i32 v65, v65
  v_cvt_f32_i32 v66, v66
  v_cvt_f32_i32 v67, v67
  v_pk_add_f32 v[64:65], v[64:65], v[16:17] neg_lo:[0,1] neg_hi:[0,1]
  s_lshl_b32 s6, s60, 7
  s_and_b32 s44, s3, 1
  s_lshl_b32 s44, s44, 2
  s_add_u32 s6, s6, s44
  v_lshrrev_b32 v26, 4, v1
  v_lshlrev_b32 v26, 5, v26
  buffer_load_dword v20, v26, s[32:35], s6 offen offset:0
  buffer_load_dword v21, v26, s[32:35], s6 offen offset:8
  buffer_load_dword v22, v26, s[32:35], s6 offen offset:16
  buffer_load_dword v23, v26, s[32:35], s6 offen offset:24
  v_pk_add_f32 v[66:67], v[66:67], v[18:19] neg_lo:[0,1] neg_hi:[0,1]
  v_cvt_f32_i32 v68, v68
  v_cvt_f32_i32 v69, v69
  v_cvt_f32_i32 v70, v70
  v_cvt_f32_i32 v71, v71
  v_pk_add_f32 v[68:69], v[68:69], v[16:17] neg_lo:[0,1] neg_hi:[0,1]
  s_bfe_u32 s6, s94, 0x40018
  s_add_u32 s6, s6, s95
  s_mul_i32 s45, s6, 458752
  buffer_load_dwordx4 v[32:35], v2, s[12:15], s45 offen
  v_pk_add_f32 v[70:71], v[70:71], v[18:19] neg_lo:[0,1] neg_hi:[0,1]
  v_cvt_pk_bf16_f32 v192, v64, v68
  v_cvt_pk_bf16_f32 v196, v65, v69
  v_cvt_pk_bf16_f32 v200, v66, v70
  v_cvt_pk_bf16_f32 v204, v67, v71
  v_cvt_f32_i32 v72, v72
  s_add_u32 s44, s45, 14336
  buffer_load_dwordx4 v[36:39], v2, s[12:15], s44 offen
  v_cvt_f32_i32 v73, v73
  v_cvt_f32_i32 v74, v74
  v_cvt_f32_i32 v75, v75
  v_pk_add_f32 v[72:73], v[72:73], v[16:17] neg_lo:[0,1] neg_hi:[0,1]
  v_pk_add_f32 v[74:75], v[74:75], v[18:19] neg_lo:[0,1] neg_hi:[0,1]
  v_cvt_f32_i32 v76, v76
  s_add_u32 s44, s45, 28672
  buffer_load_dwordx4 v[40:43], v2, s[12:15], s44 offen
  v_cvt_f32_i32 v77, v77
  v_cvt_f32_i32 v78, v78
  v_cvt_f32_i32 v79, v79
  v_pk_add_f32 v[76:77], v[76:77], v[16:17] neg_lo:[0,1] neg_hi:[0,1]
  v_pk_add_f32 v[78:79], v[78:79], v[18:19] neg_lo:[0,1] neg_hi:[0,1]
  v_cvt_pk_bf16_f32 v193, v72, v76
  s_add_u32 s44, s45, 43008
  buffer_load_dwordx4 v[44:47], v2, s[12:15], s44 offen
  v_cvt_pk_bf16_f32 v197, v73, v77
  v_cvt_pk_bf16_f32 v201, v74, v78
  v_cvt_pk_bf16_f32 v205, v75, v79
  v_cvt_f32_i32 v80, v80
  v_cvt_f32_i32 v81, v81
  v_cvt_f32_i32 v82, v82
  s_add_u32 s44, s45, 229376
  buffer_load_dwordx4 v[48:51], v2, s[12:15], s44 offen
  v_cvt_f32_i32 v83, v83
  v_pk_add_f32 v[80:81], v[80:81], v[16:17] neg_lo:[0,1] neg_hi:[0,1]
  v_pk_add_f32 v[82:83], v[82:83], v[18:19] neg_lo:[0,1] neg_hi:[0,1]
  v_cvt_f32_i32 v84, v84
  v_cvt_f32_i32 v85, v85
  v_cvt_f32_i32 v86, v86
  s_add_u32 s44, s45, 243712
  buffer_load_dwordx4 v[52:55], v2, s[12:15], s44 offen
  v_cvt_f32_i32 v87, v87
  v_pk_add_f32 v[84:85], v[84:85], v[16:17] neg_lo:[0,1] neg_hi:[0,1]
  v_pk_add_f32 v[86:87], v[86:87], v[18:19] neg_lo:[0,1] neg_hi:[0,1]
  v_cvt_pk_bf16_f32 v194, v80, v84
  v_cvt_pk_bf16_f32 v198, v81, v85
  v_cvt_pk_bf16_f32 v202, v82, v86
  s_add_u32 s44, s45, 258048
  buffer_load_dwordx4 v[56:59], v2, s[12:15], s44 offen
  v_cvt_pk_bf16_f32 v206, v83, v87
  v_cvt_f32_i32 v88, v88
  v_cvt_f32_i32 v89, v89
  v_cvt_f32_i32 v90, v90
  v_cvt_f32_i32 v91, v91
  v_pk_add_f32 v[88:89], v[88:89], v[16:17] neg_lo:[0,1] neg_hi:[0,1]
  s_add_u32 s44, s45, 272384
  buffer_load_dwordx4 v[60:63], v2, s[12:15], s44 offen
  v_pk_add_f32 v[90:91], v[90:91], v[18:19] neg_lo:[0,1] neg_hi:[0,1]
  v_cvt_f32_i32 v92, v92
  v_cvt_f32_i32 v93, v93
  v_cvt_f32_i32 v94, v94
  v_cvt_f32_i32 v95, v95
  v_pk_add_f32 v[92:93], v[92:93], v[16:17] neg_lo:[0,1] neg_hi:[0,1]
  v_pk_add_f32 v[94:95], v[94:95], v[18:19] neg_lo:[0,1] neg_hi:[0,1]
  v_cvt_pk_bf16_f32 v195, v88, v92
  v_cvt_pk_bf16_f32 v199, v89, v93
  v_cvt_pk_bf16_f32 v203, v90, v94
  v_cvt_pk_bf16_f32 v207, v91, v95
  s_bfe_u32 s6, s94, 0x4001c
  s_add_u32 s6, s6, s95
  s_mul_i32 s45, s6, 458752
  buffer_load_dwordx4 v[64:67], v2, s[12:15], s45 offen
  s_waitcnt vmcnt(14)
  v_cvt_f32_i32 v96, v96
  v_cvt_f32_i32 v97, v97
  v_cvt_f32_i32 v98, v98
  v_cvt_f32_i32 v99, v99
  v_pk_add_f32 v[96:97], v[96:97], v[16:17] neg_lo:[0,1] neg_hi:[0,1]
  v_pk_add_f32 v[98:99], v[98:99], v[18:19] neg_lo:[0,1] neg_hi:[0,1]
  v_cvt_f32_i32 v100, v100
  s_add_u32 s44, s45, 14336
  buffer_load_dwordx4 v[68:71], v2, s[12:15], s44 offen
  v_cvt_f32_i32 v101, v101
  v_cvt_f32_i32 v102, v102
  v_cvt_f32_i32 v103, v103
  v_pk_add_f32 v[100:101], v[100:101], v[16:17] neg_lo:[0,1] neg_hi:[0,1]
  v_pk_add_f32 v[102:103], v[102:103], v[18:19] neg_lo:[0,1] neg_hi:[0,1]
  v_cvt_pk_bf16_f32 v208, v96, v100
  v_cvt_pk_bf16_f32 v212, v97, v101
  v_cvt_pk_bf16_f32 v216, v98, v102
  s_add_u32 s44, s45, 28672
  buffer_load_dwordx4 v[72:75], v2, s[12:15], s44 offen
  v_cvt_pk_bf16_f32 v220, v99, v103
  v_cvt_f32_i32 v104, v104
  v_cvt_f32_i32 v105, v105
  v_cvt_f32_i32 v106, v106
  v_cvt_f32_i32 v107, v107
  v_pk_add_f32 v[104:105], v[104:105], v[16:17] neg_lo:[0,1] neg_hi:[0,1]
  v_pk_add_f32 v[106:107], v[106:107], v[18:19] neg_lo:[0,1] neg_hi:[0,1]
  v_cvt_f32_i32 v108, v108
  s_add_u32 s44, s45, 43008
  buffer_load_dwordx4 v[76:79], v2, s[12:15], s44 offen
  v_cvt_f32_i32 v109, v109
  v_cvt_f32_i32 v110, v110
  v_cvt_f32_i32 v111, v111
  v_pk_add_f32 v[108:109], v[108:109], v[16:17] neg_lo:[0,1] neg_hi:[0,1]
  v_pk_add_f32 v[110:111], v[110:111], v[18:19] neg_lo:[0,1] neg_hi:[0,1]
  v_cvt_pk_bf16_f32 v209, v104, v108
  v_cvt_pk_bf16_f32 v213, v105, v109
  v_cvt_pk_bf16_f32 v217, v106, v110
  s_add_u32 s44, s45, 229376
  buffer_load_dwordx4 v[80:83], v2, s[12:15], s44 offen
  v_cvt_pk_bf16_f32 v221, v107, v111
  v_cvt_f32_i32 v112, v112
  v_cvt_f32_i32 v113, v113
  v_cvt_f32_i32 v114, v114
  v_cvt_f32_i32 v115, v115
  v_pk_add_f32 v[112:113], v[112:113], v[16:17] neg_lo:[0,1] neg_hi:[0,1]
  v_pk_add_f32 v[114:115], v[114:115], v[18:19] neg_lo:[0,1] neg_hi:[0,1]
  v_cvt_f32_i32 v116, v116
  s_add_u32 s44, s45, 243712
  buffer_load_dwordx4 v[84:87], v2, s[12:15], s44 offen
  v_cvt_f32_i32 v117, v117
  v_cvt_f32_i32 v118, v118
  v_cvt_f32_i32 v119, v119
  v_pk_add_f32 v[116:117], v[116:117], v[16:17] neg_lo:[0,1] neg_hi:[0,1]
  v_pk_add_f32 v[118:119], v[118:119], v[18:19] neg_lo:[0,1] neg_hi:[0,1]
  v_cvt_pk_bf16_f32 v210, v112, v116
  v_cvt_pk_bf16_f32 v214, v113, v117
  v_cvt_pk_bf16_f32 v218, v114, v118
  s_add_u32 s44, s45, 258048
  buffer_load_dwordx4 v[88:91], v2, s[12:15], s44 offen
  v_cvt_pk_bf16_f32 v222, v115, v119
  v_cvt_f32_i32 v120, v120
  v_cvt_f32_i32 v121, v121
  v_cvt_f32_i32 v122, v122
  v_cvt_f32_i32 v123, v123
  v_pk_add_f32 v[120:121], v[120:121], v[16:17] neg_lo:[0,1] neg_hi:[0,1]
  v_pk_add_f32 v[122:123], v[122:123], v[18:19] neg_lo:[0,1] neg_hi:[0,1]
  v_cvt_f32_i32 v124, v124
  s_add_u32 s44, s45, 272384
  buffer_load_dwordx4 v[92:95], v2, s[12:15], s44 offen
  v_cvt_f32_i32 v125, v125
  v_cvt_f32_i32 v126, v126
  v_cvt_f32_i32 v127, v127
  v_pk_add_f32 v[124:125], v[124:125], v[16:17] neg_lo:[0,1] neg_hi:[0,1]
  v_pk_add_f32 v[126:127], v[126:127], v[18:19] neg_lo:[0,1] neg_hi:[0,1]
  v_cvt_pk_bf16_f32 v211, v120, v124
  v_cvt_pk_bf16_f32 v215, v121, v125
  v_cvt_pk_bf16_f32 v219, v122, v126
  v_cvt_pk_bf16_f32 v223, v123, v127
  s_add_u32 m0, s83, 0
  s_add_u32 s44, s64, 0
  buffer_load_dwordx4 v3, s[20:23], s44 offen lds
  s_waitcnt vmcnt(9)
  v_cvt_f32_i32 v32, v32
  v_cvt_f32_i32 v33, v33
  v_cvt_f32_i32 v34, v34
  v_cvt_f32_i32 v35, v35
  v_pk_add_f32 v[32:33], v[32:33], v[16:17] neg_lo:[0,1] neg_hi:[0,1]
  v_pk_add_f32 v[34:35], v[34:35], v[18:19] neg_lo:[0,1] neg_hi:[0,1]
  v_cvt_f32_i32 v36, v36
  s_add_u32 m0, m0, 1024
  s_add_u32 s44, s64, 7168
  buffer_load_dwordx4 v3, s[20:23], s44 offen lds
  v_cvt_f32_i32 v37, v37
  v_cvt_f32_i32 v38, v38
  v_cvt_f32_i32 v39, v39
  v_pk_add_f32 v[36:37], v[36:37], v[16:17] neg_lo:[0,1] neg_hi:[0,1]
  v_pk_add_f32 v[38:39], v[38:39], v[18:19] neg_lo:[0,1] neg_hi:[0,1]
  v_cvt_pk_bf16_f32 v224, v32, v36
  v_cvt_pk_bf16_f32 v228, v33, v37
  v_cvt_pk_bf16_f32 v232, v34, v38
  s_add_u32 m0, m0, 1024
  s_add_u32 s44, s64, 114688
  buffer_load_dwordx4 v3, s[20:23], s44 offen lds
  v_cvt_pk_bf16_f32 v236, v35, v39
  v_cvt_f32_i32 v40, v40
  v_cvt_f32_i32 v41, v41
  v_cvt_f32_i32 v42, v42
  v_cvt_f32_i32 v43, v43
  v_pk_add_f32 v[40:41], v[40:41], v[16:17] neg_lo:[0,1] neg_hi:[0,1]
  v_pk_add_f32 v[42:43], v[42:43], v[18:19] neg_lo:[0,1] neg_hi:[0,1]
  v_cvt_f32_i32 v44, v44
  s_add_u32 m0, m0, 1024
  s_add_u32 s44, s64, 121856
  buffer_load_dwordx4 v3, s[20:23], s44 offen lds
  v_cvt_f32_i32 v45, v45
  v_cvt_f32_i32 v46, v46
  v_cvt_f32_i32 v47, v47
  v_pk_add_f32 v[44:45], v[44:45], v[16:17] neg_lo:[0,1] neg_hi:[0,1]
  v_pk_add_f32 v[46:47], v[46:47], v[18:19] neg_lo:[0,1] neg_hi:[0,1]
  v_cvt_pk_bf16_f32 v225, v40, v44
  v_cvt_pk_bf16_f32 v229, v41, v45
  v_cvt_pk_bf16_f32 v233, v42, v46
  s_add_u32 m0, m0, 1024
  s_add_u32 s44, s64, 229376
  buffer_load_dwordx4 v3, s[20:23], s44 offen lds
  v_cvt_pk_bf16_f32 v237, v43, v47
  v_cvt_f32_i32 v48, v48
  v_cvt_f32_i32 v49, v49
  v_cvt_f32_i32 v50, v50
  v_cvt_f32_i32 v51, v51
  v_pk_add_f32 v[48:49], v[48:49], v[16:17] neg_lo:[0,1] neg_hi:[0,1]
  v_pk_add_f32 v[50:51], v[50:51], v[18:19] neg_lo:[0,1] neg_hi:[0,1]
  v_cvt_f32_i32 v52, v52
  s_add_u32 m0, m0, 1024
  s_add_u32 s44, s64, 236544
  buffer_load_dwordx4 v3, s[20:23], s44 offen lds
  v_cvt_f32_i32 v53, v53
  v_cvt_f32_i32 v54, v54
  v_cvt_f32_i32 v55, v55
  v_pk_add_f32 v[52:53], v[52:53], v[16:17] neg_lo:[0,1] neg_hi:[0,1]
  v_pk_add_f32 v[54:55], v[54:55], v[18:19] neg_lo:[0,1] neg_hi:[0,1]
  v_cvt_pk_bf16_f32 v226, v48, v52
  v_cvt_pk_bf16_f32 v230, v49, v53
  v_cvt_pk_bf16_f32 v234, v50, v54
  s_add_u32 m0, m0, 1024
  s_add_u32 s44, s64, 344064
  buffer_load_dwordx4 v3, s[20:23], s44 offen lds
  v_cvt_pk_bf16_f32 v238, v51, v55
  v_cvt_f32_i32 v56, v56
  v_cvt_f32_i32 v57, v57
  v_cvt_f32_i32 v58, v58
  v_cvt_f32_i32 v59, v59
  v_pk_add_f32 v[56:57], v[56:57], v[16:17] neg_lo:[0,1] neg_hi:[0,1]
  v_pk_add_f32 v[58:59], v[58:59], v[18:19] neg_lo:[0,1] neg_hi:[0,1]
  v_cvt_f32_i32 v60, v60
  s_add_u32 m0, m0, 1024
  s_add_u32 s44, s64, 351232
  buffer_load_dwordx4 v3, s[20:23], s44 offen lds
  v_cvt_f32_i32 v61, v61
  v_cvt_f32_i32 v62, v62
  v_cvt_f32_i32 v63, v63
  v_pk_add_f32 v[60:61], v[60:61], v[16:17] neg_lo:[0,1] neg_hi:[0,1]
  v_pk_add_f32 v[62:63], v[62:63], v[18:19] neg_lo:[0,1] neg_hi:[0,1]
  v_cvt_pk_bf16_f32 v227, v56, v60
  v_cvt_pk_bf16_f32 v231, v57, v61
  v_cvt_pk_bf16_f32 v235, v58, v62
  v_cvt_pk_bf16_f32 v239, v59, v63
  s_waitcnt vmcnt(8)
  v_cvt_f32_i32 v64, v64
  v_cvt_f32_i32 v65, v65
  v_cvt_f32_i32 v66, v66
  v_cvt_f32_i32 v67, v67
  v_pk_add_f32 v[64:65], v[64:65], v[16:17] neg_lo:[0,1] neg_hi:[0,1]
  v_pk_add_f32 v[66:67], v[66:67], v[18:19] neg_lo:[0,1] neg_hi:[0,1]
  v_cvt_f32_i32 v68, v68
  v_cvt_f32_i32 v69, v69
  v_cvt_f32_i32 v70, v70
  v_cvt_f32_i32 v71, v71
  v_pk_add_f32 v[68:69], v[68:69], v[16:17] neg_lo:[0,1] neg_hi:[0,1]
  v_pk_add_f32 v[70:71], v[70:71], v[18:19] neg_lo:[0,1] neg_hi:[0,1]
  v_cvt_pk_bf16_f32 v240, v64, v68
  v_cvt_pk_bf16_f32 v244, v65, v69
  v_cvt_pk_bf16_f32 v248, v66, v70
  v_cvt_pk_bf16_f32 v252, v67, v71
  v_cvt_f32_i32 v72, v72
  v_cvt_f32_i32 v73, v73
  v_cvt_f32_i32 v74, v74
  v_cvt_f32_i32 v75, v75
  v_pk_add_f32 v[72:73], v[72:73], v[16:17] neg_lo:[0,1] neg_hi:[0,1]
  v_pk_add_f32 v[74:75], v[74:75], v[18:19] neg_lo:[0,1] neg_hi:[0,1]
  v_cvt_f32_i32 v76, v76
  v_cvt_f32_i32 v77, v77
  v_cvt_f32_i32 v78, v78
  v_cvt_f32_i32 v79, v79
  v_pk_add_f32 v[76:77], v[76:77], v[16:17] neg_lo:[0,1] neg_hi:[0,1]
  v_pk_add_f32 v[78:79], v[78:79], v[18:19] neg_lo:[0,1] neg_hi:[0,1]
  v_cvt_pk_bf16_f32 v241, v72, v76
  v_cvt_pk_bf16_f32 v245, v73, v77
  v_cvt_pk_bf16_f32 v249, v74, v78
  v_cvt_pk_bf16_f32 v253, v75, v79
  v_cvt_f32_i32 v80, v80
  v_cvt_f32_i32 v81, v81
  v_cvt_f32_i32 v82, v82
  v_cvt_f32_i32 v83, v83
  v_pk_add_f32 v[80:81], v[80:81], v[16:17] neg_lo:[0,1] neg_hi:[0,1]
  v_pk_add_f32 v[82:83], v[82:83], v[18:19] neg_lo:[0,1] neg_hi:[0,1]
  v_cvt_f32_i32 v84, v84
  v_cvt_f32_i32 v85, v85
  v_cvt_f32_i32 v86, v86
  v_cvt_f32_i32 v87, v87
  v_pk_add_f32 v[84:85], v[84:85], v[16:17] neg_lo:[0,1] neg_hi:[0,1]
  v_pk_add_f32 v[86:87], v[86:87], v[18:19] neg_lo:[0,1] neg_hi:[0,1]
  v_cvt_pk_bf16_f32 v242, v80, v84
  v_cvt_pk_bf16_f32 v246, v81, v85
  v_cvt_pk_bf16_f32 v250, v82, v86
  v_cvt_pk_bf16_f32 v254, v83, v87
  v_cvt_f32_i32 v88, v88
  v_cvt_f32_i32 v89, v89
  v_cvt_f32_i32 v90, v90
  v_cvt_f32_i32 v91, v91
  v_pk_add_f32 v[88:89], v[88:89], v[16:17] neg_lo:[0,1] neg_hi:[0,1]
  v_pk_add_f32 v[90:91], v[90:91], v[18:19] neg_lo:[0,1] neg_hi:[0,1]
  v_cvt_f32_i32 v92, v92
  v_cvt_f32_i32 v93, v93
  v_cvt_f32_i32 v94, v94
  v_cvt_f32_i32 v95, v95
  v_pk_add_f32 v[92:93], v[92:93], v[16:17] neg_lo:[0,1] neg_hi:[0,1]
  v_pk_add_f32 v[94:95], v[94:95], v[18:19] neg_lo:[0,1] neg_hi:[0,1]
  v_cvt_pk_bf16_f32 v243, v88, v92
  v_cvt_pk_bf16_f32 v247, v89, v93
  v_cvt_pk_bf16_f32 v251, v90, v94
  v_cvt_pk_bf16_f32 v255, v91, v95
  v_cmp_ne_u32 s[50:51], 0, v14
  v_readfirstlane_b32 s48, v14
  s_or_b32 s50, s50, -2
  s_cmp_eq_u64 s[50:51], -1
  s_cbranch_scc0 L_aslow_27
L_aok_26:
  v_mov_b32 v13, s48
  v_and_b32 v24, 0xffff0000, v20
  v_lshlrev_b32 v20, 16, v20
  v_and_b32 v25, 0xffff0000, v21
  v_lshlrev_b32 v21, 16, v21
  v_and_b32 v26, 0xffff0000, v22
  v_lshlrev_b32 v22, 16, v22
  v_and_b32 v27, 0xffff0000, v23
  v_lshlrev_b32 v23, 16, v23
  s_and_b32 s56, s48, 0xff
  s_bfe_u32 s57, s48, 0x80008
  s_bfe_u32 s58, s48, 0x80010
  s_lshr_b32 s59, s48, 24
  s_add_u32 s6, s49, 0
  s_and_b32 s6, s6, 3
  s_lshl_b32 s7, s61, 2
  s_add_u32 s6, s6, s7
  s_lshl_b32 s6, s6, 15
  s_lshl_b32 s7, s3, 13
  s_add_u32 s6, s6, s7
  s_add_u32 s6, s6, 1048576
  v_add_u32 v30, s6, v8
  buffer_load_dwordx4 a[96:99], v30, s[24:27], s8 offen sc1
  buffer_load_dwordx4 a[100:103], v30, s[24:27], s9 offen sc1
  buffer_load_dwordx4 a[104:107], v30, s[24:27], s10 offen sc1
  buffer_load_dwordx4 a[108:111], v30, s[24:27], s11 offen sc1
  buffer_load_dwordx4 a[112:115], v30, s[24:27], s16 offen sc1
  buffer_load_dwordx4 a[116:119], v30, s[24:27], s17 offen sc1
  buffer_load_dwordx4 a[120:123], v30, s[24:27], s18 offen sc1
  buffer_load_dwordx4 a[124:127], v30, s[24:27], s19 offen sc1
  s_add_u32 s6, s49, 1
  s_and_b32 s6, s6, 3
  s_lshl_b32 s7, s61, 2
  s_add_u32 s6, s6, s7
  s_lshl_b32 s6, s6, 15
  s_lshl_b32 s7, s3, 13
  s_add_u32 s6, s6, s7
  s_add_u32 s6, s6, 1048576
  v_add_u32 v30, s6, v8
  buffer_load_dwordx4 a[128:131], v30, s[24:27], s8 offen sc1
  buffer_load_dwordx4 a[132:135], v30, s[24:27], s9 offen sc1
  buffer_load_dwordx4 a[136:139], v30, s[24:27], s10 offen sc1
  buffer_load_dwordx4 a[140:143], v30, s[24:27], s11 offen sc1
  buffer_load_dwordx4 a[144:147], v30, s[24:27], s16 offen sc1
  buffer_load_dwordx4 a[148:151], v30, s[24:27], s17 offen sc1
  buffer_load_dwordx4 a[152:155], v30, s[24:27], s18 offen sc1
  buffer_load_dwordx4 a[156:159], v30, s[24:27], s19 offen sc1
  s_waitcnt vmcnt(16)
  ds_read_b64_tr_b16 a[0:1], v4 offset:0
  ds_read_b64_tr_b16 a[2:3], v4 offset:1024
  ds_read_b64_tr_b16 a[4:5], v4 offset:8
  ds_read_b64_tr_b16 a[6:7], v4 offset:1032
  ds_read_b64_tr_b16 a[8:9], v5 offset:0
  ds_read_b64_tr_b16 a[10:11], v5 offset:1024
  ds_read_b64_tr_b16 a[12:13], v5 offset:8
  ds_read_b64_tr_b16 a[14:15], v5 offset:1032
  ds_read_b64_tr_b16 a[16:17], v6 offset:0
  ds_read_b64_tr_b16 a[18:19], v6 offset:1024
  ds_read_b64_tr_b16 a[20:21], v6 offset:8
  ds_read_b64_tr_b16 a[22:23], v6 offset:1032
  ds_read_b64_tr_b16 a[24:25], v7 offset:0
  ds_read_b64_tr_b16 a[26:27], v7 offset:1024
  ds_read_b64_tr_b16 a[28:29], v7 offset:8
  ds_read_b64_tr_b16 a[30:31], v7 offset:1032
  s_waitcnt vmcnt(8)
  v_mfma_f32_16x16x32_bf16 a[224:227], v[128:131], a[96:99], 0
  s_add_u32 s6, s49, 2
  s_and_b32 s6, s6, 3
  s_lshl_b32 s7, s61, 2
  s_add_u32 s6, s6, s7
  s_lshl_b32 s6, s6, 15
  s_lshl_b32 s7, s3, 13
  s_add_u32 s6, s6, s7
  s_add_u32 s6, s6, 1048576
  v_add_u32 v30, s6, v8
  buffer_load_dwordx4 a[160:163], v30, s[24:27], s8 offen sc1
  v_mfma_f32_16x16x32_bf16 a[224:227], v[144:147], a[100:103], a[224:227]
  v_mfma_f32_16x16x32_bf16 a[224:227], v[160:163], a[104:107], a[224:227]
  v_mfma_f32_16x16x32_bf16 a[224:227], v[176:179], a[108:111], a[224:227]
  buffer_load_dwordx4 a[164:167], v30, s[24:27], s9 offen sc1
  v_mfma_f32_16x16x32_bf16 a[224:227], v[192:195], a[112:115], a[224:227]
  v_mfma_f32_16x16x32_bf16 a[224:227], v[208:211], a[116:119], a[224:227]
  v_mfma_f32_16x16x32_bf16 a[224:227], v[224:227], a[120:123], a[224:227]
  buffer_load_dwordx4 a[168:171], v30, s[24:27], s10 offen sc1
  v_mfma_f32_16x16x32_bf16 a[224:227], v[240:243], a[124:127], a[224:227]
  v_mfma_f32_16x16x32_bf16 a[228:231], v[132:135], a[96:99], 0
  v_mfma_f32_16x16x32_bf16 a[228:231], v[148:151], a[100:103], a[228:231]
  v_mfma_f32_16x16x32_bf16 a[228:231], v[164:167], a[104:107], a[228:231]
  v_mfma_f32_16x16x32_bf16 a[228:231], v[180:183], a[108:111], a[228:231]
  buffer_load_dwordx4 a[172:175], v30, s[24:27], s11 offen sc1
  v_mfma_f32_16x16x32_bf16 a[228:231], v[196:199], a[112:115], a[228:231]
  v_mfma_f32_16x16x32_bf16 a[228:231], v[212:215], a[116:119], a[228:231]
  v_mfma_f32_16x16x32_bf16 a[228:231], v[228:231], a[120:123], a[228:231]
  buffer_load_dwordx4 a[176:179], v30, s[24:27], s16 offen sc1
  v_mfma_f32_16x16x32_bf16 a[228:231], v[244:247], a[124:127], a[228:231]
  v_accvgpr_read_b32 v32, a224
  v_cmp_u_f32 vcc, v32, v32
  s_cbranch_vccnz L_xslow_29
L_xok_28:
  ds_write_b128 v9, a[224:227] offset:0
  v_mfma_f32_16x16x32_bf16 a[232:235], v[136:139], a[96:99], 0
  v_mfma_f32_16x16x32_bf16 a[232:235], v[152:155], a[100:103], a[232:235]
  v_mfma_f32_16x16x32_bf16 a[232:235], v[168:171], a[104:107], a[232:235]
  buffer_load_dwordx4 a[180:183], v30, s[24:27], s17 offen sc1
  v_mfma_f32_16x16x32_bf16 a[232:235], v[184:187], a[108:111], a[232:235]
  v_mfma_f32_16x16x32_bf16 a[232:235], v[200:203], a[112:115], a[232:235]
  v_mfma_f32_16x16x32_bf16 a[232:235], v[216:219], a[116:119], a[232:235]
  buffer_load_dwordx4 a[184:187], v30, s[24:27], s18 offen sc1
  v_mfma_f32_16x16x32_bf16 a[232:235], v[232:235], a[120:123], a[232:235]
  v_mfma_f32_16x16x32_bf16 a[232:235], v[248:251], a[124:127], a[232:235]
  ds_write_b128 v9, a[228:231] offset:1024
  v_mfma_f32_16x16x32_bf16 a[236:239], v[140:143], a[96:99], 0
  v_mfma_f32_16x16x32_bf16 a[236:239], v[156:159], a[100:103], a[236:239]
  buffer_load_dwordx4 a[188:191], v30, s[24:27], s19 offen sc1
  v_mfma_f32_16x16x32_bf16 a[236:239], v[172:175], a[104:107], a[236:239]
  v_mfma_f32_16x16x32_bf16 a[236:239], v[188:191], a[108:111], a[236:239]
  v_mfma_f32_16x16x32_bf16 a[236:239], v[204:207], a[112:115], a[236:239]
  v_mfma_f32_16x16x32_bf16 a[236:239], v[220:223], a[116:119], a[236:239]
  v_mfma_f32_16x16x32_bf16 a[236:239], v[236:239], a[120:123], a[236:239]
  v_mfma_f32_16x16x32_bf16 a[236:239], v[252:255], a[124:127], a[236:239]
  ds_write_b128 v9, a[232:235] offset:2048
  s_waitcnt vmcnt(8)
  v_mfma_f32_16x16x32_bf16 a[240:243], v[128:131], a[128:131], 0
  s_add_u32 s6, s49, 3
  s_and_b32 s6, s6, 3
  s_lshl_b32 s7, s61, 2
  s_add_u32 s6, s6, s7
  s_lshl_b32 s6, s6, 15
  s_lshl_b32 s7, s3, 13
  s_add_u32 s6, s6, s7
  s_add_u32 s6, s6, 1048576
  v_add_u32 v30, s6, v8
  buffer_load_dwordx4 a[192:195], v30, s[24:27], s8 offen sc1
  v_mfma_f32_16x16x32_bf16 a[240:243], v[144:147], a[132:135], a[240:243]
  v_mfma_f32_16x16x32_bf16 a[240:243], v[160:163], a[136:139], a[240:243]
  v_mfma_f32_16x16x32_bf16 a[240:243], v[176:179], a[140:143], a[240:243]
  buffer_load_dwordx4 a[196:199], v30, s[24:27], s9 offen sc1
  v_mfma_f32_16x16x32_bf16 a[240:243], v[192:195], a[144:147], a[240:243]
  v_mfma_f32_16x16x32_bf16 a[240:243], v[208:211], a[148:151], a[240:243]
  v_mfma_f32_16x16x32_bf16 a[240:243], v[224:227], a[152:155], a[240:243]
  buffer_load_dwordx4 a[200:203], v30, s[24:27], s10 offen sc1
  v_mfma_f32_16x16x32_bf16 a[240:243], v[240:243], a[156:159], a[240:243]
  ds_write_b128 v9, a[236:239] offset:3072
  v_mfma_f32_16x16x32_bf16 a[244:247], v[132:135], a[128:131], 0
  v_mfma_f32_16x16x32_bf16 a[244:247], v[148:151], a[132:135], a[244:247]
  v_mfma_f32_16x16x32_bf16 a[244:247], v[164:167], a[136:139], a[244:247]
  v_mfma_f32_16x16x32_bf16 a[244:247], v[180:183], a[140:143], a[244:247]
  buffer_load_dwordx4 a[204:207], v30, s[24:27], s11 offen sc1
  v_mfma_f32_16x16x32_bf16 a[244:247], v[196:199], a[144:147], a[244:247]
  v_mfma_f32_16x16x32_bf16 a[244:247], v[212:215], a[148:151], a[244:247]
  v_mfma_f32_16x16x32_bf16 a[244:247], v[228:231], a[152:155], a[244:247]
  buffer_load_dwordx4 a[208:211], v30, s[24:27], s16 offen sc1
  v_mfma_f32_16x16x32_bf16 a[244:247], v[244:247], a[156:159], a[244:247]
  v_accvgpr_read_b32 v32, a240
  v_cmp_u_f32 vcc, v32, v32
  s_cbranch_vccnz L_xslow_33
L_xok_32:
  ds_write_b128 v9, a[240:243] offset:4096
  v_mfma_f32_16x16x32_bf16 a[248:251], v[136:139], a[128:131], 0
  v_mfma_f32_16x16x32_bf16 a[248:251], v[152:155], a[132:135], a[248:251]
  v_mfma_f32_16x16x32_bf16 a[248:251], v[168:171], a[136:139], a[248:251]
  buffer_load_dwordx4 a[212:215], v30, s[24:27], s17 offen sc1
  v_mfma_f32_16x16x32_bf16 a[248:251], v[184:187], a[140:143], a[248:251]
  v_mfma_f32_16x16x32_bf16 a[248:251], v[200:203], a[144:147], a[248:251]
  v_mfma_f32_16x16x32_bf16 a[248:251], v[216:219], a[148:151], a[248:251]
  buffer_load_dwordx4 a[216:219], v30, s[24:27], s18 offen sc1
  v_mfma_f32_16x16x32_bf16 a[248:251], v[232:235], a[152:155], a[248:251]
  v_mfma_f32_16x16x32_bf16 a[248:251], v[248:251], a[156:159], a[248:251]
  ds_write_b128 v9, a[244:247] offset:5120
  v_mfma_f32_16x16x32_bf16 a[252:255], v[140:143], a[128:131], 0
  v_mfma_f32_16x16x32_bf16 a[252:255], v[156:159], a[132:135], a[252:255]
  buffer_load_dwordx4 a[220:223], v30, s[24:27], s19 offen sc1
  v_mfma_f32_16x16x32_bf16 a[252:255], v[172:175], a[136:139], a[252:255]
  v_mfma_f32_16x16x32_bf16 a[252:255], v[188:191], a[140:143], a[252:255]
  v_mfma_f32_16x16x32_bf16 a[252:255], v[204:207], a[144:147], a[252:255]
  v_mfma_f32_16x16x32_bf16 a[252:255], v[220:223], a[148:151], a[252:255]
  v_mfma_f32_16x16x32_bf16 a[252:255], v[236:239], a[152:155], a[252:255]
  v_mfma_f32_16x16x32_bf16 a[252:255], v[252:255], a[156:159], a[252:255]
  ds_write_b128 v9, a[248:251] offset:6144
  s_waitcnt vmcnt(8)
  v_mfma_f32_16x16x32_bf16 a[224:227], v[128:131], a[160:163], 0
  s_add_u32 m0, s83, 8192
  s_add_u32 s44, s65, 0
  buffer_load_dwordx4 v3, s[20:23], s44 offen lds
  v_mfma_f32_16x16x32_bf16 a[224:227], v[144:147], a[164:167], a[224:227]
  v_mfma_f32_16x16x32_bf16 a[224:227], v[160:163], a[168:171], a[224:227]
  v_mfma_f32_16x16x32_bf16 a[224:227], v[176:179], a[172:175], a[224:227]
  s_add_u32 m0, m0, 1024
  s_add_u32 s44, s65, 7168
  buffer_load_dwordx4 v3, s[20:23], s44 offen lds
  v_mfma_f32_16x16x32_bf16 a[224:227], v[192:195], a[176:179], a[224:227]
  v_mfma_f32_16x16x32_bf16 a[224:227], v[208:211], a[180:183], a[224:227]
  v_mfma_f32_16x16x32_bf16 a[224:227], v[224:227], a[184:187], a[224:227]
  s_add_u32 m0, m0, 1024
  s_add_u32 s44, s65, 114688
  buffer_load_dwordx4 v3, s[20:23], s44 offen lds
  v_mfma_f32_16x16x32_bf16 a[224:227], v[240:243], a[188:191], a[224:227]
  ds_write_b128 v9, a[252:255] offset:7168
  v_mfma_f32_16x16x32_bf16 a[228:231], v[132:135], a[160:163], 0
  v_mfma_f32_16x16x32_bf16 a[228:231], v[148:151], a[164:167], a[228:231]
  s_waitcnt lgkmcnt(0)
  s_barrier
  v_mfma_f32_16x16x32_bf16 a[228:231], v[164:167], a[168:171], a[228:231]
  ds_read_b128 v[96:99], v10 offset:0
  ds_read_b128 v[100:103], v10 offset:1024
  v_mfma_f32_16x16x32_bf16 a[228:231], v[180:183], a[172:175], a[228:231]
  s_add_u32 m0, m0, 1024
  s_add_u32 s44, s65, 121856
  buffer_load_dwordx4 v3, s[20:23], s44 offen lds
  ds_read_b128 v[104:107], v10 offset:8192
  ds_read_b128 v[108:111], v10 offset:9216
  v_mfma_f32_16x16x32_bf16 a[228:231], v[196:199], a[176:179], a[228:231]
  ds_read_b128 v[112:115], v10 offset:16384
  ds_read_b128 v[116:119], v10 offset:17408
  v_mfma_f32_16x16x32_bf16 a[228:231], v[212:215], a[180:183], a[228:231]
  ds_read_b128 v[120:123], v10 offset:24576
  ds_read_b128 v[124:127], v10 offset:25600
  v_mfma_f32_16x16x32_bf16 a[228:231], v[228:231], a[184:187], a[228:231]
  s_add_u32 m0, m0, 1024
  s_add_u32 s44, s65, 229376
  buffer_load_dwordx4 v3, s[20:23], s44 offen lds
  v_mfma_f32_16x16x32_bf16 a[228:231], v[244:247], a[188:191], a[228:231]
  v_accvgpr_read_b32 v32, a224
  v_cmp_u_f32 vcc, v32, v32
  s_cbranch_vccnz L_xslow_37
L_xok_36:
  ds_write_b128 v9, a[224:227] offset:32768
  v_mfma_f32_16x16x32_bf16 a[232:235], v[136:139], a[160:163], 0
  s_waitcnt lgkmcnt(5)
  v_add_f32 v96, v96, v104
  v_add_f32 v97, v97, v105
  v_mfma_f32_16x16x32_bf16 a[232:235], v[152:155], a[164:167], a[232:235]
  v_add_f32 v98, v98, v106
  v_add_f32 v99, v99, v107
  v_add_f32 v100, v100, v108
  v_mfma_f32_16x16x32_bf16 a[232:235], v[168:171], a[168:171], a[232:235]
  s_add_u32 m0, m0, 1024
  s_add_u32 s44, s65, 236544
  buffer_load_dwordx4 v3, s[20:23], s44 offen lds
  v_add_f32 v101, v101, v109
  v_add_f32 v102, v102, v110
  v_add_f32 v103, v103, v111
  v_mfma_f32_16x16x32_bf16 a[232:235], v[184:187], a[172:175], a[232:235]
  s_waitcnt lgkmcnt(1)
  v_add_f32 v112, v112, v120
  v_add_f32 v113, v113, v121
  v_mfma_f32_16x16x32_bf16 a[232:235], v[200:203], a[176:179], a[232:235]
  v_add_f32 v114, v114, v122
  v_add_f32 v115, v115, v123
  v_add_f32 v116, v116, v124
  v_mfma_f32_16x16x32_bf16 a[232:235], v[216:219], a[180:183], a[232:235]
  s_add_u32 m0, m0, 1024
  s_add_u32 s44, s65, 344064
  buffer_load_dwordx4 v3, s[20:23], s44 offen lds
  v_add_f32 v117, v117, v125
  v_add_f32 v118, v118, v126
  v_add_f32 v119, v119, v127
  v_mfma_f32_16x16x32_bf16 a[232:235], v[232:235], a[184:187], a[232:235]
  v_add_f32 v96, v96, v112
  v_add_f32 v97, v97, v113
  v_add_f32 v98, v98, v114
  v_mfma_f32_16x16x32_bf16 a[232:235], v[248:251], a[188:191], a[232:235]
  ds_write_b128 v9, a[228:231] offset:33792
  v_add_f32 v99, v99, v115
  v_add_f32 v100, v100, v116
  v_add_f32 v101, v101, v117
  v_mfma_f32_16x16x32_bf16 a[236:239], v[140:143], a[160:163], 0
  v_add_f32 v102, v102, v118
  v_add_f32 v103, v103, v119
  v_mul_f32 v96, v96, v20
  v_mfma_f32_16x16x32_bf16 a[236:239], v[156:159], a[164:167], a[236:239]
  s_add_u32 m0, m0, 1024
  s_add_u32 s44, s65, 351232
  buffer_load_dwordx4 v3, s[20:23], s44 offen lds
  v_mul_f32 v97, v97, v21
  v_mul_f32 v98, v98, v22
  v_mul_f32 v99, v99, v23
  v_mfma_f32_16x16x32_bf16 a[236:239], v[172:175], a[168:171], a[236:239]
  v_mul_f32 v100, v100, v24
  v_mul_f32 v101, v101, v25
  v_mul_f32 v102, v102, v26
  v_mfma_f32_16x16x32_bf16 a[236:239], v[188:191], a[172:175], a[236:239]
  v_mul_f32 v103, v103, v27
  v_cvt_pk_bf16_f32 v104, v96, v97
  v_cvt_pk_bf16_f32 v105, v98, v99
  v_mfma_f32_16x16x32_bf16 a[236:239], v[204:207], a[176:179], a[236:239]
  v_cvt_pk_bf16_f32 v106, v100, v101
  v_cvt_pk_bf16_f32 v107, v102, v103
  s_lshr_b32 s6, s3, 1
  s_add_u32 s6, s6, s49
  s_add_u32 s6, s6, 0
  s_and_b32 s6, s6, 3
  s_lshl_b32 s7, s61, 2
  s_add_u32 s6, s6, s7
  s_lshr_b32 s7, s6, 1
  s_lshl_b32 s7, s7, 7
  s_and_b32 s44, s6, 1
  s_lshl_b32 s44, s44, 3
  s_add_u32 s7, s7, s44
  v_writelane_b32 v31, s7, 0
  s_mul_i32 s6, s6, 112
  s_lshl_b32 s7, s60, 1
  s_add_u32 s6, s6, s7
  s_and_b32 s7, s3, 1
  s_add_u32 s6, s6, s7
  s_lshl_b32 s6, s6, 10
  s_add_u32 s6, s6, 2097152
  buffer_store_dwordx4 v[104:107], v8, s[24:27], s6 offen sc1
  v_mfma_f32_16x16x32_bf16 a[236:239], v[220:223], a[180:183], a[236:239]
  v_mfma_f32_16x16x32_bf16 a[236:239], v[236:239], a[184:187], a[236:239]
  v_mfma_f32_16x16x32_bf16 a[236:239], v[252:255], a[188:191], a[236:239]
  ds_write_b128 v9, a[232:235] offset:34816
  s_waitcnt vmcnt(9)
  v_mfma_f32_16x16x32_bf16 a[240:243], v[128:131], a[192:195], 0
  s_add_u32 m0, s83, 16384
  s_add_u32 s44, s66, 0
  buffer_load_dwordx4 v3, s[20:23], s44 offen lds
  v_mfma_f32_16x16x32_bf16 a[240:243], v[144:147], a[196:199], a[240:243]
  v_mfma_f32_16x16x32_bf16 a[240:243], v[160:163], a[200:203], a[240:243]
  v_mfma_f32_16x16x32_bf16 a[240:243], v[176:179], a[204:207], a[240:243]
  s_add_u32 m0, m0, 1024
  s_add_u32 s44, s66, 7168
  buffer_load_dwordx4 v3, s[20:23], s44 offen lds
  v_mfma_f32_16x16x32_bf16 a[240:243], v[192:195], a[208:211], a[240:243]
  v_mfma_f32_16x16x32_bf16 a[240:243], v[208:211], a[212:215], a[240:243]
  v_mfma_f32_16x16x32_bf16 a[240:243], v[224:227], a[216:219], a[240:243]
  s_add_u32 m0, m0, 1024
  s_add_u32 s44, s66, 114688
  buffer_load_dwordx4 v3, s[20:23], s44 offen lds
  v_mfma_f32_16x16x32_bf16 a[240:243], v[240:243], a[220:223], a[240:243]
  ds_write_b128 v9, a[236:239] offset:35840
  v_mfma_f32_16x16x32_bf16 a[244:247], v[132:135], a[192:195], 0
  v_mfma_f32_16x16x32_bf16 a[244:247], v[148:151], a[196:199], a[244:247]
  v_mfma_f32_16x16x32_bf16 a[244:247], v[164:167], a[200:203], a[244:247]
  v_mfma_f32_16x16x32_bf16 a[244:247], v[180:183], a[204:207], a[244:247]
  s_add_u32 m0, m0, 1024
  s_add_u32 s44, s66, 121856
  buffer_load_dwordx4 v3, s[20:23], s44 offen lds
  v_mfma_f32_16x16x32_bf16 a[244:247], v[196:199], a[208:211], a[244:247]
  v_mfma_f32_16x16x32_bf16 a[244:247], v[212:215], a[212:215], a[244:247]
  v_mfma_f32_16x16x32_bf16 a[244:247], v[228:231], a[216:219], a[244:247]
  s_add_u32 m0, m0, 1024
  s_add_u32 s44, s66, 229376
  buffer_load_dwordx4 v3, s[20:23], s44 offen lds
  v_mfma_f32_16x16x32_bf16 a[244:247], v[244:247], a[220:223], a[244:247]
  v_accvgpr_read_b32 v32, a240
  v_cmp_u_f32 vcc, v32, v32
  s_cbranch_vccnz L_xslow_41
L_xok_40:
  ds_write_b128 v9, a[240:243] offset:36864
  v_mfma_f32_16x16x32_bf16 a[248:251], v[136:139], a[192:195], 0
  v_mfma_f32_16x16x32_bf16 a[248:251], v[152:155], a[196:199], a[248:251]
  v_mfma_f32_16x16x32_bf16 a[248:251], v[168:171], a[200:203], a[248:251]
  s_add_u32 m0, m0, 1024
  s_add_u32 s44, s66, 236544
  buffer_load_dwordx4 v3, s[20:23], s44 offen lds
  v_mfma_f32_16x16x32_bf16 a[248:251], v[184:187], a[204:207], a[248:251]
  v_mfma_f32_16x16x32_bf16 a[248:251], v[200:203], a[208:211], a[248:251]
  v_mfma_f32_16x16x32_bf16 a[248:251], v[216:219], a[212:215], a[248:251]
  s_add_u32 m0, m0, 1024
  s_add_u32 s44, s66, 344064
  buffer_load_dwordx4 v3, s[20:23], s44 offen lds
  v_mfma_f32_16x16x32_bf16 a[248:251], v[232:235], a[216:219], a[248:251]
  v_mfma_f32_16x16x32_bf16 a[248:251], v[248:251], a[220:223], a[248:251]
  ds_write_b128 v9, a[244:247] offset:37888
  v_mfma_f32_16x16x32_bf16 a[252:255], v[140:143], a[192:195], 0
  v_mfma_f32_16x16x32_bf16 a[252:255], v[156:159], a[196:199], a[252:255]
  s_add_u32 m0, m0, 1024
  s_add_u32 s44, s66, 351232
  buffer_load_dwordx4 v3, s[20:23], s44 offen lds
  v_mfma_f32_16x16x32_bf16 a[252:255], v[172:175], a[200:203], a[252:255]
  v_mfma_f32_16x16x32_bf16 a[252:255], v[188:191], a[204:207], a[252:255]
  v_mfma_f32_16x16x32_bf16 a[252:255], v[204:207], a[208:211], a[252:255]
  v_mfma_f32_16x16x32_bf16 a[252:255], v[220:223], a[212:215], a[252:255]
  v_mfma_f32_16x16x32_bf16 a[252:255], v[236:239], a[216:219], a[252:255]
  v_mfma_f32_16x16x32_bf16 a[252:255], v[252:255], a[220:223], a[252:255]
  ds_write_b128 v9, a[248:251] offset:38912
  s_nop 7
  ds_write_b128 v9, a[252:255] offset:39936
  s_waitcnt lgkmcnt(0)
  s_barrier
  ds_read_b128 v[96:99], v10 offset:32768
  ds_read_b128 v[100:103], v10 offset:33792
  ds_read_b128 v[104:107], v10 offset:40960
  ds_read_b128 v[108:111], v10 offset:41984
  ds_read_b128 v[112:115], v10 offset:49152
  ds_read_b128 v[116:119], v10 offset:50176
  ds_read_b128 v[120:123], v10 offset:57344
  ds_read_b128 v[124:127], v10 offset:58368
  s_waitcnt lgkmcnt(4)
  v_add_f32 v96, v96, v104
  v_add_f32 v97, v97, v105
  v_add_f32 v98, v98, v106
  v_add_f32 v99, v99, v107
  v_add_f32 v100, v100, v108
  v_add_f32 v101, v101, v109
  v_add_f32 v102, v102, v110
  v_add_f32 v103, v103, v111
  s_waitcnt lgkmcnt(0)
  v_add_f32 v112, v112, v120
  v_add_f32 v113, v113, v121
  v_add_f32 v114, v114, v122
  v_add_f32 v115, v115, v123
  v_add_f32 v116, v116, v124
  v_add_f32 v117, v117, v125
  v_add_f32 v118, v118, v126
  v_add_f32 v119, v119, v127
  v_add_f32 v96, v96, v112
  v_add_f32 v97, v97, v113
  v_add_f32 v98, v98, v114
  v_add_f32 v99, v99, v115
  v_add_f32 v100, v100, v116
  v_add_f32 v101, v101, v117
  v_add_f32 v102, v102, v118
  v_add_f32 v103, v103, v119
  v_mul_f32 v96, v96, v20
  v_mul_f32 v97, v97, v21
  v_mul_f32 v98, v98, v22
  v_mul_f32 v99, v99, v23
  v_mul_f32 v100, v100, v24
  v_mul_f32 v101, v101, v25
  v_mul_f32 v102, v102, v26
  v_mul_f32 v103, v103, v27
  v_cvt_pk_bf16_f32 v104, v96, v97
  v_cvt_pk_bf16_f32 v105, v98, v99
  v_cvt_pk_bf16_f32 v106, v100, v101
  v_cvt_pk_bf16_f32 v107, v102, v103
  s_lshr_b32 s6, s3, 1
  s_add_u32 s6, s6, s49
  s_add_u32 s6, s6, 2
  s_and_b32 s6, s6, 3
  s_lshl_b32 s7, s61, 2
  s_add_u32 s6, s6, s7
  s_lshr_b32 s7, s6, 1
  s_lshl_b32 s7, s7, 7
  s_and_b32 s44, s6, 1
  s_lshl_b32 s44, s44, 3
  s_add_u32 s7, s7, s44
  v_writelane_b32 v31, s7, 1
  s_mul_i32 s6, s6, 112
  s_lshl_b32 s7, s60, 1
  s_add_u32 s6, s6, s7
  s_and_b32 s7, s3, 1
  s_add_u32 s6, s6, s7
  s_lshl_b32 s6, s6, 10
  s_add_u32 s6, s6, 2097152
  buffer_store_dwordx4 v[104:107], v8, s[24:27], s6 offen sc1
  s_sub_u32 s6, s3, 1
  s_and_b32 s6, s6, 3
  s_lshl_b32 s6, s6, 13
  s_add_u32 s6, s6, 98304
  v_add_u32 v16, s6, v8
  s_sub_u32 s6, s3, 2
  s_and_b32 s6, s6, 3
  s_lshl_b32 s6, s6, 13
  s_add_u32 s6, s6, 100352
  v_add_u32 v17, s6, v8
  s_sub_u32 s6, s3, 3
  s_and_b32 s6, s6, 3
  s_lshl_b32 s6, s6, 13
  s_add_u32 s6, s6, 102400
  v_add_u32 v18, s6, v8
  s_lshl_b32 s7, s62, 15
  s_add_u32 s7, s7, s92
  s_add_u32 s6, s62, 1
  s_and_b32 s6, s6, 3
  s_lshl_b32 s6, s6, 13
  s_add_u32 s8, s6, s7
  s_add_u32 s16, s8, 131072
  s_add_u32 s6, s62, 2
  s_and_b32 s6, s6, 3
  s_lshl_b32 s6, s6, 13
  s_add_u32 s9, s6, s7
  s_add_u32 s17, s9, 131072
  s_add_u32 s6, s62, 3
  s_and_b32 s6, s6, 3
  s_lshl_b32 s6, s6, 13
  s_add_u32 s10, s6, s7
  s_add_u32 s18, s10, 131072
  s_add_u32 m0, s83, 0
  s_add_u32 s44, s67, 0
  buffer_load_dwordx4 v3, s[20:23], s44 offen lds
  s_waitcnt vmcnt(11)
  ds_read_b64_tr_b16 a[32:33], v4 offset:8192
  s_add_u32 m0, m0, 1024
  s_add_u32 s44, s67, 7168
  buffer_load_dwordx4 v3, s[20:23], s44 offen lds
  ds_read_b64_tr_b16 a[34:35], v4 offset:9216
  ds_read_b64_tr_b16 a[36:37], v4 offset:8200
  s_add_u32 m0, m0, 1024
  s_add_u32 s44, s67, 114688
  buffer_load_dwordx4 v3, s[20:23], s44 offen lds
  ds_read_b64_tr_b16 a[38:39], v4 offset:9224
  ds_read_b64_tr_b16 a[40:41], v5 offset:8192
  s_add_u32 m0, m0, 1024
  s_add_u32 s44, s67, 121856
  buffer_load_dwordx4 v3, s[20:23], s44 offen lds
  ds_read_b64_tr_b16 a[42:43], v5 offset:9216
  ds_read_b64_tr_b16 a[44:45], v5 offset:8200
  s_add_u32 m0, m0, 1024
  s_add_u32 s44, s67, 229376
  buffer_load_dwordx4 v3, s[20:23], s44 offen lds
  ds_read_b64_tr_b16 a[46:47], v5 offset:9224
  ds_read_b64_tr_b16 a[48:49], v6 offset:8192
  s_add_u32 m0, m0, 1024
  s_add_u32 s44, s67, 236544
  buffer_load_dwordx4 v3, s[20:23], s44 offen lds
  ds_read_b64_tr_b16 a[50:51], v6 offset:9216
  ds_read_b64_tr_b16 a[52:53], v6 offset:8200
  s_add_u32 m0, m0, 1024
  s_add_u32 s44, s67, 344064
  buffer_load_dwordx4 v3, s[20:23], s44 offen lds
  ds_read_b64_tr_b16 a[54:55], v6 offset:9224
  ds_read_b64_tr_b16 a[56:57], v7 offset:8192
  s_add_u32 m0, m0, 1024
  s_add_u32 s44, s67, 351232
  buffer_load_dwordx4 v3, s[20:23], s44 offen lds
  ds_read_b64_tr_b16 a[58:59], v7 offset:9216
  ds_read_b64_tr_b16 a[60:61], v7 offset:8200
  ds_read_b64_tr_b16 a[62:63], v7 offset:9224
  s_waitcnt vmcnt(8)
  s_lshl_b32 s6, s60, 10
  s_and_b32 s7, s3, 1
  s_lshl_b32 s7, s7, 2
  s_add_u32 s6, s6, s7
  s_add_u32 s6, s6, 65536
  s_mov_b64 exec, 3
  buffer_store_dword v13, v31, s[24:27], s6 offen sc1
  s_mov_b64 exec, -1
  s_waitcnt lgkmcnt(0)
  s_add_u32 m0, s83, 8192
  s_add_u32 s44, s68, 0
  buffer_load_dwordx4 v3, s[20:23], s44 offen lds
  ds_read_b64_tr_b16 a[64:65], v4 offset:16384
  s_add_u32 m0, m0, 1024
  s_add_u32 s44, s68, 7168
  buffer_load_dwordx4 v3, s[20:23], s44 offen lds
  ds_read_b64_tr_b16 a[66:67], v4 offset:17408
  ds_read_b64_tr_b16 a[68:69], v4 offset:16392
  s_add_u32 m0, m0, 1024
  s_add_u32 s44, s68, 114688
  buffer_load_dwordx4 v3, s[20:23], s44 offen lds
  ds_read_b64_tr_b16 a[70:71], v4 offset:17416
  ds_read_b64_tr_b16 a[72:73], v5 offset:16384
  s_add_u32 m0, m0, 1024
  s_add_u32 s44, s68, 121856
  buffer_load_dwordx4 v3, s[20:23], s44 offen lds
  ds_read_b64_tr_b16 a[74:75], v5 offset:17408
  ds_read_b64_tr_b16 a[76:77], v5 offset:16392
  s_add_u32 m0, m0, 1024
  s_add_u32 s44, s68, 229376
  buffer_load_dwordx4 v3, s[20:23], s44 offen lds
  ds_read_b64_tr_b16 a[78:79], v5 offset:17416
  ds_read_b64_tr_b16 a[80:81], v6 offset:16384
  s_add_u32 m0, m0, 1024
  s_add_u32 s44, s68, 236544
  buffer_load_dwordx4 v3, s[20:23], s44 offen lds
  ds_read_b64_tr_b16 a[82:83], v6 offset:17408
  ds_read_b64_tr_b16 a[84:85], v6 offset:16392
  s_add_u32 m0, m0, 1024
  s_add_u32 s44, s68, 344064
  buffer_load_dwordx4 v3, s[20:23], s44 offen lds
  ds_read_b64_tr_b16 a[86:87], v6 offset:17416
  ds_read_b64_tr_b16 a[88:89], v7 offset:16384
  s_add_u32 m0, m0, 1024
  s_add_u32 s44, s68, 351232
  buffer_load_dwordx4 v3, s[20:23], s44 offen lds
  ds_read_b64_tr_b16 a[90:91], v7 offset:17408
  ds_read_b64_tr_b16 a[92:93], v7 offset:16392
  ds_read_b64_tr_b16 a[94:95], v7 offset:17416
  s_waitcnt lgkmcnt(0)
  s_add_u32 m0, s83, 16384
  s_add_u32 s44, s69, 0
  buffer_load_dwordx4 v3, s[20:23], s44 offen lds
  s_waitcnt vmcnt(10)
  ds_read_b64_tr_b16 a[96:97], v4 offset:0
  s_add_u32 m0, m0, 1024
  s_add_u32 s44, s69, 7168
  buffer_load_dwordx4 v3, s[20:23], s44 offen lds
  ds_read_b64_tr_b16 a[98:99], v4 offset:1024
  ds_read_b64_tr_b16 a[100:101], v4 offset:8
  s_add_u32 m0, m0, 1024
  s_add_u32 s44, s69, 114688
  buffer_load_dwordx4 v3, s[20:23], s44 offen lds
  ds_read_b64_tr_b16 a[102:103], v4 offset:1032
  ds_read_b64_tr_b16 a[104:105], v5 offset:0
  s_add_u32 m0, m0, 1024
  s_add_u32 s44, s69, 121856
  buffer_load_dwordx4 v3, s[20:23], s44 offen lds
  ds_read_b64_tr_b16 a[106:107], v5 offset:1024
  ds_read_b64_tr_b16 a[108:109], v5 offset:8
  s_add_u32 m0, m0, 1024
  s_add_u32 s44, s69, 229376
  buffer_load_dwordx4 v3, s[20:23], s44 offen lds
  ds_read_b64_tr_b16 a[110:111], v5 offset:1032
  ds_read_b64_tr_b16 a[112:113], v6 offset:0
  s_add_u32 m0, m0, 1024
  s_add_u32 s44, s69, 236544
  buffer_load_dwordx4 v3, s[20:23], s44 offen lds
  ds_read_b64_tr_b16 a[114:115], v6 offset:1024
  ds_read_b64_tr_b16 a[116:117], v6 offset:8
  s_add_u32 m0, m0, 1024
  s_add_u32 s44, s69, 344064
  buffer_load_dwordx4 v3, s[20:23], s44 offen lds
  ds_read_b64_tr_b16 a[118:119], v6 offset:1032
  ds_read_b64_tr_b16 a[120:121], v7 offset:0
  s_add_u32 m0, m0, 1024
  s_add_u32 s44, s69, 351232
  buffer_load_dwordx4 v3, s[20:23], s44 offen lds
  ds_read_b64_tr_b16 a[122:123], v7 offset:1024
  ds_read_b64_tr_b16 a[124:125], v7 offset:8
  ds_read_b64_tr_b16 a[126:127], v7 offset:1032
  buffer_load_dword v14, v12, s[24:27], 0 offen sc1
  s_waitcnt lgkmcnt(0)
  s_add_u32 m0, s83, 0
  s_add_u32 s44, s70, 0
  buffer_load_dwordx4 v3, s[20:23], s44 offen lds
  s_waitcnt vmcnt(10)
  ds_read_b64_tr_b16 a[128:129], v4 offset:8192
  s_add_u32 m0, m0, 1024
  s_add_u32 s44, s70, 7168
  buffer_load_dwordx4 v3, s[20:23], s44 offen lds
  ds_read_b64_tr_b16 a[130:131], v4 offset:9216
  ds_read_b64_tr_b16 a[132:133], v4 offset:8200
  s_add_u32 m0, m0, 1024
  s_add_u32 s44, s70, 114688
  buffer_load_dwordx4 v3, s[20:23], s44 offen lds
  ds_read_b64_tr_b16 a[134:135], v4 offset:9224
  ds_read_b64_tr_b16 a[136:137], v5 offset:8192
  s_add_u32 m0, m0, 1024
  s_add_u32 s44, s70, 121856
  buffer_load_dwordx4 v3, s[20:23], s44 offen lds
  ds_read_b64_tr_b16 a[138:139], v5 offset:9216
  ds_read_b64_tr_b16 a[140:141], v5 offset:8200
  s_add_u32 m0, m0, 1024
  s_add_u32 s44, s70, 229376
  buffer_load_dwordx4 v3, s[20:23], s44 offen lds
  ds_read_b64_tr_b16 a[142:143], v5 offset:9224
  ds_read_b64_tr_b16 a[144:145], v6 offset:8192
  s_add_u32 m0, m0, 1024
  s_add_u32 s44, s70, 236544
  buffer_load_dwordx4 v3, s[20:23], s44 offen lds
  ds_read_b64_tr_b16 a[146:147], v6 offset:9216
  ds_read_b64_tr_b16 a[148:149], v6 offset:8200
  s_add_u32 m0, m0, 1024
  s_add_u32 s44, s70, 344064
  buffer_load_dwordx4 v3, s[20:23], s44 offen lds
  ds_read_b64_tr_b16 a[150:151], v6 offset:9224
  ds_read_b64_tr_b16 a[152:153], v7 offset:8192
  s_add_u32 m0, m0, 1024
  s_add_u32 s44, s70, 351232
  buffer_load_dwordx4 v3, s[20:23], s44 offen lds
  ds_read_b64_tr_b16 a[154:155], v7 offset:9216
  ds_read_b64_tr_b16 a[156:157], v7 offset:8200
  ds_read_b64_tr_b16 a[158:159], v7 offset:9224
  s_waitcnt vmcnt(8)
  v_cmp_eq_u32 s[50:51], v14, v13
  s_nop 1
  s_andn2_b32 s6, 0xff, s50
  s_cbranch_scc1 L_rslow_45
L_rok_44:
  s_mul_i32 s6, s84, 114688
  s_add_u32 s6, s6, s93
  v_add_u32 v30, s6, v8
  buffer_load_dwordx4 v[128:131], v30, s[24:27], s72 offen sc1
  buffer_load_dwordx4 v[132:135], v30, s[24:27], s73 offen sc1
  buffer_load_dwordx4 v[136:139], v30, s[24:27], s74 offen sc1
  buffer_load_dwordx4 v[140:143], v30, s[24:27], s75 offen sc1
  buffer_load_dwordx4 v[144:147], v30, s[24:27], s76 offen sc1
  buffer_load_dwordx4 v[148:151], v30, s[24:27], s77 offen sc1
  buffer_load_dwordx4 v[152:155], v30, s[24:27], s78 offen sc1
  s_andn2_b32 s6, 0xff00, s50
  s_cbranch_scc1 L_rslow_47
L_rok_46:
  s_mul_i32 s6, s85, 114688
  s_add_u32 s6, s6, s93
  v_add_u32 v30, s6, v8
  buffer_load_dwordx4 v[156:159], v30, s[24:27], s72 offen sc1
  buffer_load_dwordx4 v[160:163], v30, s[24:27], s73 offen sc1
  buffer_load_dwordx4 v[164:167], v30, s[24:27], s74 offen sc1
  buffer_load_dwordx4 v[168:171], v30, s[24:27], s75 offen sc1
  buffer_load_dwordx4 v[172:175], v30, s[24:27], s76 offen sc1
  buffer_load_dwordx4 v[176:179], v30, s[24:27], s77 offen sc1
  buffer_load_dwordx4 v[180:183], v30, s[24:27], s78 offen sc1
  ds_read_b64_tr_b16 a[160:161], v4 offset:16384
  ds_read_b64_tr_b16 a[162:163], v4 offset:17408
  ds_read_b64_tr_b16 a[164:165], v4 offset:16392
  ds_read_b64_tr_b16 a[166:167], v4 offset:17416
  ds_read_b64_tr_b16 a[168:169], v5 offset:16384
  ds_read_b64_tr_b16 a[170:171], v5 offset:17408
  ds_read_b64_tr_b16 a[172:173], v5 offset:16392
  ds_read_b64_tr_b16 a[174:175], v5 offset:17416
  ds_read_b64_tr_b16 a[176:177], v6 offset:16384
  ds_read_b64_tr_b16 a[178:179], v6 offset:17408
  ds_read_b64_tr_b16 a[180:181], v6 offset:16392
  ds_read_b64_tr_b16 a[182:183], v6 offset:17416
  ds_read_b64_tr_b16 a[184:185], v7 offset:16384
  ds_read_b64_tr_b16 a[186:187], v7 offset:17408
  ds_read_b64_tr_b16 a[188:189], v7 offset:16392
  ds_read_b64_tr_b16 a[190:191], v7 offset:17416
  s_waitcnt vmcnt(14)
  ds_read_b64_tr_b16 a[192:193], v4 offset:0
  ds_read_b64_tr_b16 a[194:195], v4 offset:1024
  ds_read_b64_tr_b16 a[196:197], v4 offset:8
  ds_read_b64_tr_b16 a[198:199], v4 offset:1032
  ds_read_b64_tr_b16 a[200:201], v5 offset:0
  ds_read_b64_tr_b16 a[202:203], v5 offset:1024
  ds_read_b64_tr_b16 a[204:205], v5 offset:8
  ds_read_b64_tr_b16 a[206:207], v5 offset:1032
  ds_read_b64_tr_b16 a[208:209], v6 offset:0
  ds_read_b64_tr_b16 a[210:211], v6 offset:1024
  ds_read_b64_tr_b16 a[212:213], v6 offset:8
  ds_read_b64_tr_b16 a[214:215], v6 offset:1032
  ds_read_b64_tr_b16 a[216:217], v7 offset:0
  ds_read_b64_tr_b16 a[218:219], v7 offset:1024
  ds_read_b64_tr_b16 a[220:221], v7 offset:8
  ds_read_b64_tr_b16 a[222:223], v7 offset:1032
  s_waitcnt lgkmcnt(0)
L_g3:
  s_waitcnt vmcnt(7)
  v_mfma_f32_16x16x32_bf16 a[224:227], a[0:3], v[128:131], 0
  s_andn2_b32 s6, 0xff0000, s50
  s_cbranch_scc1 L_rslow_49
L_rok_48:
  v_mfma_f32_16x16x32_bf16 a[224:227], a[32:35], v[132:135], a[224:227]
  v_mfma_f32_16x16x32_bf16 a[224:227], a[64:67], v[136:139], a[224:227]
  v_mfma_f32_16x16x32_bf16 a[224:227], a[96:99], v[140:143], a[224:227]
  s_mul_i32 s6, s86, 114688
  s_add_u32 s6, s6, s93
  v_add_u32 v30, s6, v8
  buffer_load_dwordx4 v[184:187], v30, s[24:27], s72 offen sc1
  v_mfma_f32_16x16x32_bf16 a[224:227], a[128:131], v[144:147], a[224:227]
  v_mfma_f32_16x16x32_bf16 a[224:227], a[160:163], v[148:151], a[224:227]
  v_mfma_f32_16x16x32_bf16 a[224:227], a[192:195], v[152:155], a[224:227]
  v_mfma_f32_16x16x32_bf16 a[228:231], a[4:7], v[128:131], 0
  v_mfma_f32_16x16x32_bf16 a[228:231], a[36:39], v[132:135], a[228:231]
  v_mfma_f32_16x16x32_bf16 a[228:231], a[68:71], v[136:139], a[228:231]
  v_mfma_f32_16x16x32_bf16 a[228:231], a[100:103], v[140:143], a[228:231]
  buffer_load_dwordx4 v[188:191], v30, s[24:27], s73 offen sc1
  v_mfma_f32_16x16x32_bf16 a[228:231], a[132:135], v[144:147], a[228:231]
  v_mfma_f32_16x16x32_bf16 a[228:231], a[164:167], v[148:151], a[228:231]
  buffer_load_dword v14, v12, s[24:27], 0 offen sc1
  v_mfma_f32_16x16x32_bf16 a[228:231], a[196:199], v[152:155], a[228:231]
  v_mfma_f32_16x16x32_bf16 a[232:235], a[8:11], v[128:131], 0
  ds_write_b128 v9, a[224:227] offset:0
  v_mfma_f32_16x16x32_bf16 a[232:235], a[40:43], v[132:135], a[232:235]
  v_mfma_f32_16x16x32_bf16 a[232:235], a[72:75], v[136:139], a[232:235]
  v_mfma_f32_16x16x32_bf16 a[232:235], a[104:107], v[140:143], a[232:235]
  buffer_load_dwordx4 v[192:195], v30, s[24:27], s74 offen sc1
  v_mfma_f32_16x16x32_bf16 a[232:235], a[136:139], v[144:147], a[232:235]
  v_mfma_f32_16x16x32_bf16 a[232:235], a[168:171], v[148:151], a[232:235]
  v_mfma_f32_16x16x32_bf16 a[232:235], a[200:203], v[152:155], a[232:235]
  v_mfma_f32_16x16x32_bf16 a[236:239], a[12:15], v[128:131], 0
  ds_write_b128 v9, a[228:231] offset:1024
  v_mfma_f32_16x16x32_bf16 a[236:239], a[44:47], v[132:135], a[236:239]
  v_mfma_f32_16x16x32_bf16 a[236:239], a[76:79], v[136:139], a[236:239]
  v_mfma_f32_16x16x32_bf16 a[236:239], a[108:111], v[140:143], a[236:239]
  buffer_load_dwordx4 v[196:199], v30, s[24:27], s75 offen sc1
  v_mfma_f32_16x16x32_bf16 a[236:239], a[140:143], v[144:147], a[236:239]
  v_mfma_f32_16x16x32_bf16 a[236:239], a[172:175], v[148:151], a[236:239]
  v_mfma_f32_16x16x32_bf16 a[236:239], a[204:207], v[152:155], a[236:239]
  v_mfma_f32_16x16x32_bf16 a[240:243], a[16:19], v[128:131], 0
  ds_write_b128 v9, a[232:235] offset:2048
  v_mfma_f32_16x16x32_bf16 a[240:243], a[48:51], v[132:135], a[240:243]
  v_mfma_f32_16x16x32_bf16 a[240:243], a[80:83], v[136:139], a[240:243]
  v_mfma_f32_16x16x32_bf16 a[240:243], a[112:115], v[140:143], a[240:243]
  buffer_load_dwordx4 v[200:203], v30, s[24:27], s76 offen sc1
  v_mfma_f32_16x16x32_bf16 a[240:243], a[144:147], v[144:147], a[240:243]
  v_mfma_f32_16x16x32_bf16 a[240:243], a[176:179], v[148:151], a[240:243]
  v_mfma_f32_16x16x32_bf16 a[240:243], a[208:211], v[152:155], a[240:243]
  v_mfma_f32_16x16x32_bf16 a[244:247], a[20:23], v[128:131], 0
  ds_write_b128 v9, a[236:239] offset:3072
  v_mfma_f32_16x16x32_bf16 a[244:247], a[52:55], v[132:135], a[244:247]
  v_mfma_f32_16x16x32_bf16 a[244:247], a[84:87], v[136:139], a[244:247]
  v_mfma_f32_16x16x32_bf16 a[244:247], a[116:119], v[140:143], a[244:247]
  buffer_load_dwordx4 v[204:207], v30, s[24:27], s77 offen sc1
  v_mfma_f32_16x16x32_bf16 a[244:247], a[148:151], v[144:147], a[244:247]
  v_mfma_f32_16x16x32_bf16 a[244:247], a[180:183], v[148:151], a[244:247]
  v_mfma_f32_16x16x32_bf16 a[244:247], a[212:215], v[152:155], a[244:247]
  v_mfma_f32_16x16x32_bf16 v[244:247], a[24:27], v[128:131], 0
  ds_write_b128 v9, a[240:243] offset:4096
  v_mfma_f32_16x16x32_bf16 v[244:247], a[56:59], v[132:135], v[244:247]
  v_mfma_f32_16x16x32_bf16 v[244:247], a[88:91], v[136:139], v[244:247]
  v_mfma_f32_16x16x32_bf16 v[244:247], a[120:123], v[140:143], v[244:247]
  buffer_load_dwordx4 v[208:211], v30, s[24:27], s78 offen sc1
  v_mfma_f32_16x16x32_bf16 v[244:247], a[152:155], v[144:147], v[244:247]
  v_mfma_f32_16x16x32_bf16 v[244:247], a[184:187], v[148:151], v[244:247]
  v_mfma_f32_16x16x32_bf16 v[244:247], a[216:219], v[152:155], v[244:247]
  v_mfma_f32_16x16x32_bf16 v[248:251], a[28:31], v[128:131], 0
  ds_write_b128 v9, a[244:247] offset:5120
  v_mfma_f32_16x16x32_bf16 v[248:251], a[60:63], v[132:135], v[248:251]
  v_mfma_f32_16x16x32_bf16 v[248:251], a[92:95], v[136:139], v[248:251]
  v_mfma_f32_16x16x32_bf16 v[248:251], a[124:127], v[140:143], v[248:251]
  v_mfma_f32_16x16x32_bf16 v[248:251], a[156:159], v[144:147], v[248:251]
  s_mul_i32 s46, s87, 114688
  s_add_u32 s46, s46, s93
  v_mfma_f32_16x16x32_bf16 v[248:251], a[188:191], v[148:151], v[248:251]
  v_add_u32 v30, s46, v8
  v_mfma_f32_16x16x32_bf16 v[248:251], a[220:223], v[152:155], v[248:251]
  s_waitcnt vmcnt(8)
  v_mfma_f32_16x16x32_bf16 a[224:227], a[0:3], v[156:159], 0
  s_lshl_b32 s97, s84, 2
  s_add_u32 s97, s97, s62
  v_mfma_f32_16x16x32_bf16 a[224:227], a[32:35], v[160:163], a[224:227]
  s_waitcnt lgkmcnt(0)
  s_barrier
  v_mfma_f32_16x16x32_bf16 a[224:227], a[64:67], v[164:167], a[224:227]
  s_waitcnt vmcnt(5)
  v_cmp_eq_u32 s[50:51], v14, v13
  s_nop 1
  s_andn2_b32 s6, 0xff000000, s50
  s_cbranch_scc1 L_rslow_51
L_rok_50:
  ds_read_b128 v[96:99], v16 offset:0
  v_mfma_f32_16x16x32_bf16 a[224:227], a[96:99], v[168:171], a[224:227]
  buffer_load_dwordx4 v[128:131], v30, s[24:27], s72 offen sc1
  ds_read_b128 v[100:103], v16 offset:1024
  v_mfma_f32_16x16x32_bf16 a[224:227], a[128:131], v[172:175], a[224:227]
  ds_read_b128 v[104:107], v17 offset:0
  v_mfma_f32_16x16x32_bf16 a[224:227], a[160:163], v[176:179], a[224:227]
  ds_read_b128 v[108:111], v17 offset:1024
  v_mfma_f32_16x16x32_bf16 a[224:227], a[192:195], v[180:183], a[224:227]
  ds_read_b128 v[112:115], v18 offset:0
  v_mfma_f32_16x16x32_bf16 a[228:231], a[4:7], v[156:159], 0
  ds_read_b128 v[116:119], v18 offset:1024
  v_mfma_f32_16x16x32_bf16 a[228:231], a[36:39], v[160:163], a[228:231]
  v_mfma_f32_16x16x32_bf16 a[228:231], a[68:71], v[164:167], a[228:231]
  s_lshl_b32 s97, s97, 13
  s_add_u32 s97, s97, s92
  v_mfma_f32_16x16x32_bf16 a[228:231], a[100:103], v[168:171], a[228:231]
  buffer_load_dwordx4 v[132:135], v30, s[24:27], s73 offen sc1
  v_mfma_f32_16x16x32_bf16 a[228:231], a[132:135], v[172:175], a[228:231]
  v_mfma_f32_16x16x32_bf16 a[228:231], a[164:167], v[176:179], a[228:231]
  s_waitcnt lgkmcnt(2)
  v_add_f32 v96, v96, v104
  v_mfma_f32_16x16x32_bf16 a[228:231], a[196:199], v[180:183], a[228:231]
  v_add_f32 v97, v97, v105
  v_add_f32 v98, v98, v106
  v_mfma_f32_16x16x32_bf16 a[232:235], a[8:11], v[156:159], 0
  ds_write_b128 v9, a[224:227] offset:32768
  v_add_f32 v99, v99, v107
  v_mfma_f32_16x16x32_bf16 a[232:235], a[40:43], v[160:163], a[232:235]
  v_add_f32 v100, v100, v108
  v_add_f32 v101, v101, v109
  v_mfma_f32_16x16x32_bf16 a[232:235], a[72:75], v[164:167], a[232:235]
  v_add_f32 v102, v102, v110
  v_add_f32 v103, v103, v111
  v_mfma_f32_16x16x32_bf16 a[232:235], a[104:107], v[168:171], a[232:235]
  buffer_load_dwordx4 v[136:139], v30, s[24:27], s74 offen sc1
  s_waitcnt lgkmcnt(1)
  v_mfma_f32_16x16x32_bf16 a[232:235], a[136:139], v[172:175], a[232:235]
  v_add_f32 v96, v96, v112
  v_add_f32 v97, v97, v113
  v_mfma_f32_16x16x32_bf16 a[232:235], a[168:171], v[176:179], a[232:235]
  v_add_f32 v98, v98, v114
  v_add_f32 v99, v99, v115
  v_mfma_f32_16x16x32_bf16 a[232:235], a[200:203], v[180:183], a[232:235]
  v_add_f32 v100, v100, v116
  v_add_f32 v101, v101, v117
  v_mfma_f32_16x16x32_bf16 a[236:239], a[12:15], v[156:159], 0
  ds_write_b128 v9, a[228:231] offset:33792
  v_add_f32 v102, v102, v118
  v_mfma_f32_16x16x32_bf16 a[236:239], a[44:47], v[160:163], a[236:239]
  v_add_f32 v103, v103, v119
  v_add_f32 v96, v96, v244
  v_mfma_f32_16x16x32_bf16 a[236:239], a[76:79], v[164:167], a[236:239]
  v_add_f32 v97, v97, v245
  v_add_f32 v98, v98, v246
  v_mfma_f32_16x16x32_bf16 a[236:239], a[108:111], v[168:171], a[236:239]
  buffer_load_dwordx4 v[140:143], v30, s[24:27], s75 offen sc1
  v_add_f32 v99, v99, v247
  v_mfma_f32_16x16x32_bf16 a[236:239], a[140:143], v[172:175], a[236:239]
  v_add_f32 v100, v100, v248
  v_add_f32 v101, v101, v249
  v_mfma_f32_16x16x32_bf16 a[236:239], a[172:175], v[176:179], a[236:239]
  v_add_f32 v102, v102, v250
  v_add_f32 v103, v103, v251
  v_mfma_f32_16x16x32_bf16 a[236:239], a[204:207], v[180:183], a[236:239]
  v_perm_b32 v104, v96, v13, s52
  v_perm_b32 v105, v97, v13, s53
  v_mfma_f32_16x16x32_bf16 a[240:243], a[16:19], v[156:159], 0
  ds_write_b128 v9, a[232:235] offset:34816
  v_perm_b32 v106, v98, v13, s54
  v_mfma_f32_16x16x32_bf16 a[240:243], a[48:51], v[160:163], a[240:243]
  v_perm_b32 v107, v99, v13, s55
  v_perm_b32 v108, v100, v13, s52
  v_mfma_f32_16x16x32_bf16 a[240:243], a[80:83], v[164:167], a[240:243]
  v_perm_b32 v109, v101, v13, s53
  v_perm_b32 v110, v102, v13, s54
  v_mfma_f32_16x16x32_bf16 a[240:243], a[112:115], v[168:171], a[240:243]
  buffer_load_dwordx4 v[144:147], v30, s[24:27], s76 offen sc1
  v_perm_b32 v111, v103, v13, s55
  v_mfma_f32_16x16x32_bf16 a[240:243], a[144:147], v[172:175], a[240:243]
  v_mfma_f32_16x16x32_bf16 a[240:243], a[176:179], v[176:179], a[240:243]
  v_mfma_f32_16x16x32_bf16 a[240:243], a[208:211], v[180:183], a[240:243]
  v_mfma_f32_16x16x32_bf16 a[244:247], a[20:23], v[156:159], 0
  ds_write_b128 v9, a[236:239] offset:35840
  v_mfma_f32_16x16x32_bf16 a[244:247], a[52:55], v[160:163], a[244:247]
  v_mfma_f32_16x16x32_bf16 a[244:247], a[84:87], v[164:167], a[244:247]
  v_mfma_f32_16x16x32_bf16 a[244:247], a[116:119], v[168:171], a[244:247]
  buffer_load_dwordx4 v[148:151], v30, s[24:27], s77 offen sc1
  v_mfma_f32_16x16x32_bf16 a[244:247], a[148:151], v[172:175], a[244:247]
  v_mfma_f32_16x16x32_bf16 a[244:247], a[180:183], v[176:179], a[244:247]
  v_mfma_f32_16x16x32_bf16 a[244:247], a[212:215], v[180:183], a[244:247]
  buffer_store_dwordx4 v[104:107], v8, s[24:27], s97 offen offset:0 sc1
  v_mfma_f32_16x16x32_bf16 v[244:247], a[24:27], v[156:159], 0
  ds_write_b128 v9, a[240:243] offset:36864
  v_mfma_f32_16x16x32_bf16 v[244:247], a[56:59], v[160:163], v[244:247]
  v_mfma_f32_16x16x32_bf16 v[244:247], a[88:91], v[164:167], v[244:247]
  v_mfma_f32_16x16x32_bf16 v[244:247], a[120:123], v[168:171], v[244:247]
  buffer_load_dwordx4 v[152:155], v30, s[24:27], s78 offen sc1
  v_mfma_f32_16x16x32_bf16 v[244:247], a[152:155], v[172:175], v[244:247]
  v_mfma_f32_16x16x32_bf16 v[244:247], a[184:187], v[176:179], v[244:247]
  v_mfma_f32_16x16x32_bf16 v[244:247], a[216:219], v[180:183], v[244:247]
  v_mfma_f32_16x16x32_bf16 v[248:251], a[28:31], v[156:159], 0
  ds_write_b128 v9, a[244:247] offset:37888
  v_mfma_f32_16x16x32_bf16 v[248:251], a[60:63], v[160:163], v[248:251]
  v_mfma_f32_16x16x32_bf16 v[248:251], a[92:95], v[164:167], v[248:251]
  v_mfma_f32_16x16x32_bf16 v[248:251], a[124:127], v[168:171], v[248:251]
  buffer_store_dwordx4 v[108:111], v8, s[24:27], s97 offen offset:1024 sc1
  v_mfma_f32_16x16x32_bf16 v[248:251], a[156:159], v[172:175], v[248:251]
  s_mul_i32 s46, s88, 114688
  s_add_u32 s46, s46, s93
  v_mfma_f32_16x16x32_bf16 v[248:251], a[188:191], v[176:179], v[248:251]
  v_add_u32 v30, s46, v8
  v_mfma_f32_16x16x32_bf16 v[248:251], a[220:223], v[180:183], v[248:251]
  s_andn2_b32 s6, 0xff, s51
  s_cbranch_scc1 L_rslow_53
L_rok_52:
  s_waitcnt vmcnt(9)
  v_mfma_f32_16x16x32_bf16 a[224:227], a[0:3], v[184:187], 0
  s_lshl_b32 s97, s85, 2
  s_add_u32 s97, s97, s62
  v_mfma_f32_16x16x32_bf16 a[224:227], a[32:35], v[188:191], a[224:227]
  s_waitcnt lgkmcnt(0)
  s_barrier
  v_mfma_f32_16x16x32_bf16 a[224:227], a[64:67], v[192:195], a[224:227]
  ds_read_b128 v[96:99], v16 offset:32768
  v_mfma_f32_16x16x32_bf16 a[224:227], a[96:99], v[196:199], a[224:227]
  buffer_load_dwordx4 v[156:159], v30, s[24:27], s72 offen sc1
  ds_read_b128 v[100:103], v16 offset:33792
  v_mfma_f32_16x16x32_bf16 a[224:227], a[128:131], v[200:203], a[224:227]
  ds_read_b128 v[104:107], v17 offset:32768
  v_mfma_f32_16x16x32_bf16 a[224:227], a[160:163], v[204:207], a[224:227]
  ds_read_b128 v[108:111], v17 offset:33792
  v_mfma_f32_16x16x32_bf16 a[224:227], a[192:195], v[208:211], a[224:227]
  ds_read_b128 v[112:115], v18 offset:32768
  v_mfma_f32_16x16x32_bf16 a[228:231], a[4:7], v[184:187], 0
  ds_read_b128 v[116:119], v18 offset:33792
  v_mfma_f32_16x16x32_bf16 a[228:231], a[36:39], v[188:191], a[228:231]
  v_mfma_f32_16x16x32_bf16 a[228:231], a[68:71], v[192:195], a[228:231]
  s_lshl_b32 s97, s97, 13
  s_add_u32 s97, s97, s92
  v_mfma_f32_16x16x32_bf16 a[228:231], a[100:103], v[196:199], a[228:231]
  buffer_load_dwordx4 v[160:163], v30, s[24:27], s73 offen sc1
  v_mfma_f32_16x16x32_bf16 a[228:231], a[132:135], v[200:203], a[228:231]
  v_mfma_f32_16x16x32_bf16 a[228:231], a[164:167], v[204:207], a[228:231]
  s_waitcnt lgkmcnt(2)
  v_add_f32 v96, v96, v104
  v_mfma_f32_16x16x32_bf16 a[228:231], a[196:199], v[208:211], a[228:231]
  v_add_f32 v97, v97, v105
  v_add_f32 v98, v98, v106
  v_mfma_f32_16x16x32_bf16 a[232:235], a[8:11], v[184:187], 0
  ds_write_b128 v9, a[224:227] offset:0
  v_add_f32 v99, v99, v107
  v_mfma_f32_16x16x32_bf16 a[232:235], a[40:43], v[188:191], a[232:235]
  v_add_f32 v100, v100, v108
  v_add_f32 v101, v101, v109
  v_mfma_f32_16x16x32_bf16 a[232:235], a[72:75], v[192:195], a[232:235]
  v_add_f32 v102, v102, v110
  v_add_f32 v103, v103, v111
  v_mfma_f32_16x16x32_bf16 a[232:235], a[104:107], v[196:199], a[232:235]
  buffer_load_dwordx4 v[164:167], v30, s[24:27], s74 offen sc1
  s_waitcnt lgkmcnt(1)
  v_mfma_f32_16x16x32_bf16 a[232:235], a[136:139], v[200:203], a[232:235]
  v_add_f32 v96, v96, v112
  v_add_f32 v97, v97, v113
  v_mfma_f32_16x16x32_bf16 a[232:235], a[168:171], v[204:207], a[232:235]
  v_add_f32 v98, v98, v114
  v_add_f32 v99, v99, v115
  v_mfma_f32_16x16x32_bf16 a[232:235], a[200:203], v[208:211], a[232:235]
  v_add_f32 v100, v100, v116
  v_add_f32 v101, v101, v117
  v_mfma_f32_16x16x32_bf16 a[236:239], a[12:15], v[184:187], 0
  ds_write_b128 v9, a[228:231] offset:1024
  v_add_f32 v102, v102, v118
  v_mfma_f32_16x16x32_bf16 a[236:239], a[44:47], v[188:191], a[236:239]
  v_add_f32 v103, v103, v119
  v_add_f32 v96, v96, v244
  v_mfma_f32_16x16x32_bf16 a[236:239], a[76:79], v[192:195], a[236:239]
  v_add_f32 v97, v97, v245
  v_add_f32 v98, v98, v246
  v_mfma_f32_16x16x32_bf16 a[236:239], a[108:111], v[196:199], a[236:239]
  buffer_load_dwordx4 v[168:171], v30, s[24:27], s75 offen sc1
  v_add_f32 v99, v99, v247
  v_mfma_f32_16x16x32_bf16 a[236:239], a[140:143], v[200:203], a[236:239]
  v_add_f32 v100, v100, v248
  v_add_f32 v101, v101, v249
  v_mfma_f32_16x16x32_bf16 a[236:239], a[172:175], v[204:207], a[236:239]
  v_add_f32 v102, v102, v250
  v_add_f32 v103, v103, v251
  v_mfma_f32_16x16x32_bf16 a[236:239], a[204:207], v[208:211], a[236:239]
  v_perm_b32 v104, v96, v13, s52
  v_perm_b32 v105, v97, v13, s53
  v_mfma_f32_16x16x32_bf16 a[240:243], a[16:19], v[184:187], 0
  ds_write_b128 v9, a[232:235] offset:2048
  v_perm_b32 v106, v98, v13, s54
  v_mfma_f32_16x16x32_bf16 a[240:243], a[48:51], v[188:191], a[240:243]
  v_perm_b32 v107, v99, v13, s55
  v_perm_b32 v108, v100, v13, s52
  v_mfma_f32_16x16x32_bf16 a[240:243], a[80:83], v[192:195], a[240:243]
  v_perm_b32 v109, v101, v13, s53
  v_perm_b32 v110, v102, v13, s54
  v_mfma_f32_16x16x32_bf16 a[240:243], a[112:115], v[196:199], a[240:243]
  buffer_load_dwordx4 v[172:175], v30, s[24:27], s76 offen sc1
  v_perm_b32 v111, v103, v13, s55
  v_mfma_f32_16x16x32_bf16 a[240:243], a[144:147], v[200:203], a[240:243]
  v_mfma_f32_16x16x32_bf16 a[240:243], a[176:179], v[204:207], a[240:243]
  v_mfma_f32_16x16x32_bf16 a[240:243], a[208:211], v[208:211], a[240:243]
  v_mfma_f32_16x16x32_bf16 a[244:247], a[20:23], v[184:187], 0
  ds_write_b128 v9, a[236:239] offset:3072
  v_mfma_f32_16x16x32_bf16 a[244:247], a[52:55], v[188:191], a[244:247]
  v_mfma_f32_16x16x32_bf16 a[244:247], a[84:87], v[192:195], a[244:247]
  v_mfma_f32_16x16x32_bf16 a[244:247], a[116:119], v[196:199], a[244:247]
  buffer_load_dwordx4 v[176:179], v30, s[24:27], s77 offen sc1
  v_mfma_f32_16x16x32_bf16 a[244:247], a[148:151], v[200:203], a[244:247]
  v_mfma_f32_16x16x32_bf16 a[244:247], a[180:183], v[204:207], a[244:247]
  v_mfma_f32_16x16x32_bf16 a[244:247], a[212:215], v[208:211], a[244:247]
  buffer_store_dwordx4 v[104:107], v8, s[24:27], s97 offen offset:0 sc1
  v_mfma_f32_16x16x32_bf16 v[244:247], a[24:27], v[184:187], 0
  ds_write_b128 v9, a[240:243] offset:4096
  v_mfma_f32_16x16x32_bf16 v[244:247], a[56:59], v[188:191], v[244:247]
  v_mfma_f32_16x16x32_bf16 v[244:247], a[88:91], v[192:195], v[244:247]
  v_mfma_f32_16x16x32_bf16 v[244:247], a[120:123], v[196:199], v[244:247]
  buffer_load_dwordx4 v[180:183], v30, s[24:27], s78 offen sc1
  v_mfma_f32_16x16x32_bf16 v[244:247], a[152:155], v[200:203], v[244:247]
  v_mfma_f32_16x16x32_bf16 v[244:247], a[184:187], v[204:207], v[244:247]
  v_mfma_f32_16x16x32_bf16 v[244:247], a[216:219], v[208:211], v[244:247]
  v_mfma_f32_16x16x32_bf16 v[248:251], a[28:31], v[184:187], 0
  ds_write_b128 v9, a[244:247] offset:5120
  v_mfma_f32_16x16x32_bf16 v[248:251], a[60:63], v[188:191], v[248:251]
  v_mfma_f32_16x16x32_bf16 v[248:251], a[92:95], v[192:195], v[248:251]
  v_mfma_f32_16x16x32_bf16 v[248:251], a[124:127], v[196:199], v[248:251]
  buffer_store_dwordx4 v[108:111], v8, s[24:27], s97 offen offset:1024 sc1
  v_mfma_f32_16x16x32_bf16 v[248:251], a[156:159], v[200:203], v[248:251]
  s_mul_i32 s46, s89, 114688
  s_add_u32 s46, s46, s93
  v_mfma_f32_16x16x32_bf16 v[248:251], a[188:191], v[204:207], v[248:251]
  v_add_u32 v30, s46, v8
  v_mfma_f32_16x16x32_bf16 v[248:251], a[220:223], v[208:211], v[248:251]
  s_andn2_b32 s6, 0xff00, s51
  s_cbranch_scc1 L_rslow_55
L_rok_54:
  s_waitcnt vmcnt(10)
  v_mfma_f32_16x16x32_bf16 a[224:227], a[0:3], v[128:131], 0
  s_lshl_b32 s97, s86, 2
  s_add_u32 s97, s97, s62
  v_mfma_f32_16x16x32_bf16 a[224:227], a[32:35], v[132:135], a[224:227]
  s_waitcnt lgkmcnt(0)
  s_barrier
  v_mfma_f32_16x16x32_bf16 a[224:227], a[64:67], v[136:139], a[224:227]
  ds_read_b128 v[96:99], v16 offset:0
  v_mfma_f32_16x16x32_bf16 a[224:227], a[96:99], v[140:143], a[224:227]
  buffer_load_dwordx4 v[184:187], v30, s[24:27], s72 offen sc1
  ds_read_b128 v[100:103], v16 offset:1024
  v_mfma_f32_16x16x32_bf16 a[224:227], a[128:131], v[144:147], a[224:227]
  ds_read_b128 v[104:107], v17 offset:0
  v_mfma_f32_16x16x32_bf16 a[224:227], a[160:163], v[148:151], a[224:227]
  ds_read_b128 v[108:111], v17 offset:1024
  v_mfma_f32_16x16x32_bf16 a[224:227], a[192:195], v[152:155], a[224:227]
  ds_read_b128 v[112:115], v18 offset:0
  v_mfma_f32_16x16x32_bf16 a[228:231], a[4:7], v[128:131], 0
  ds_read_b128 v[116:119], v18 offset:1024
  v_mfma_f32_16x16x32_bf16 a[228:231], a[36:39], v[132:135], a[228:231]
  v_mfma_f32_16x16x32_bf16 a[228:231], a[68:71], v[136:139], a[228:231]
  s_lshl_b32 s97, s97, 13
  s_add_u32 s97, s97, s92
  v_mfma_f32_16x16x32_bf16 a[228:231], a[100:103], v[140:143], a[228:231]
  buffer_load_dwordx4 v[188:191], v30, s[24:27], s73 offen sc1
  v_mfma_f32_16x16x32_bf16 a[228:231], a[132:135], v[144:147], a[228:231]
  v_mfma_f32_16x16x32_bf16 a[228:231], a[164:167], v[148:151], a[228:231]
  s_waitcnt lgkmcnt(2)
  v_add_f32 v96, v96, v104
  v_mfma_f32_16x16x32_bf16 a[228:231], a[196:199], v[152:155], a[228:231]
  v_add_f32 v97, v97, v105
  v_add_f32 v98, v98, v106
  v_mfma_f32_16x16x32_bf16 a[232:235], a[8:11], v[128:131], 0
  ds_write_b128 v9, a[224:227] offset:32768
  v_add_f32 v99, v99, v107
  v_mfma_f32_16x16x32_bf16 a[232:235], a[40:43], v[132:135], a[232:235]
  v_add_f32 v100, v100, v108
  v_add_f32 v101, v101, v109
  v_mfma_f32_16x16x32_bf16 a[232:235], a[72:75], v[136:139], a[232:235]
  v_add_f32 v102, v102, v110
  v_add_f32 v103, v103, v111
  v_mfma_f32_16x16x32_bf16 a[232:235], a[104:107], v[140:143], a[232:235]
  buffer_load_dwordx4 v[192:195], v30, s[24:27], s74 offen sc1
  s_waitcnt lgkmcnt(1)
  v_mfma_f32_16x16x32_bf16 a[232:235], a[136:139], v[144:147], a[232:235]
  v_add_f32 v96, v96, v112
  v_add_f32 v97, v97, v113
  v_mfma_f32_16x16x32_bf16 a[232:235], a[168:171], v[148:151], a[232:235]
  v_add_f32 v98, v98, v114
  v_add_f32 v99, v99, v115
  v_mfma_f32_16x16x32_bf16 a[232:235], a[200:203], v[152:155], a[232:235]
  v_add_f32 v100, v100, v116
  v_add_f32 v101, v101, v117
  v_mfma_f32_16x16x32_bf16 a[236:239], a[12:15], v[128:131], 0
  ds_write_b128 v9, a[228:231] offset:33792
  v_add_f32 v102, v102, v118
  v_mfma_f32_16x16x32_bf16 a[236:239], a[44:47], v[132:135], a[236:239]
  v_add_f32 v103, v103, v119
  v_add_f32 v96, v96, v244
  v_mfma_f32_16x16x32_bf16 a[236:239], a[76:79], v[136:139], a[236:239]
  v_add_f32 v97, v97, v245
  v_add_f32 v98, v98, v246
  v_mfma_f32_16x16x32_bf16 a[236:239], a[108:111], v[140:143], a[236:239]
  buffer_load_dwordx4 v[196:199], v30, s[24:27], s75 offen sc1
  v_add_f32 v99, v99, v247
  v_mfma_f32_16x16x32_bf16 a[236:239], a[140:143], v[144:147], a[236:239]
  v_add_f32 v100, v100, v248
  v_add_f32 v101, v101, v249
  v_mfma_f32_16x16x32_bf16 a[236:239], a[172:175], v[148:151], a[236:239]
  v_add_f32 v102, v102, v250
  v_add_f32 v103, v103, v251
  v_mfma_f32_16x16x32_bf16 a[236:239], a[204:207], v[152:155], a[236:239]
  v_perm_b32 v104, v96, v13, s52
  v_perm_b32 v105, v97, v13, s53
  v_mfma_f32_16x16x32_bf16 a[240:243], a[16:19], v[128:131], 0
  ds_write_b128 v9, a[232:235] offset:34816
  v_perm_b32 v106, v98, v13, s54
  v_mfma_f32_16x16x32_bf16 a[240:243], a[48:51], v[132:135], a[240:243]
  v_perm_b32 v107, v99, v13, s55
  v_perm_b32 v108, v100, v13, s52
  v_mfma_f32_16x16x32_bf16 a[240:243], a[80:83], v[136:139], a[240:243]
  v_perm_b32 v109, v101, v13, s53
  v_perm_b32 v110, v102, v13, s54
  v_mfma_f32_16x16x32_bf16 a[240:243], a[112:115], v[140:143], a[240:243]
  buffer_load_dwordx4 v[200:203], v30, s[24:27], s76 offen sc1
  v_perm_b32 v111, v103, v13, s55
  v_mfma_f32_16x16x32_bf16 a[240:243], a[144:147], v[144:147], a[240:243]
  v_mfma_f32_16x16x32_bf16 a[240:243], a[176:179], v[148:151], a[240:243]
  v_mfma_f32_16x16x32_bf16 a[240:243], a[208:211], v[152:155], a[240:243]
  v_mfma_f32_16x16x32_bf16 a[244:247], a[20:23], v[128:131], 0
  ds_write_b128 v9, a[236:239] offset:35840
  v_mfma_f32_16x16x32_bf16 a[244:247], a[52:55], v[132:135], a[244:247]
  v_mfma_f32_16x16x32_bf16 a[244:247], a[84:87], v[136:139], a[244:247]
  v_mfma_f32_16x16x32_bf16 a[244:247], a[116:119], v[140:143], a[244:247]
  buffer_load_dwordx4 v[204:207], v30, s[24:27], s77 offen sc1
  v_mfma_f32_16x16x32_bf16 a[244:247], a[148:151], v[144:147], a[244:247]
  v_mfma_f32_16x16x32_bf16 a[244:247], a[180:183], v[148:151], a[244:247]
  v_mfma_f32_16x16x32_bf16 a[244:247], a[212:215], v[152:155], a[244:247]
  buffer_store_dwordx4 v[104:107], v8, s[24:27], s97 offen offset:0 sc1
  v_mfma_f32_16x16x32_bf16 v[244:247], a[24:27], v[128:131], 0
  ds_write_b128 v9, a[240:243] offset:36864
  v_mfma_f32_16x16x32_bf16 v[244:247], a[56:59], v[132:135], v[244:247]
  v_mfma_f32_16x16x32_bf16 v[244:247], a[88:91], v[136:139], v[244:247]
  v_mfma_f32_16x16x32_bf16 v[244:247], a[120:123], v[140:143], v[244:247]
  buffer_load_dwordx4 v[208:211], v30, s[24:27], s78 offen sc1
  v_mfma_f32_16x16x32_bf16 v[244:247], a[152:155], v[144:147], v[244:247]
  v_mfma_f32_16x16x32_bf16 v[244:247], a[184:187], v[148:151], v[244:247]
  v_mfma_f32_16x16x32_bf16 v[244:247], a[216:219], v[152:155], v[244:247]
  v_mfma_f32_16x16x32_bf16 v[248:251], a[28:31], v[128:131], 0
  ds_write_b128 v9, a[244:247] offset:37888
  v_mfma_f32_16x16x32_bf16 v[248:251], a[60:63], v[132:135], v[248:251]
  v_mfma_f32_16x16x32_bf16 v[248:251], a[92:95], v[136:139], v[248:251]
  v_mfma_f32_16x16x32_bf16 v[248:251], a[124:127], v[140:143], v[248:251]
  buffer_store_dwordx4 v[108:111], v8, s[24:27], s97 offen offset:1024 sc1
  v_mfma_f32_16x16x32_bf16 v[248:251], a[156:159], v[144:147], v[248:251]
  s_mul_i32 s46, s90, 114688
  s_add_u32 s46, s46, s93
  v_mfma_f32_16x16x32_bf16 v[248:251], a[188:191], v[148:151], v[248:251]
  v_add_u32 v30, s46, v8
  v_mfma_f32_16x16x32_bf16 v[248:251], a[220:223], v[152:155], v[248:251]
  s_andn2_b32 s6, 0xff0000, s51
  s_cbranch_scc1 L_rslow_57
L_rok_56:
  s_waitcnt vmcnt(10)
  v_mfma_f32_16x16x32_bf16 a[224:227], a[0:3], v[156:159], 0
  s_lshl_b32 s97, s87, 2
  s_add_u32 s97, s97, s62
  v_mfma_f32_16x16x32_bf16 a[224:227], a[32:35], v[160:163], a[224:227]
  s_waitcnt lgkmcnt(0)
  s_barrier
  v_mfma_f32_16x16x32_bf16 a[224:227], a[64:67], v[164:167], a[224:227]
  ds_read_b128 v[96:99], v16 offset:32768
  v_mfma_f32_16x16x32_bf16 a[224:227], a[96:99], v[168:171], a[224:227]
  buffer_load_dwordx4 v[128:131], v30, s[24:27], s72 offen sc1
  ds_read_b128 v[100:103], v16 offset:33792
  v_mfma_f32_16x16x32_bf16 a[224:227], a[128:131], v[172:175], a[224:227]
  ds_read_b128 v[104:107], v17 offset:32768
  v_mfma_f32_16x16x32_bf16 a[224:227], a[160:163], v[176:179], a[224:227]
  ds_read_b128 v[108:111], v17 offset:33792
  v_mfma_f32_16x16x32_bf16 a[224:227], a[192:195], v[180:183], a[224:227]
  ds_read_b128 v[112:115], v18 offset:32768
  v_mfma_f32_16x16x32_bf16 a[228:231], a[4:7], v[156:159], 0
  ds_read_b128 v[116:119], v18 offset:33792
  v_mfma_f32_16x16x32_bf16 a[228:231], a[36:39], v[160:163], a[228:231]
  v_mfma_f32_16x16x32_bf16 a[228:231], a[68:71], v[164:167], a[228:231]
  s_lshl_b32 s97, s97, 13
  s_add_u32 s97, s97, s92
  v_mfma_f32_16x16x32_bf16 a[228:231], a[100:103], v[168:171], a[228:231]
  buffer_load_dwordx4 v[132:135], v30, s[24:27], s73 offen sc1
  v_mfma_f32_16x16x32_bf16 a[228:231], a[132:135], v[172:175], a[228:231]
  v_mfma_f32_16x16x32_bf16 a[228:231], a[164:167], v[176:179], a[228:231]
  s_waitcnt lgkmcnt(2)
  v_add_f32 v96, v96, v104
  v_mfma_f32_16x16x32_bf16 a[228:231], a[196:199], v[180:183], a[228:231]
  v_add_f32 v97, v97, v105
  v_add_f32 v98, v98, v106
  v_mfma_f32_16x16x32_bf16 a[232:235], a[8:11], v[156:159], 0
  ds_write_b128 v9, a[224:227] offset:0
  v_add_f32 v99, v99, v107
  v_mfma_f32_16x16x32_bf16 a[232:235], a[40:43], v[160:163], a[232:235]
  v_add_f32 v100, v100, v108
  v_add_f32 v101, v101, v109
  v_mfma_f32_16x16x32_bf16 a[232:235], a[72:75], v[164:167], a[232:235]
  v_add_f32 v102, v102, v110
  v_add_f32 v103, v103, v111
  v_mfma_f32_16x16x32_bf16 a[232:235], a[104:107], v[168:171], a[232:235]
  buffer_load_dwordx4 v[136:139], v30, s[24:27], s74 offen sc1
  s_waitcnt lgkmcnt(1)
  v_mfma_f32_16x16x32_bf16 a[232:235], a[136:139], v[172:175], a[232:235]
  v_add_f32 v96, v96, v112
  v_add_f32 v97, v97, v113
  v_mfma_f32_16x16x32_bf16 a[232:235], a[168:171], v[176:179], a[232:235]
  v_add_f32 v98, v98, v114
  v_add_f32 v99, v99, v115
  v_mfma_f32_16x16x32_bf16 a[232:235], a[200:203], v[180:183], a[232:235]
  v_add_f32 v100, v100, v116
  v_add_f32 v101, v101, v117
  v_mfma_f32_16x16x32_bf16 a[236:239], a[12:15], v[156:159], 0
  ds_write_b128 v9, a[228:231] offset:1024
  v_add_f32 v102, v102, v118
  v_mfma_f32_16x16x32_bf16 a[236:239], a[44:47], v[160:163], a[236:239]
  v_add_f32 v103, v103, v119
  v_add_f32 v96, v96, v244
  v_mfma_f32_16x16x32_bf16 a[236:239], a[76:79], v[164:167], a[236:239]
  v_add_f32 v97, v97, v245
  v_add_f32 v98, v98, v246
  v_mfma_f32_16x16x32_bf16 a[236:239], a[108:111], v[168:171], a[236:239]
  buffer_load_dwordx4 v[140:143], v30, s[24:27], s75 offen sc1
  v_add_f32 v99, v99, v247
  v_mfma_f32_16x16x32_bf16 a[236:239], a[140:143], v[172:175], a[236:239]
  v_add_f32 v100, v100, v248
  v_add_f32 v101, v101, v249
  v_mfma_f32_16x16x32_bf16 a[236:239], a[172:175], v[176:179], a[236:239]
  v_add_f32 v102, v102, v250
  v_add_f32 v103, v103, v251
  v_mfma_f32_16x16x32_bf16 a[236:239], a[204:207], v[180:183], a[236:239]
  v_perm_b32 v104, v96, v13, s52
  v_perm_b32 v105, v97, v13, s53
  v_mfma_f32_16x16x32_bf16 a[240:243], a[16:19], v[156:159], 0
  ds_write_b128 v9, a[232:235] offset:2048
  v_perm_b32 v106, v98, v13, s54
  v_mfma_f32_16x16x32_bf16 a[240:243], a[48:51], v[160:163], a[240:243]
  v_perm_b32 v107, v99, v13, s55
  v_perm_b32 v108, v100, v13, s52
  v_mfma_f32_16x16x32_bf16 a[240:243], a[80:83], v[164:167], a[240:243]
  v_perm_b32 v109, v101, v13, s53
  v_perm_b32 v110, v102, v13, s54
  v_mfma_f32_16x16x32_bf16 a[240:243], a[112:115], v[168:171], a[240:243]
  buffer_load_dwordx4 v[144:147], v30, s[24:27], s76 offen sc1
  v_perm_b32 v111, v103, v13, s55
  v_mfma_f32_16x16x32_bf16 a[240:243], a[144:147], v[172:175], a[240:243]
  v_mfma_f32_16x16x32_bf16 a[240:243], a[176:179], v[176:179], a[240:243]
  v_mfma_f32_16x16x32_bf16 a[240:243], a[208:211], v[180:183], a[240:243]
  v_mfma_f32_16x16x32_bf16 a[244:247], a[20:23], v[156:159], 0
  ds_write_b128 v9, a[236:239] offset:3072
  v_mfma_f32_16x16x32_bf16 a[244:247], a[52:55], v[160:163], a[244:247]
  v_mfma_f32_16x16x32_bf16 a[244:247], a[84:87], v[164:167], a[244:247]
  v_mfma_f32_16x16x32_bf16 a[244:247], a[116:119], v[168:171], a[244:247]
  buffer_load_dwordx4 v[148:151], v30, s[24:27], s77 offen sc1
  v_mfma_f32_16x16x32_bf16 a[244:247], a[148:151], v[172:175], a[244:247]
  v_mfma_f32_16x16x32_bf16 a[244:247], a[180:183], v[176:179], a[244:247]
  v_mfma_f32_16x16x32_bf16 a[244:247], a[212:215], v[180:183], a[244:247]
  buffer_store_dwordx4 v[104:107], v8, s[24:27], s97 offen offset:0 sc1
  v_mfma_f32_16x16x32_bf16 v[244:247], a[24:27], v[156:159], 0
  ds_write_b128 v9, a[240:243] offset:4096
  v_mfma_f32_16x16x32_bf16 v[244:247], a[56:59], v[160:163], v[244:247]
  v_mfma_f32_16x16x32_bf16 v[244:247], a[88:91], v[164:167], v[244:247]
  v_mfma_f32_16x16x32_bf16 v[244:247], a[120:123], v[168:171], v[244:247]
  buffer_load_dwordx4 v[152:155], v30, s[24:27], s78 offen sc1
  v_mfma_f32_16x16x32_bf16 v[244:247], a[152:155], v[172:175], v[244:247]
  v_mfma_f32_16x16x32_bf16 v[244:247], a[184:187], v[176:179], v[244:247]
  v_mfma_f32_16x16x32_bf16 v[244:247], a[216:219], v[180:183], v[244:247]
  v_mfma_f32_16x16x32_bf16 v[248:251], a[28:31], v[156:159], 0
  ds_write_b128 v9, a[244:247] offset:5120
  v_mfma_f32_16x16x32_bf16 v[248:251], a[60:63], v[160:163], v[248:251]
  v_mfma_f32_16x16x32_bf16 v[248:251], a[92:95], v[164:167], v[248:251]
  v_mfma_f32_16x16x32_bf16 v[248:251], a[124:127], v[168:171], v[248:251]
  buffer_store_dwordx4 v[108:111], v8, s[24:27], s97 offen offset:1024 sc1
  v_mfma_f32_16x16x32_bf16 v[248:251], a[156:159], v[172:175], v[248:251]
  s_mul_i32 s46, s91, 114688
  s_add_u32 s46, s46, s93
  v_mfma_f32_16x16x32_bf16 v[248:251], a[188:191], v[176:179], v[248:251]
  v_add_u32 v30, s46, v8
  v_mfma_f32_16x16x32_bf16 v[248:251], a[220:223], v[180:183], v[248:251]
  s_andn2_b32 s6, 0xff000000, s51
  s_cbranch_scc1 L_rslow_59
L_rok_58:
  s_waitcnt vmcnt(10)
  v_mfma_f32_16x16x32_bf16 a[224:227], a[0:3], v[184:187], 0
  s_lshl_b32 s97, s88, 2
  s_add_u32 s97, s97, s62
  v_mfma_f32_16x16x32_bf16 a[224:227], a[32:35], v[188:191], a[224:227]
  s_waitcnt lgkmcnt(0)
  s_barrier
  v_mfma_f32_16x16x32_bf16 a[224:227], a[64:67], v[192:195], a[224:227]
  ds_read_b128 v[96:99], v16 offset:0
  v_mfma_f32_16x16x32_bf16 a[224:227], a[96:99], v[196:199], a[224:227]
  buffer_load_dwordx4 v[156:159], v30, s[24:27], s72 offen sc1
  ds_read_b128 v[100:103], v16 offset:1024
  v_mfma_f32_16x16x32_bf16 a[224:227], a[128:131], v[200:203], a[224:227]
  ds_read_b128 v[104:107], v17 offset:0
  v_mfma_f32_16x16x32_bf16 a[224:227], a[160:163], v[204:207], a[224:227]
  ds_read_b128 v[108:111], v17 offset:1024
  v_mfma_f32_16x16x32_bf16 a[224:227], a[192:195], v[208:211], a[224:227]
  ds_read_b128 v[112:115], v18 offset:0
  v_mfma_f32_16x16x32_bf16 a[228:231], a[4:7], v[184:187], 0
  ds_read_b128 v[116:119], v18 offset:1024
  v_mfma_f32_16x16x32_bf16 a[228:231], a[36:39], v[188:191], a[228:231]
  v_mfma_f32_16x16x32_bf16 a[228:231], a[68:71], v[192:195], a[228:231]
  s_lshl_b32 s97, s97, 13
  s_add_u32 s97, s97, s92
  v_mfma_f32_16x16x32_bf16 a[228:231], a[100:103], v[196:199], a[228:231]
  buffer_load_dwordx4 v[160:163], v30, s[24:27], s73 offen sc1
  v_mfma_f32_16x16x32_bf16 a[228:231], a[132:135], v[200:203], a[228:231]
  v_mfma_f32_16x16x32_bf16 a[228:231], a[164:167], v[204:207], a[228:231]
  s_waitcnt lgkmcnt(2)
  v_add_f32 v96, v96, v104
  v_mfma_f32_16x16x32_bf16 a[228:231], a[196:199], v[208:211], a[228:231]
  v_add_f32 v97, v97, v105
  v_add_f32 v98, v98, v106
  v_mfma_f32_16x16x32_bf16 a[232:235], a[8:11], v[184:187], 0
  ds_write_b128 v9, a[224:227] offset:32768
  v_add_f32 v99, v99, v107
  v_mfma_f32_16x16x32_bf16 a[232:235], a[40:43], v[188:191], a[232:235]
  v_add_f32 v100, v100, v108
  v_add_f32 v101, v101, v109
  v_mfma_f32_16x16x32_bf16 a[232:235], a[72:75], v[192:195], a[232:235]
  v_add_f32 v102, v102, v110
  v_add_f32 v103, v103, v111
  v_mfma_f32_16x16x32_bf16 a[232:235], a[104:107], v[196:199], a[232:235]
  buffer_load_dwordx4 v[164:167], v30, s[24:27], s74 offen sc1
  s_waitcnt lgkmcnt(1)
  v_mfma_f32_16x16x32_bf16 a[232:235], a[136:139], v[200:203], a[232:235]
  v_add_f32 v96, v96, v112
  v_add_f32 v97, v97, v113
  v_mfma_f32_16x16x32_bf16 a[232:235], a[168:171], v[204:207], a[232:235]
  v_add_f32 v98, v98, v114
  v_add_f32 v99, v99, v115
  v_mfma_f32_16x16x32_bf16 a[232:235], a[200:203], v[208:211], a[232:235]
  v_add_f32 v100, v100, v116
  v_add_f32 v101, v101, v117
  v_mfma_f32_16x16x32_bf16 a[236:239], a[12:15], v[184:187], 0
  ds_write_b128 v9, a[228:231] offset:33792
  v_add_f32 v102, v102, v118
  v_mfma_f32_16x16x32_bf16 a[236:239], a[44:47], v[188:191], a[236:239]
  v_add_f32 v103, v103, v119
  v_add_f32 v96, v96, v244
  v_mfma_f32_16x16x32_bf16 a[236:239], a[76:79], v[192:195], a[236:239]
  v_add_f32 v97, v97, v245
  v_add_f32 v98, v98, v246
  v_mfma_f32_16x16x32_bf16 a[236:239], a[108:111], v[196:199], a[236:239]
  buffer_load_dwordx4 v[168:171], v30, s[24:27], s75 offen sc1
  v_add_f32 v99, v99, v247
  v_mfma_f32_16x16x32_bf16 a[236:239], a[140:143], v[200:203], a[236:239]
  v_add_f32 v100, v100, v248
  v_add_f32 v101, v101, v249
  v_mfma_f32_16x16x32_bf16 a[236:239], a[172:175], v[204:207], a[236:239]
  v_add_f32 v102, v102, v250
  v_add_f32 v103, v103, v251
  v_mfma_f32_16x16x32_bf16 a[236:239], a[204:207], v[208:211], a[236:239]
  v_perm_b32 v104, v96, v13, s52
  v_perm_b32 v105, v97, v13, s53
  v_mfma_f32_16x16x32_bf16 a[240:243], a[16:19], v[184:187], 0
  ds_write_b128 v9, a[232:235] offset:34816
  v_perm_b32 v106, v98, v13, s54
  v_mfma_f32_16x16x32_bf16 a[240:243], a[48:51], v[188:191], a[240:243]
  v_perm_b32 v107, v99, v13, s55
  v_perm_b32 v108, v100, v13, s52
  v_mfma_f32_16x16x32_bf16 a[240:243], a[80:83], v[192:195], a[240:243]
  v_perm_b32 v109, v101, v13, s53
  v_perm_b32 v110, v102, v13, s54
  v_mfma_f32_16x16x32_bf16 a[240:243], a[112:115], v[196:199], a[240:243]
  buffer_load_dwordx4 v[172:175], v30, s[24:27], s76 offen sc1
  v_perm_b32 v111, v103, v13, s55
  v_mfma_f32_16x16x32_bf16 a[240:243], a[144:147], v[200:203], a[240:243]
  v_mfma_f32_16x16x32_bf16 a[240:243], a[176:179], v[204:207], a[240:243]
  v_mfma_f32_16x16x32_bf16 a[240:243], a[208:211], v[208:211], a[240:243]
  v_mfma_f32_16x16x32_bf16 a[244:247], a[20:23], v[184:187], 0
  ds_write_b128 v9, a[236:239] offset:35840
  v_mfma_f32_16x16x32_bf16 a[244:247], a[52:55], v[188:191], a[244:247]
  v_mfma_f32_16x16x32_bf16 a[244:247], a[84:87], v[192:195], a[244:247]
  v_mfma_f32_16x16x32_bf16 a[244:247], a[116:119], v[196:199], a[244:247]
  buffer_load_dwordx4 v[176:179], v30, s[24:27], s77 offen sc1
  v_mfma_f32_16x16x32_bf16 a[244:247], a[148:151], v[200:203], a[244:247]
  v_mfma_f32_16x16x32_bf16 a[244:247], a[180:183], v[204:207], a[244:247]
  v_mfma_f32_16x16x32_bf16 a[244:247], a[212:215], v[208:211], a[244:247]
  buffer_store_dwordx4 v[104:107], v8, s[24:27], s97 offen offset:0 sc1
  v_mfma_f32_16x16x32_bf16 v[244:247], a[24:27], v[184:187], 0
  ds_write_b128 v9, a[240:243] offset:36864
  v_mfma_f32_16x16x32_bf16 v[244:247], a[56:59], v[188:191], v[244:247]
  v_mfma_f32_16x16x32_bf16 v[244:247], a[88:91], v[192:195], v[244:247]
  v_mfma_f32_16x16x32_bf16 v[244:247], a[120:123], v[196:199], v[244:247]
  buffer_load_dwordx4 v[180:183], v30, s[24:27], s78 offen sc1
  v_mfma_f32_16x16x32_bf16 v[244:247], a[152:155], v[200:203], v[244:247]
  v_mfma_f32_16x16x32_bf16 v[244:247], a[184:187], v[204:207], v[244:247]
  v_mfma_f32_16x16x32_bf16 v[244:247], a[216:219], v[208:211], v[244:247]
  v_mfma_f32_16x16x32_bf16 v[248:251], a[28:31], v[184:187], 0
  ds_write_b128 v9, a[244:247] offset:37888
  v_mfma_f32_16x16x32_bf16 v[248:251], a[60:63], v[188:191], v[248:251]
  v_mfma_f32_16x16x32_bf16 v[248:251], a[92:95], v[192:195], v[248:251]
  v_mfma_f32_16x16x32_bf16 v[248:251], a[124:127], v[196:199], v[248:251]
  buffer_store_dwordx4 v[108:111], v8, s[24:27], s97 offen offset:1024 sc1
  v_mfma_f32_16x16x32_bf16 v[248:251], a[156:159], v[200:203], v[248:251]
  v_mfma_f32_16x16x32_bf16 v[248:251], a[188:191], v[204:207], v[248:251]
  v_mfma_f32_16x16x32_bf16 v[248:251], a[220:223], v[208:211], v[248:251]
  s_waitcnt vmcnt(10)
  v_mfma_f32_16x16x32_bf16 a[224:227], a[0:3], v[128:131], 0
  s_lshl_b32 s97, s89, 2
  s_add_u32 s97, s97, s62
  v_mfma_f32_16x16x32_bf16 a[224:227], a[32:35], v[132:135], a[224:227]
  s_waitcnt lgkmcnt(0)
  s_barrier
  v_mfma_f32_16x16x32_bf16 a[224:227], a[64:67], v[136:139], a[224:227]
  ds_read_b128 v[96:99], v16 offset:32768
  v_mfma_f32_16x16x32_bf16 a[224:227], a[96:99], v[140:143], a[224:227]
  buffer_load_dwordx4 v[32:35], v8, s[24:27], s8 offen offset:0 sc1
  ds_read_b128 v[100:103], v16 offset:33792
  v_mfma_f32_16x16x32_bf16 a[224:227], a[128:131], v[144:147], a[224:227]
  ds_read_b128 v[104:107], v17 offset:32768
  v_mfma_f32_16x16x32_bf16 a[224:227], a[160:163], v[148:151], a[224:227]
  ds_read_b128 v[108:111], v17 offset:33792
  v_mfma_f32_16x16x32_bf16 a[224:227], a[192:195], v[152:155], a[224:227]
  ds_read_b128 v[112:115], v18 offset:32768
  v_mfma_f32_16x16x32_bf16 a[228:231], a[4:7], v[128:131], 0
  buffer_load_dwordx4 v[36:39], v8, s[24:27], s8 offen offset:1024 sc1
  ds_read_b128 v[116:119], v18 offset:33792
  v_mfma_f32_16x16x32_bf16 a[228:231], a[36:39], v[132:135], a[228:231]
  v_mfma_f32_16x16x32_bf16 a[228:231], a[68:71], v[136:139], a[228:231]
  s_lshl_b32 s97, s97, 13
  s_add_u32 s97, s97, s92
  v_mfma_f32_16x16x32_bf16 a[228:231], a[100:103], v[140:143], a[228:231]
  v_mfma_f32_16x16x32_bf16 a[228:231], a[132:135], v[144:147], a[228:231]
  buffer_load_dwordx4 v[40:43], v8, s[24:27], s9 offen offset:0 sc1
  v_mfma_f32_16x16x32_bf16 a[228:231], a[164:167], v[148:151], a[228:231]
  s_waitcnt lgkmcnt(2)
  v_add_f32 v96, v96, v104
  v_mfma_f32_16x16x32_bf16 a[228:231], a[196:199], v[152:155], a[228:231]
  v_add_f32 v97, v97, v105
  v_add_f32 v98, v98, v106
  v_mfma_f32_16x16x32_bf16 a[232:235], a[8:11], v[128:131], 0
  ds_write_b128 v9, a[224:227] offset:0
  v_add_f32 v99, v99, v107
  v_mfma_f32_16x16x32_bf16 a[232:235], a[40:43], v[132:135], a[232:235]
  buffer_load_dwordx4 v[44:47], v8, s[24:27], s9 offen offset:1024 sc1
  v_add_f32 v100, v100, v108
  v_mfma_f32_16x16x32_bf16 a[232:235], a[72:75], v[136:139], a[232:235]
  v_add_f32 v101, v101, v109
  v_add_f32 v102, v102, v110
  v_mfma_f32_16x16x32_bf16 a[232:235], a[104:107], v[140:143], a[232:235]
  v_add_f32 v103, v103, v111
  s_waitcnt lgkmcnt(1)
  v_mfma_f32_16x16x32_bf16 a[232:235], a[136:139], v[144:147], a[232:235]
  v_add_f32 v96, v96, v112
  v_add_f32 v97, v97, v113
  v_mfma_f32_16x16x32_bf16 a[232:235], a[168:171], v[148:151], a[232:235]
  buffer_load_dwordx4 v[48:51], v8, s[24:27], s10 offen offset:0 sc1
  v_add_f32 v98, v98, v114
  v_mfma_f32_16x16x32_bf16 a[232:235], a[200:203], v[152:155], a[232:235]
  v_add_f32 v99, v99, v115
  v_add_f32 v100, v100, v116
  v_mfma_f32_16x16x32_bf16 a[236:239], a[12:15], v[128:131], 0
  ds_write_b128 v9, a[228:231] offset:1024
  v_add_f32 v101, v101, v117
  v_mfma_f32_16x16x32_bf16 a[236:239], a[44:47], v[132:135], a[236:239]
  v_add_f32 v102, v102, v118
  v_add_f32 v103, v103, v119
  v_mfma_f32_16x16x32_bf16 a[236:239], a[76:79], v[136:139], a[236:239]
  buffer_load_dwordx4 v[52:55], v8, s[24:27], s10 offen offset:1024 sc1
  v_add_f32 v96, v96, v244
  v_mfma_f32_16x16x32_bf16 a[236:239], a[108:111], v[140:143], a[236:239]
  v_add_f32 v97, v97, v245
  v_add_f32 v98, v98, v246
  v_mfma_f32_16x16x32_bf16 a[236:239], a[140:143], v[144:147], a[236:239]
  v_add_f32 v99, v99, v247
  v_add_f32 v100, v100, v248
  v_mfma_f32_16x16x32_bf16 a[236:239], a[172:175], v[148:151], a[236:239]
  v_add_f32 v101, v101, v249
  v_add_f32 v102, v102, v250
  v_mfma_f32_16x16x32_bf16 a[236:239], a[204:207], v[152:155], a[236:239]
  v_add_f32 v103, v103, v251
  v_perm_b32 v104, v96, v13, s52
  v_mfma_f32_16x16x32_bf16 a[240:243], a[16:19], v[128:131], 0
  ds_write_b128 v9, a[232:235] offset:2048
  v_perm_b32 v105, v97, v13, s53
  v_mfma_f32_16x16x32_bf16 a[240:243], a[48:51], v[132:135], a[240:243]
  v_perm_b32 v106, v98, v13, s54
  v_perm_b32 v107, v99, v13, s55
  v_mfma_f32_16x16x32_bf16 a[240:243], a[80:83], v[136:139], a[240:243]
  v_perm_b32 v108, v100, v13, s52
  v_perm_b32 v109, v101, v13, s53
  v_mfma_f32_16x16x32_bf16 a[240:243], a[112:115], v[140:143], a[240:243]
  v_perm_b32 v110, v102, v13, s54
  v_perm_b32 v111, v103, v13, s55
  v_mfma_f32_16x16x32_bf16 a[240:243], a[144:147], v[144:147], a[240:243]
  buffer_store_dwordx4 v[104:107], v8, s[24:27], s97 offen offset:0 sc1
  v_mfma_f32_16x16x32_bf16 a[240:243], a[176:179], v[148:151], a[240:243]
  v_mfma_f32_16x16x32_bf16 a[240:243], a[208:211], v[152:155], a[240:243]
  v_mfma_f32_16x16x32_bf16 a[244:247], a[20:23], v[128:131], 0
  ds_write_b128 v9, a[236:239] offset:3072
  v_mfma_f32_16x16x32_bf16 a[244:247], a[52:55], v[132:135], a[244:247]
  buffer_store_dwordx4 v[108:111], v8, s[24:27], s97 offen offset:1024 sc1
  v_mfma_f32_16x16x32_bf16 a[244:247], a[84:87], v[136:139], a[244:247]
  v_mfma_f32_16x16x32_bf16 a[244:247], a[116:119], v[140:143], a[244:247]
  v_mfma_f32_16x16x32_bf16 a[244:247], a[148:151], v[144:147], a[244:247]
  v_mfma_f32_16x16x32_bf16 a[244:247], a[180:183], v[148:151], a[244:247]
  v_mfma_f32_16x16x32_bf16 a[244:247], a[212:215], v[152:155], a[244:247]
  v_mfma_f32_16x16x32_bf16 v[244:247], a[24:27], v[128:131], 0
  ds_write_b128 v9, a[240:243] offset:4096
  v_mfma_f32_16x16x32_bf16 v[244:247], a[56:59], v[132:135], v[244:247]
  v_mfma_f32_16x16x32_bf16 v[244:247], a[88:91], v[136:139], v[244:247]
  v_mfma_f32_16x16x32_bf16 v[244:247], a[120:123], v[140:143], v[244:247]
  v_mfma_f32_16x16x32_bf16 v[244:247], a[152:155], v[144:147], v[244:247]
  v_mfma_f32_16x16x32_bf16 v[244:247], a[184:187], v[148:151], v[244:247]
  v_mfma_f32_16x16x32_bf16 v[244:247], a[216:219], v[152:155], v[244:247]
  v_mfma_f32_16x16x32_bf16 v[248:251], a[28:31], v[128:131], 0
  ds_write_b128 v9, a[244:247] offset:5120
  v_mfma_f32_16x16x32_bf16 v[248:251], a[60:63], v[132:135], v[248:251]
  v_mfma_f32_16x16x32_bf16 v[248:251], a[92:95], v[136:139], v[248:251]
  v_mfma_f32_16x16x32_bf16 v[248:251], a[124:127], v[140:143], v[248:251]
  v_mfma_f32_16x16x32_bf16 v[248:251], a[156:159], v[144:147], v[248:251]
  v_mfma_f32_16x16x32_bf16 v[248:251], a[188:191], v[148:151], v[248:251]
  v_mfma_f32_16x16x32_bf16 v[248:251], a[220:223], v[152:155], v[248:251]
  s_waitcnt vmcnt(9)
  v_mfma_f32_16x16x32_bf16 a[224:227], a[0:3], v[156:159], 0
  v_mfma_f32_16x16x32_bf16 a[224:227], a[32:35], v[160:163], a[224:227]
  s_waitcnt lgkmcnt(0)
  s_barrier
  v_mfma_f32_16x16x32_bf16 a[224:227], a[64:67], v[164:167], a[224:227]
  ds_read_b128 v[96:99], v16 offset:0
  v_mfma_f32_16x16x32_bf16 a[224:227], a[96:99], v[168:171], a[224:227]
  ds_read_b128 v[100:103], v16 offset:1024
  v_mfma_f32_16x16x32_bf16 a[224:227], a[128:131], v[172:175], a[224:227]
  ds_read_b128 v[104:107], v17 offset:0
  v_mfma_f32_16x16x32_bf16 a[224:227], a[160:163], v[176:179], a[224:227]
  ds_read_b128 v[108:111], v17 offset:1024
  v_mfma_f32_16x16x32_bf16 a[224:227], a[192:195], v[180:183], a[224:227]
  ds_read_b128 v[112:115], v18 offset:0
  v_mfma_f32_16x16x32_bf16 a[228:231], a[4:7], v[156:159], 0
  ds_read_b128 v[116:119], v18 offset:1024
  v_mfma_f32_16x16x32_bf16 a[228:231], a[36:39], v[160:163], a[228:231]
  v_mfma_f32_16x16x32_bf16 a[228:231], a[68:71], v[164:167], a[228:231]
  s_waitcnt lgkmcnt(2)
  v_add_f32 v96, v96, v104
  v_add_f32 v97, v97, v105
  v_mfma_f32_16x16x32_bf16 a[228:231], a[100:103], v[168:171], a[228:231]
  v_add_f32 v98, v98, v106
  v_add_f32 v99, v99, v107
  v_add_f32 v100, v100, v108
  v_mfma_f32_16x16x32_bf16 a[228:231], a[132:135], v[172:175], a[228:231]
  v_add_f32 v101, v101, v109
  v_add_f32 v102, v102, v110
  v_add_f32 v103, v103, v111
  v_mfma_f32_16x16x32_bf16 a[228:231], a[164:167], v[176:179], a[228:231]
  s_waitcnt lgkmcnt(0)
  v_add_f32 v96, v96, v112
  v_add_f32 v97, v97, v113
  v_mfma_f32_16x16x32_bf16 a[228:231], a[196:199], v[180:183], a[228:231]
  v_add_f32 v98, v98, v114
  v_add_f32 v99, v99, v115
  v_add_f32 v100, v100, v116
  v_mfma_f32_16x16x32_bf16 a[232:235], a[8:11], v[156:159], 0
  ds_write_b128 v9, a[224:227] offset:32768
  v_add_f32 v101, v101, v117
  v_add_f32 v102, v102, v118
  v_add_f32 v103, v103, v119
  v_mfma_f32_16x16x32_bf16 a[232:235], a[40:43], v[160:163], a[232:235]
  v_add_f32 v96, v96, v244
  v_add_f32 v97, v97, v245
  v_add_f32 v98, v98, v246
  v_mfma_f32_16x16x32_bf16 a[232:235], a[72:75], v[164:167], a[232:235]
  v_add_f32 v99, v99, v247
  v_add_f32 v100, v100, v248
  v_add_f32 v101, v101, v249
  v_mfma_f32_16x16x32_bf16 a[232:235], a[104:107], v[168:171], a[232:235]
  v_add_f32 v102, v102, v250
  v_add_f32 v103, v103, v251
  s_waitcnt vmcnt(2)
  v_mfma_f32_16x16x32_bf16 a[232:235], a[136:139], v[172:175], a[232:235]
  v_msad_u8 v31, v32, s56, 0
  v_msad_u8 v31, v33, s57, v31
  v_msad_u8 v31, v34, s58, v31
  v_mfma_f32_16x16x32_bf16 a[232:235], a[168:171], v[176:179], a[232:235]
  v_msad_u8 v31, v35, s59, v31
  v_msad_u8 v31, v36, s56, v31
  v_msad_u8 v31, v37, s57, v31
  v_mfma_f32_16x16x32_bf16 a[232:235], a[200:203], v[180:183], a[232:235]
  v_msad_u8 v31, v38, s58, v31
  v_msad_u8 v31, v39, s59, v31
  v_msad_u8 v31, v40, s56, v31
  v_mfma_f32_16x16x32_bf16 a[236:239], a[12:15], v[156:159], 0
  ds_write_b128 v9, a[228:231] offset:33792
  v_msad_u8 v31, v41, s57, v31
  v_msad_u8 v31, v42, s58, v31
  v_msad_u8 v31, v43, s59, v31
  v_mfma_f32_16x16x32_bf16 a[236:239], a[44:47], v[160:163], a[236:239]
  v_msad_u8 v31, v44, s56, v31
  v_msad_u8 v31, v45, s57, v31
  v_msad_u8 v31, v46, s58, v31
  v_mfma_f32_16x16x32_bf16 a[236:239], a[76:79], v[164:167], a[236:239]
  v_msad_u8 v31, v47, s59, v31
  v_msad_u8 v31, v48, s56, v31
  v_msad_u8 v31, v49, s57, v31
  v_mfma_f32_16x16x32_bf16 a[236:239], a[108:111], v[168:171], a[236:239]
  v_msad_u8 v31, v50, s58, v31
  v_msad_u8 v31, v51, s59, v31
  v_msad_u8 v31, v52, s56, v31
  v_mfma_f32_16x16x32_bf16 a[236:239], a[140:143], v[172:175], a[236:239]
  v_msad_u8 v31, v53, s57, v31
  v_msad_u8 v31, v54, s58, v31
  v_msad_u8 v31, v55, s59, v31
  v_mfma_f32_16x16x32_bf16 a[236:239], a[172:175], v[176:179], a[236:239]
  v_cmp_ne_u32 vcc, 0, v31
  s_cbranch_vccnz L_pslow_61
L_pok_60:
  v_add_f32 v32, v32, v40
  v_mfma_f32_16x16x32_bf16 a[236:239], a[204:207], v[180:183], a[236:239]
  v_add_f32 v33, v33, v41
  v_add_f32 v34, v34, v42
  v_add_f32 v35, v35, v43
  v_mfma_f32_16x16x32_bf16 a[240:243], a[16:19], v[156:159], 0
  ds_write_b128 v9, a[232:235] offset:34816
  v_add_f32 v36, v36, v44
  v_add_f32 v37, v37, v45
  v_add_f32 v38, v38, v46
  v_mfma_f32_16x16x32_bf16 a[240:243], a[48:51], v[160:163], a[240:243]
  v_add_f32 v39, v39, v47
  v_add_f32 v32, v32, v48
  v_add_f32 v33, v33, v49
  v_mfma_f32_16x16x32_bf16 a[240:243], a[80:83], v[164:167], a[240:243]
  buffer_load_dwordx4 v[72:75], v8, s[24:27], s18 offen offset:0 sc1
  v_add_f32 v34, v34, v50
  v_add_f32 v35, v35, v51
  v_add_f32 v36, v36, v52
  v_mfma_f32_16x16x32_bf16 a[240:243], a[112:115], v[168:171], a[240:243]
  v_add_f32 v37, v37, v53
  v_add_f32 v38, v38, v54
  v_add_f32 v39, v39, v55
  v_mfma_f32_16x16x32_bf16 a[240:243], a[144:147], v[172:175], a[240:243]
  buffer_load_dwordx4 v[76:79], v8, s[24:27], s18 offen offset:1024 sc1
  v_add_f32 v96, v96, v32
  v_add_f32 v97, v97, v33
  v_add_f32 v98, v98, v34
  v_mfma_f32_16x16x32_bf16 a[240:243], a[176:179], v[176:179], a[240:243]
  v_add_f32 v99, v99, v35
  v_add_f32 v100, v100, v36
  v_add_f32 v101, v101, v37
  v_mfma_f32_16x16x32_bf16 a[240:243], a[208:211], v[180:183], a[240:243]
  buffer_load_dwordx4 v[64:67], v8, s[24:27], s17 offen offset:0 sc1
  v_add_f32 v102, v102, v38
  v_add_f32 v103, v103, v39
  v_cvt_pk_bf16_f32 v80, v96, v97
  v_mfma_f32_16x16x32_bf16 a[244:247], a[20:23], v[156:159], 0
  ds_write_b128 v9, a[236:239] offset:35840
  v_cvt_pk_bf16_f32 v81, v98, v99
  v_cvt_pk_bf16_f32 v82, v100, v101
  v_cvt_pk_bf16_f32 v83, v102, v103
  v_mfma_f32_16x16x32_bf16 a[244:247], a[52:55], v[160:163], a[244:247]
  buffer_load_dwordx4 v[68:71], v8, s[24:27], s17 offen offset:1024 sc1
  v_mfma_f32_16x16x32_bf16 a[244:247], a[84:87], v[164:167], a[244:247]
  v_mfma_f32_16x16x32_bf16 a[244:247], a[116:119], v[168:171], a[244:247]
  buffer_load_dwordx4 v[56:59], v8, s[24:27], s16 offen offset:0 sc1
  v_mfma_f32_16x16x32_bf16 a[244:247], a[148:151], v[172:175], a[244:247]
  v_mfma_f32_16x16x32_bf16 a[244:247], a[180:183], v[176:179], a[244:247]
  buffer_load_dwordx4 v[60:63], v8, s[24:27], s16 offen offset:1024 sc1
  v_mfma_f32_16x16x32_bf16 a[244:247], a[212:215], v[180:183], a[244:247]
  v_mfma_f32_16x16x32_bf16 v[244:247], a[24:27], v[156:159], 0
  ds_write_b128 v9, a[240:243] offset:36864
  v_mfma_f32_16x16x32_bf16 v[244:247], a[56:59], v[160:163], v[244:247]
  s_lshl_b32 s6, s63, 3
  s_add_u32 s6, s6, s90
  s_mul_i32 s6, s6, 114688
  s_lshl_b32 s7, s82, 8
  s_add_u32 s6, s6, s7
  buffer_store_dwordx4 v[80:83], v28, s[28:31], s6 offen
  v_mfma_f32_16x16x32_bf16 v[244:247], a[88:91], v[164:167], v[244:247]
  v_mfma_f32_16x16x32_bf16 v[244:247], a[120:123], v[168:171], v[244:247]
  v_mfma_f32_16x16x32_bf16 v[244:247], a[152:155], v[172:175], v[244:247]
  v_mfma_f32_16x16x32_bf16 v[244:247], a[184:187], v[176:179], v[244:247]
  v_mfma_f32_16x16x32_bf16 v[244:247], a[216:219], v[180:183], v[244:247]
  v_mfma_f32_16x16x32_bf16 v[248:251], a[28:31], v[156:159], 0
  ds_write_b128 v9, a[244:247] offset:37888
  v_mfma_f32_16x16x32_bf16 v[248:251], a[60:63], v[160:163], v[248:251]
  s_waitcnt lgkmcnt(0)
  s_barrier
  v_mfma_f32_16x16x32_bf16 v[248:251], a[92:95], v[164:167], v[248:251]
  ds_read_b128 v[96:99], v16 offset:32768
  ds_read_b128 v[100:103], v16 offset:33792
  v_mfma_f32_16x16x32_bf16 v[248:251], a[124:127], v[168:171], v[248:251]
  ds_read_b128 v[104:107], v17 offset:32768
  ds_read_b128 v[108:111], v17 offset:33792
  v_mfma_f32_16x16x32_bf16 v[248:251], a[156:159], v[172:175], v[248:251]
  ds_read_b128 v[112:115], v18 offset:32768
  ds_read_b128 v[116:119], v18 offset:33792
  v_mfma_f32_16x16x32_bf16 v[248:251], a[188:191], v[176:179], v[248:251]
  s_lshl_b32 s97, s63, 3
  s_add_u32 s97, s97, s91
  s_mul_i32 s97, s97, 114688
  v_mfma_f32_16x16x32_bf16 v[248:251], a[220:223], v[180:183], v[248:251]
  s_lshl_b32 s7, s82, 8
  s_add_u32 s97, s97, s7
  s_waitcnt lgkmcnt(2)
  v_pk_add_f32 v[96:97], v[96:97], v[104:105]
  v_pk_add_f32 v[98:99], v[98:99], v[106:107]
  v_pk_add_f32 v[100:101], v[100:101], v[108:109]
  v_pk_add_f32 v[102:103], v[102:103], v[110:111]
  s_waitcnt lgkmcnt(0)
  v_pk_add_f32 v[96:97], v[96:97], v[112:113]
  v_pk_add_f32 v[98:99], v[98:99], v[114:115]
  v_pk_add_f32 v[100:101], v[100:101], v[116:117]
  v_pk_add_f32 v[102:103], v[102:103], v[118:119]
  v_pk_add_f32 v[96:97], v[96:97], v[244:245]
  v_pk_add_f32 v[98:99], v[98:99], v[246:247]
  v_pk_add_f32 v[100:101], v[100:101], v[248:249]
  v_pk_add_f32 v[102:103], v[102:103], v[250:251]
  s_waitcnt vmcnt(1)
L_pagain_64:
  v_msad_u8 v31, v56, s56, 0
  v_msad_u8 v31, v57, s57, v31
  v_msad_u8 v31, v58, s58, v31
  v_msad_u8 v31, v59, s59, v31
  v_msad_u8 v31, v60, s56, v31
  v_msad_u8 v31, v61, s57, v31
  v_msad_u8 v31, v62, s58, v31
  v_msad_u8 v31, v63, s59, v31
  v_msad_u8 v31, v64, s56, v31
  v_msad_u8 v31, v65, s57, v31
  v_msad_u8 v31, v66, s58, v31
  v_msad_u8 v31, v67, s59, v31
  v_msad_u8 v31, v68, s56, v31
  v_msad_u8 v31, v69, s57, v31
  v_msad_u8 v31, v70, s58, v31
  v_msad_u8 v31, v71, s59, v31
  v_msad_u8 v31, v72, s56, v31
  v_msad_u8 v31, v73, s57, v31
  v_msad_u8 v31, v74, s58, v31
  v_msad_u8 v31, v75, s59, v31
  v_msad_u8 v31, v76, s56, v31
  v_msad_u8 v31, v77, s57, v31
  v_msad_u8 v31, v78, s58, v31
  v_msad_u8 v31, v79, s59, v31
  v_cmp_ne_u32 vcc, 0, v31
  s_cbranch_vccz L_pok_62
  s_cmp_eq_u32 s47, 0
  s_cbranch_scc1 L_pok_62
  s_sub_u32 s47, s47, 1
  buffer_load_dwordx4 v[56:59], v8, s[24:27], s16 offen offset:0 sc1
  buffer_load_dwordx4 v[60:63], v8, s[24:27], s16 offen offset:1024 sc1
  buffer_load_dwordx4 v[64:67], v8, s[24:27], s17 offen offset:0 sc1
  buffer_load_dwordx4 v[68:71], v8, s[24:27], s17 offen offset:1024 sc1
  buffer_load_dwordx4 v[72:75], v8, s[24:27], s18 offen offset:0 sc1
  buffer_load_dwordx4 v[76:79], v8, s[24:27], s18 offen offset:1024 sc1
  s_waitcnt vmcnt(0)
  s_branch L_pagain_64
L_pok_62:
  v_pk_add_f32 v[56:57], v[56:57], v[64:65]
  v_pk_add_f32 v[58:59], v[58:59], v[66:67]
  v_pk_add_f32 v[60:61], v[60:61], v[68:69]
  v_pk_add_f32 v[62:63], v[62:63], v[70:71]
  v_pk_add_f32 v[96:97], v[96:97], v[72:73]
  v_pk_add_f32 v[98:99], v[98:99], v[74:75]
  v_pk_add_f32 v[100:101], v[100:101], v[76:77]
  v_pk_add_f32 v[102:103], v[102:103], v[78:79]
  v_pk_add_f32 v[96:97], v[96:97], v[56:57]
  v_pk_add_f32 v[98:99], v[98:99], v[58:59]
  v_pk_add_f32 v[100:101], v[100:101], v[60:61]
  v_pk_add_f32 v[102:103], v[102:103], v[62:63]
  v_cvt_pk_bf16_f32 v84, v96, v97
  v_cvt_pk_bf16_f32 v85, v98, v99
  v_cvt_pk_bf16_f32 v86, v100, v101
  v_cvt_pk_bf16_f32 v87, v102, v103
  buffer_store_dwordx4 v[84:87], v28, s[28:31], s97 offen
  s_endpgm
L_exit:
  s_endpgm
L_aslow_3:
  s_cmp_eq_u32 s47, 0
  s_cbranch_scc1 L_aok_2
  s_sub_u32 s47, s47, 1
  buffer_load_dword v14, v0, s[40:43], 0 offen sc1
  s_waitcnt vmcnt(0)
  v_cmp_ne_u32 s[50:51], 0, v14
  v_readfirstlane_b32 s48, v14
  s_or_b32 s50, s50, -2
  s_cmp_eq_u64 s[50:51], -1
  s_cbranch_scc0 L_aslow_3
  s_branch L_aok_2
L_aslow_5:
  s_cmp_eq_u32 s47, 0
  s_cbranch_scc1 L_aok_4
  s_sub_u32 s47, s47, 1
  buffer_load_dword v14, v0, s[40:43], 0 offen sc1
  s_waitcnt vmcnt(0)
  v_cmp_ne_u32 s[50:51], 0, v14
  v_readfirstlane_b32 s48, v14
  s_or_b32 s50, s50, -2
  s_cmp_eq_u64 s[50:51], -1
  s_cbranch_scc0 L_aslow_5
  s_branch L_aok_4
L_xslow_7:
  s_mov_b32 s97, 1
L_xloop_8:
  s_cmp_eq_u32 s47, 0
  s_cbranch_scc1 L_xdone_9
  s_sub_u32 s47, s47, 1
  s_nop 7
  buffer_load_dword v14, v11, s[24:27], 0 offen sc1
  s_add_u32 s6, s49, 0
  s_and_b32 s6, s6, 3
  s_lshl_b32 s7, s61, 2
  s_add_u32 s6, s6, s7
  s_lshl_b32 s6, s6, 15
  s_lshl_b32 s7, s3, 13
  s_add_u32 s6, s6, s7
  s_add_u32 s6, s6, 1048576
  v_add_u32 v33, s6, v8
  buffer_load_dwordx4 a[96:99], v33, s[24:27], s8 offen sc1
  buffer_load_dwordx4 a[100:103], v33, s[24:27], s9 offen sc1
  buffer_load_dwordx4 a[104:107], v33, s[24:27], s10 offen sc1
  buffer_load_dwordx4 a[108:111], v33, s[24:27], s11 offen sc1
  buffer_load_dwordx4 a[112:115], v33, s[24:27], s16 offen sc1
  buffer_load_dwordx4 a[116:119], v33, s[24:27], s17 offen sc1
  buffer_load_dwordx4 a[120:123], v33, s[24:27], s18 offen sc1
  buffer_load_dwordx4 a[124:127], v33, s[24:27], s19 offen sc1
  s_add_u32 s6, s49, 1
  s_and_b32 s6, s6, 3
  s_lshl_b32 s7, s61, 2
  s_add_u32 s6, s6, s7
  s_lshl_b32 s6, s6, 15
  s_lshl_b32 s7, s3, 13
  s_add_u32 s6, s6, s7
  s_add_u32 s6, s6, 1048576
  v_add_u32 v33, s6, v8
  buffer_load_dwordx4 a[128:131], v33, s[24:27], s8 offen sc1
  buffer_load_dwordx4 a[132:135], v33, s[24:27], s9 offen sc1
  buffer_load_dwordx4 a[136:139], v33, s[24:27], s10 offen sc1
  buffer_load_dwordx4 a[140:143], v33, s[24:27], s11 offen sc1
  buffer_load_dwordx4 a[144:147], v33, s[24:27], s16 offen sc1
  buffer_load_dwordx4 a[148:151], v33, s[24:27], s17 offen sc1
  buffer_load_dwordx4 a[152:155], v33, s[24:27], s18 offen sc1
  buffer_load_dwordx4 a[156:159], v33, s[24:27], s19 offen sc1
  s_add_u32 s6, s49, 2
  s_and_b32 s6, s6, 3
  s_lshl_b32 s7, s61, 2
  s_add_u32 s6, s6, s7
  s_lshl_b32 s6, s6, 15
  s_lshl_b32 s7, s3, 13
  s_add_u32 s6, s6, s7
  s_add_u32 s6, s6, 1048576
  v_add_u32 v33, s6, v8
  buffer_load_dwordx4 a[160:163], v33, s[24:27], s8 offen sc1
  buffer_load_dwordx4 a[164:167], v33, s[24:27], s9 offen sc1
  buffer_load_dwordx4 a[168:171], v33, s[24:27], s10 offen sc1
  buffer_load_dwordx4 a[172:175], v33, s[24:27], s11 offen sc1
  buffer_load_dwordx4 a[176:179], v33, s[24:27], s16 offen sc1
  s_waitcnt vmcnt(13)
  v_mfma_f32_16x16x32_bf16 a[224:227], v[128:131], a[96:99], 0
  v_mfma_f32_16x16x32_bf16 a[224:227], v[144:147], a[100:103], a[224:227]
  v_mfma_f32_16x16x32_bf16 a[224:227], v[160:163], a[104:107], a[224:227]
  v_mfma_f32_16x16x32_bf16 a[224:227], v[176:179], a[108:111], a[224:227]
  v_mfma_f32_16x16x32_bf16 a[224:227], v[192:195], a[112:115], a[224:227]
  v_mfma_f32_16x16x32_bf16 a[224:227], v[208:211], a[116:119], a[224:227]
  v_mfma_f32_16x16x32_bf16 a[224:227], v[224:227], a[120:123], a[224:227]
  v_mfma_f32_16x16x32_bf16 a[224:227], v[240:243], a[124:127], a[224:227]
  v_mfma_f32_16x16x32_bf16 a[228:231], v[132:135], a[96:99], 0
  v_mfma_f32_16x16x32_bf16 a[228:231], v[148:151], a[100:103], a[228:231]
  v_mfma_f32_16x16x32_bf16 a[228:231], v[164:167], a[104:107], a[228:231]
  v_mfma_f32_16x16x32_bf16 a[228:231], v[180:183], a[108:111], a[228:231]
  v_mfma_f32_16x16x32_bf16 a[228:231], v[196:199], a[112:115], a[228:231]
  v_mfma_f32_16x16x32_bf16 a[228:231], v[212:215], a[116:119], a[228:231]
  v_mfma_f32_16x16x32_bf16 a[228:231], v[228:231], a[120:123], a[228:231]
  v_mfma_f32_16x16x32_bf16 a[228:231], v[244:247], a[124:127], a[228:231]
  s_nop 7
  v_accvgpr_read_b32 v32, a224
  v_cmp_u_f32 vcc, v32, v32
  s_cbranch_vccz L_xdone_9
  s_cmp_eq_u32 s97, 0
  s_cbranch_scc1 L_xdone_9
  v_cmp_eq_u32 s[50:51], v14, v13
  s_nop 1
  s_andn2_b32 s97, 0xffff, s50
  s_branch L_xloop_8
L_xdone_9:
  s_branch L_xok_6
L_xslow_11:
  s_mov_b32 s97, 1
L_xloop_12:
  s_cmp_eq_u32 s47, 0
  s_cbranch_scc1 L_xdone_13
  s_sub_u32 s47, s47, 1
  s_nop 7
  buffer_load_dword v14, v11, s[24:27], 0 offen sc1
  s_add_u32 s6, s49, 1
  s_and_b32 s6, s6, 3
  s_lshl_b32 s7, s61, 2
  s_add_u32 s6, s6, s7
  s_lshl_b32 s6, s6, 15
  s_lshl_b32 s7, s3, 13
  s_add_u32 s6, s6, s7
  s_add_u32 s6, s6, 1048576
  v_add_u32 v33, s6, v8
  buffer_load_dwordx4 a[128:131], v33, s[24:27], s8 offen sc1
  buffer_load_dwordx4 a[132:135], v33, s[24:27], s9 offen sc1
  buffer_load_dwordx4 a[136:139], v33, s[24:27], s10 offen sc1
  buffer_load_dwordx4 a[140:143], v33, s[24:27], s11 offen sc1
  buffer_load_dwordx4 a[144:147], v33, s[24:27], s16 offen sc1
  buffer_load_dwordx4 a[148:151], v33, s[24:27], s17 offen sc1
  buffer_load_dwordx4 a[152:155], v33, s[24:27], s18 offen sc1
  buffer_load_dwordx4 a[156:159], v33, s[24:27], s19 offen sc1
  s_add_u32 s6, s49, 2
  s_and_b32 s6, s6, 3
  s_lshl_b32 s7, s61, 2
  s_add_u32 s6, s6, s7
  s_lshl_b32 s6, s6, 15
  s_lshl_b32 s7, s3, 13
  s_add_u32 s6, s6, s7
  s_add_u32 s6, s6, 1048576
  v_add_u32 v33, s6, v8
  buffer_load_dwordx4 a[160:163], v33, s[24:27], s8 offen sc1
  buffer_load_dwordx4 a[164:167], v33, s[24:27], s9 offen sc1
  buffer_load_dwordx4 a[168:171], v33, s[24:27], s10 offen sc1
  buffer_load_dwordx4 a[172:175], v33, s[24:27], s11 offen sc1
  buffer_load_dwordx4 a[176:179], v33, s[24:27], s16 offen sc1
  buffer_load_dwordx4 a[180:183], v33, s[24:27], s17 offen sc1
  buffer_load_dwordx4 a[184:187], v33, s[24:27], s18 offen sc1
  buffer_load_dwordx4 a[188:191], v33, s[24:27], s19 offen sc1
  s_add_u32 s6, s49, 3
  s_and_b32 s6, s6, 3
  s_lshl_b32 s7, s61, 2
  s_add_u32 s6, s6, s7
  s_lshl_b32 s6, s6, 15
  s_lshl_b32 s7, s3, 13
  s_add_u32 s6, s6, s7
  s_add_u32 s6, s6, 1048576
  v_add_u32 v33, s6, v8
  buffer_load_dwordx4 a[192:195], v33, s[24:27], s8 offen sc1
  buffer_load_dwordx4 a[196:199], v33, s[24:27], s9 offen sc1
  buffer_load_dwordx4 a[200:203], v33, s[24:27], s10 offen sc1
  buffer_load_dwordx4 a[204:207], v33, s[24:27], s11 offen sc1
  buffer_load_dwordx4 a[208:211], v33, s[24:27], s16 offen sc1
  s_waitcnt vmcnt(13)
  v_mfma_f32_16x16x32_bf16 a[240:243], v[128:131], a[128:131], 0
  v_mfma_f32_16x16x32_bf16 a[240:243], v[144:147], a[132:135], a[240:243]
  v_mfma_f32_16x16x32_bf16 a[240:243], v[160:163], a[136:139], a[240:243]
  v_mfma_f32_16x16x32_bf16 a[240:243], v[176:179], a[140:143], a[240:243]
  v_mfma_f32_16x16x32_bf16 a[240:243], v[192:195], a[144:147], a[240:243]
  v_mfma_f32_16x16x32_bf16 a[240:243], v[208:211], a[148:151], a[240:243]
  v_mfma_f32_16x16x32_bf16 a[240:243], v[224:227], a[152:155], a[240:243]
  v_mfma_f32_16x16x32_bf16 a[240:243], v[240:243], a[156:159], a[240:243]
  v_mfma_f32_16x16x32_bf16 a[244:247], v[132:135], a[128:131], 0
  v_mfma_f32_16x16x32_bf16 a[244:247], v[148:151], a[132:135], a[244:247]
  v_mfma_f32_16x16x32_bf16 a[244:247], v[164:167], a[136:139], a[244:247]
  v_mfma_f32_16x16x32_bf16 a[244:247], v[180:183], a[140:143], a[244:247]
  v_mfma_f32_16x16x32_bf16 a[244:247], v[196:199], a[144:147], a[244:247]
  v_mfma_f32_16x16x32_bf16 a[244:247], v[212:215], a[148:151], a[244:247]
  v_mfma_f32_16x16x32_bf16 a[244:247], v[228:231], a[152:155], a[244:247]
  v_mfma_f32_16x16x32_bf16 a[244:247], v[244:247], a[156:159], a[244:247]
  s_nop 7
  v_accvgpr_read_b32 v32, a240
  v_cmp_u_f32 vcc, v32, v32
  s_cbranch_vccz L_xdone_13
  s_cmp_eq_u32 s97, 0
  s_cbranch_scc1 L_xdone_13
  v_cmp_eq_u32 s[50:51], v14, v13
  s_nop 1
  s_andn2_b32 s97, 0xffff, s50
  s_branch L_xloop_12
L_xdone_13:
  s_branch L_xok_10
L_xslow_15:
  s_mov_b32 s97, 1
L_xloop_16:
  s_cmp_eq_u32 s47, 0
  s_cbranch_scc1 L_xdone_17
  s_sub_u32 s47, s47, 1
  s_nop 7
  buffer_load_dword v14, v11, s[24:27], 0 offen sc1
  s_add_u32 s6, s49, 2
  s_and_b32 s6, s6, 3
  s_lshl_b32 s7, s61, 2
  s_add_u32 s6, s6, s7
  s_lshl_b32 s6, s6, 15
  s_lshl_b32 s7, s3, 13
  s_add_u32 s6, s6, s7
  s_add_u32 s6, s6, 1048576
  v_add_u32 v33, s6, v8
  buffer_load_dwordx4 a[160:163], v33, s[24:27], s8 offen sc1
  buffer_load_dwordx4 a[164:167], v33, s[24:27], s9 offen sc1
  buffer_load_dwordx4 a[168:171], v33, s[24:27], s10 offen sc1
  buffer_load_dwordx4 a[172:175], v33, s[24:27], s11 offen sc1
  buffer_load_dwordx4 a[176:179], v33, s[24:27], s16 offen sc1
  buffer_load_dwordx4 a[180:183], v33, s[24:27], s17 offen sc1
  buffer_load_dwordx4 a[184:187], v33, s[24:27], s18 offen sc1
  buffer_load_dwordx4 a[188:191], v33, s[24:27], s19 offen sc1
  s_add_u32 s6, s49, 3
  s_and_b32 s6, s6, 3
  s_lshl_b32 s7, s61, 2
  s_add_u32 s6, s6, s7
  s_lshl_b32 s6, s6, 15
  s_lshl_b32 s7, s3, 13
  s_add_u32 s6, s6, s7
  s_add_u32 s6, s6, 1048576
  v_add_u32 v33, s6, v8
  buffer_load_dwordx4 a[192:195], v33, s[24:27], s8 offen sc1
  buffer_load_dwordx4 a[196:199], v33, s[24:27], s9 offen sc1
  buffer_load_dwordx4 a[200:203], v33, s[24:27], s10 offen sc1
  buffer_load_dwordx4 a[204:207], v33, s[24:27], s11 offen sc1
  buffer_load_dwordx4 a[208:211], v33, s[24:27], s16 offen sc1
  buffer_load_dwordx4 a[212:215], v33, s[24:27], s17 offen sc1
  buffer_load_dwordx4 a[216:219], v33, s[24:27], s18 offen sc1
  buffer_load_dwordx4 a[220:223], v33, s[24:27], s19 offen sc1
  s_waitcnt vmcnt(0)
  v_mfma_f32_16x16x32_bf16 a[224:227], v[128:131], a[160:163], 0
  v_mfma_f32_16x16x32_bf16 a[224:227], v[144:147], a[164:167], a[224:227]
  v_mfma_f32_16x16x32_bf16 a[224:227], v[160:163], a[168:171], a[224:227]
  v_mfma_f32_16x16x32_bf16 a[224:227], v[176:179], a[172:175], a[224:227]
  v_mfma_f32_16x16x32_bf16 a[224:227], v[192:195], a[176:179], a[224:227]
  v_mfma_f32_16x16x32_bf16 a[224:227], v[208:211], a[180:183], a[224:227]
  v_mfma_f32_16x16x32_bf16 a[224:227], v[224:227], a[184:187], a[224:227]
  v_mfma_f32_16x16x32_bf16 a[224:227], v[240:243], a[188:191], a[224:227]
  v_mfma_f32_16x16x32_bf16 a[228:231], v[132:135], a[160:163], 0
  v_mfma_f32_16x16x32_bf16 a[228:231], v[148:151], a[164:167], a[228:231]
  v_mfma_f32_16x16x32_bf16 a[228:231], v[164:167], a[168:171], a[228:231]
  v_mfma_f32_16x16x32_bf16 a[228:231], v[180:183], a[172:175], a[228:231]
  v_mfma_f32_16x16x32_bf16 a[228:231], v[196:199], a[176:179], a[228:231]
  v_mfma_f32_16x16x32_bf16 a[228:231], v[212:215], a[180:183], a[228:231]
  v_mfma_f32_16x16x32_bf16 a[228:231], v[228:231], a[184:187], a[228:231]
  v_mfma_f32_16x16x32_bf16 a[228:231], v[244:247], a[188:191], a[228:231]
  s_nop 7
  v_accvgpr_read_b32 v32, a224
  v_cmp_u_f32 vcc, v32, v32
  s_cbranch_vccz L_xdone_17
  s_cmp_eq_u32 s97, 0
  s_cbranch_scc1 L_xdone_17
  v_cmp_eq_u32 s[50:51], v14, v13
  s_nop 1
  s_andn2_b32 s97, 0xffff, s50
  s_branch L_xloop_16
L_xdone_17:
  s_branch L_xok_14
L_xslow_19:
  s_mov_b32 s97, 1
L_xloop_20:
  s_cmp_eq_u32 s47, 0
  s_cbranch_scc1 L_xdone_21
  s_sub_u32 s47, s47, 1
  s_nop 7
  buffer_load_dword v14, v11, s[24:27], 0 offen sc1
  s_add_u32 s6, s49, 3
  s_and_b32 s6, s6, 3
  s_lshl_b32 s7, s61, 2
  s_add_u32 s6, s6, s7
  s_lshl_b32 s6, s6, 15
  s_lshl_b32 s7, s3, 13
  s_add_u32 s6, s6, s7
  s_add_u32 s6, s6, 1048576
  v_add_u32 v33, s6, v8
  buffer_load_dwordx4 a[192:195], v33, s[24:27], s8 offen sc1
  buffer_load_dwordx4 a[196:199], v33, s[24:27], s9 offen sc1
  buffer_load_dwordx4 a[200:203], v33, s[24:27], s10 offen sc1
  buffer_load_dwordx4 a[204:207], v33, s[24:27], s11 offen sc1
  buffer_load_dwordx4 a[208:211], v33, s[24:27], s16 offen sc1
  buffer_load_dwordx4 a[212:215], v33, s[24:27], s17 offen sc1
  buffer_load_dwordx4 a[216:219], v33, s[24:27], s18 offen sc1
  buffer_load_dwordx4 a[220:223], v33, s[24:27], s19 offen sc1
  s_waitcnt vmcnt(0)
  v_mfma_f32_16x16x32_bf16 a[240:243], v[128:131], a[192:195], 0
  v_mfma_f32_16x16x32_bf16 a[240:243], v[144:147], a[196:199], a[240:243]
  v_mfma_f32_16x16x32_bf16 a[240:243], v[160:163], a[200:203], a[240:243]
  v_mfma_f32_16x16x32_bf16 a[240:243], v[176:179], a[204:207], a[240:243]
  v_mfma_f32_16x16x32_bf16 a[240:243], v[192:195], a[208:211], a[240:243]
  v_mfma_f32_16x16x32_bf16 a[240:243], v[208:211], a[212:215], a[240:243]
  v_mfma_f32_16x16x32_bf16 a[240:243], v[224:227], a[216:219], a[240:243]
  v_mfma_f32_16x16x32_bf16 a[240:243], v[240:243], a[220:223], a[240:243]
  v_mfma_f32_16x16x32_bf16 a[244:247], v[132:135], a[192:195], 0
  v_mfma_f32_16x16x32_bf16 a[244:247], v[148:151], a[196:199], a[244:247]
  v_mfma_f32_16x16x32_bf16 a[244:247], v[164:167], a[200:203], a[244:247]
  v_mfma_f32_16x16x32_bf16 a[244:247], v[180:183], a[204:207], a[244:247]
  v_mfma_f32_16x16x32_bf16 a[244:247], v[196:199], a[208:211], a[244:247]
  v_mfma_f32_16x16x32_bf16 a[244:247], v[212:215], a[212:215], a[244:247]
  v_mfma_f32_16x16x32_bf16 a[244:247], v[228:231], a[216:219], a[244:247]
  v_mfma_f32_16x16x32_bf16 a[244:247], v[244:247], a[220:223], a[244:247]
  s_nop 7
  v_accvgpr_read_b32 v32, a240
  v_cmp_u_f32 vcc, v32, v32
  s_cbranch_vccz L_xdone_21
  s_cmp_eq_u32 s97, 0
  s_cbranch_scc1 L_xdone_21
  v_cmp_eq_u32 s[50:51], v14, v13
  s_nop 1
  s_andn2_b32 s97, 0xffff, s50
  s_branch L_xloop_20
L_xdone_21:
  s_branch L_xok_18
L_rslow_23:
  s_cmp_eq_u32 s47, 0
  s_cbranch_scc1 L_rok_22
  s_sub_u32 s47, s47, 1
  buffer_load_dword v14, v12, s[24:27], 0 offen sc1
  s_waitcnt vmcnt(0)
  v_cmp_eq_u32 s[50:51], v14, v13
  s_nop 1
  s_andn2_b32 s6, 0xff, s50
  s_cbranch_scc1 L_rslow_23
  s_branch L_rok_22
L_rslow_25:
  s_cmp_eq_u32 s47, 0
  s_cbranch_scc1 L_rok_24
  s_sub_u32 s47, s47, 1
  buffer_load_dword v14, v12, s[24:27], 0 offen sc1
  s_waitcnt vmcnt(0)
  v_cmp_eq_u32 s[50:51], v14, v13
  s_nop 1
  s_andn2_b32 s6, 0xff00, s50
  s_cbranch_scc1 L_rslow_25
  s_branch L_rok_24
L_aslow_27:
  s_cmp_eq_u32 s47, 0
  s_cbranch_scc1 L_aok_26
  s_sub_u32 s47, s47, 1
  buffer_load_dword v14, v0, s[40:43], 0 offen sc1
  s_waitcnt vmcnt(0)
  v_cmp_ne_u32 s[50:51], 0, v14
  v_readfirstlane_b32 s48, v14
  s_or_b32 s50, s50, -2
  s_cmp_eq_u64 s[50:51], -1
  s_cbranch_scc0 L_aslow_27
  s_branch L_aok_26
L_xslow_29:
  s_mov_b32 s97, 1
L_xloop_30:
  s_cmp_eq_u32 s47, 0
  s_cbranch_scc1 L_xdone_31
  s_sub_u32 s47, s47, 1
  s_nop 7
  buffer_load_dword v14, v11, s[24:27], 0 offen sc1
  s_add_u32 s6, s49, 0
  s_and_b32 s6, s6, 3
  s_lshl_b32 s7, s61, 2
  s_add_u32 s6, s6, s7
  s_lshl_b32 s6, s6, 15
  s_lshl_b32 s7, s3, 13
  s_add_u32 s6, s6, s7
  s_add_u32 s6, s6, 1048576
  v_add_u32 v33, s6, v8
  buffer_load_dwordx4 a[96:99], v33, s[24:27], s8 offen sc1
  buffer_load_dwordx4 a[100:103], v33, s[24:27], s9 offen sc1
  buffer_load_dwordx4 a[104:107], v33, s[24:27], s10 offen sc1
  buffer_load_dwordx4 a[108:111], v33, s[24:27], s11 offen sc1
  buffer_load_dwordx4 a[112:115], v33, s[24:27], s16 offen sc1
  buffer_load_dwordx4 a[116:119], v33, s[24:27], s17 offen sc1
  buffer_load_dwordx4 a[120:123], v33, s[24:27], s18 offen sc1
  buffer_load_dwordx4 a[124:127], v33, s[24:27], s19 offen sc1
  s_add_u32 s6, s49, 1
  s_and_b32 s6, s6, 3
  s_lshl_b32 s7, s61, 2
  s_add_u32 s6, s6, s7
  s_lshl_b32 s6, s6, 15
  s_lshl_b32 s7, s3, 13
  s_add_u32 s6, s6, s7
  s_add_u32 s6, s6, 1048576
  v_add_u32 v33, s6, v8
  buffer_load_dwordx4 a[128:131], v33, s[24:27], s8 offen sc1
  buffer_load_dwordx4 a[132:135], v33, s[24:27], s9 offen sc1
  buffer_load_dwordx4 a[136:139], v33, s[24:27], s10 offen sc1
  buffer_load_dwordx4 a[140:143], v33, s[24:27], s11 offen sc1
  buffer_load_dwordx4 a[144:147], v33, s[24:27], s16 offen sc1
  buffer_load_dwordx4 a[148:151], v33, s[24:27], s17 offen sc1
  buffer_load_dwordx4 a[152:155], v33, s[24:27], s18 offen sc1
  buffer_load_dwordx4 a[156:159], v33, s[24:27], s19 offen sc1
  s_add_u32 s6, s49, 2
  s_and_b32 s6, s6, 3
  s_lshl_b32 s7, s61, 2
  s_add_u32 s6, s6, s7
  s_lshl_b32 s6, s6, 15
  s_lshl_b32 s7, s3, 13
  s_add_u32 s6, s6, s7
  s_add_u32 s6, s6, 1048576
  v_add_u32 v33, s6, v8
  buffer_load_dwordx4 a[160:163], v33, s[24:27], s8 offen sc1
  buffer_load_dwordx4 a[164:167], v33, s[24:27], s9 offen sc1
  buffer_load_dwordx4 a[168:171], v33, s[24:27], s10 offen sc1
  buffer_load_dwordx4 a[172:175], v33, s[24:27], s11 offen sc1
  buffer_load_dwordx4 a[176:179], v33, s[24:27], s16 offen sc1
  s_waitcnt vmcnt(13)
  v_mfma_f32_16x16x32_bf16 a[224:227], v[128:131], a[96:99], 0
  v_mfma_f32_16x16x32_bf16 a[224:227], v[144:147], a[100:103], a[224:227]
  v_mfma_f32_16x16x32_bf16 a[224:227], v[160:163], a[104:107], a[224:227]
  v_mfma_f32_16x16x32_bf16 a[224:227], v[176:179], a[108:111], a[224:227]
  v_mfma_f32_16x16x32_bf16 a[224:227], v[192:195], a[112:115], a[224:227]
  v_mfma_f32_16x16x32_bf16 a[224:227], v[208:211], a[116:119], a[224:227]
  v_mfma_f32_16x16x32_bf16 a[224:227], v[224:227], a[120:123], a[224:227]
  v_mfma_f32_16x16x32_bf16 a[224:227], v[240:243], a[124:127], a[224:227]
  v_mfma_f32_16x16x32_bf16 a[228:231], v[132:135], a[96:99], 0
  v_mfma_f32_16x16x32_bf16 a[228:231], v[148:151], a[100:103], a[228:231]
  v_mfma_f32_16x16x32_bf16 a[228:231], v[164:167], a[104:107], a[228:231]
  v_mfma_f32_16x16x32_bf16 a[228:231], v[180:183], a[108:111], a[228:231]
  v_mfma_f32_16x16x32_bf16 a[228:231], v[196:199], a[112:115], a[228:231]
  v_mfma_f32_16x16x32_bf16 a[228:231], v[212:215], a[116:119], a[228:231]
  v_mfma_f32_16x16x32_bf16 a[228:231], v[228:231], a[120:123], a[228:231]
  v_mfma_f32_16x16x32_bf16 a[228:231], v[244:247], a[124:127], a[228:231]
  s_nop 7
  v_accvgpr_read_b32 v32, a224
  v_cmp_u_f32 vcc, v32, v32
  s_cbranch_vccz L_xdone_31
  s_cmp_eq_u32 s97, 0
  s_cbranch_scc1 L_xdone_31
  v_cmp_eq_u32 s[50:51], v14, v13
  s_nop 1
  s_andn2_b32 s97, 0xffff, s50
  s_branch L_xloop_30
L_xdone_31:
  s_branch L_xok_28
L_xslow_33:
  s_mov_b32 s97, 1
L_xloop_34:
  s_cmp_eq_u32 s47, 0
  s_cbranch_scc1 L_xdone_35
  s_sub_u32 s47, s47, 1
  s_nop 7
  buffer_load_dword v14, v11, s[24:27], 0 offen sc1
  s_add_u32 s6, s49, 1
  s_and_b32 s6, s6, 3
  s_lshl_b32 s7, s61, 2
  s_add_u32 s6, s6, s7
  s_lshl_b32 s6, s6, 15
  s_lshl_b32 s7, s3, 13
  s_add_u32 s6, s6, s7
  s_add_u32 s6, s6, 1048576
  v_add_u32 v33, s6, v8
  buffer_load_dwordx4 a[128:131], v33, s[24:27], s8 offen sc1
  buffer_load_dwordx4 a[132:135], v33, s[24:27], s9 offen sc1
  buffer_load_dwordx4 a[136:139], v33, s[24:27], s10 offen sc1
  buffer_load_dwordx4 a[140:143], v33, s[24:27], s11 offen sc1
  buffer_load_dwordx4 a[144:147], v33, s[24:27], s16 offen sc1
  buffer_load_dwordx4 a[148:151], v33, s[24:27], s17 offen sc1
  buffer_load_dwordx4 a[152:155], v33, s[24:27], s18 offen sc1
  buffer_load_dwordx4 a[156:159], v33, s[24:27], s19 offen sc1
  s_add_u32 s6, s49, 2
  s_and_b32 s6, s6, 3
  s_lshl_b32 s7, s61, 2
  s_add_u32 s6, s6, s7
  s_lshl_b32 s6, s6, 15
  s_lshl_b32 s7, s3, 13
  s_add_u32 s6, s6, s7
  s_add_u32 s6, s6, 1048576
  v_add_u32 v33, s6, v8
  buffer_load_dwordx4 a[160:163], v33, s[24:27], s8 offen sc1
  buffer_load_dwordx4 a[164:167], v33, s[24:27], s9 offen sc1
  buffer_load_dwordx4 a[168:171], v33, s[24:27], s10 offen sc1
  buffer_load_dwordx4 a[172:175], v33, s[24:27], s11 offen sc1
  buffer_load_dwordx4 a[176:179], v33, s[24:27], s16 offen sc1
  buffer_load_dwordx4 a[180:183], v33, s[24:27], s17 offen sc1
  buffer_load_dwordx4 a[184:187], v33, s[24:27], s18 offen sc1
  buffer_load_dwordx4 a[188:191], v33, s[24:27], s19 offen sc1
  s_add_u32 s6, s49, 3
  s_and_b32 s6, s6, 3
  s_lshl_b32 s7, s61, 2
  s_add_u32 s6, s6, s7
  s_lshl_b32 s6, s6, 15
  s_lshl_b32 s7, s3, 13
  s_add_u32 s6, s6, s7
  s_add_u32 s6, s6, 1048576
  v_add_u32 v33, s6, v8
  buffer_load_dwordx4 a[192:195], v33, s[24:27], s8 offen sc1
  buffer_load_dwordx4 a[196:199], v33, s[24:27], s9 offen sc1
  buffer_load_dwordx4 a[200:203], v33, s[24:27], s10 offen sc1
  buffer_load_dwordx4 a[204:207], v33, s[24:27], s11 offen sc1
  buffer_load_dwordx4 a[208:211], v33, s[24:27], s16 offen sc1
  s_waitcnt vmcnt(13)
  v_mfma_f32_16x16x32_bf16 a[240:243], v[128:131], a[128:131], 0
  v_mfma_f32_16x16x32_bf16 a[240:243], v[144:147], a[132:135], a[240:243]
  v_mfma_f32_16x16x32_bf16 a[240:243], v[160:163], a[136:139], a[240:243]
  v_mfma_f32_16x16x32_bf16 a[240:243], v[176:179], a[140:143], a[240:243]
  v_mfma_f32_16x16x32_bf16 a[240:243], v[192:195], a[144:147], a[240:243]
  v_mfma_f32_16x16x32_bf16 a[240:243], v[208:211], a[148:151], a[240:243]
  v_mfma_f32_16x16x32_bf16 a[240:243], v[224:227], a[152:155], a[240:243]
  v_mfma_f32_16x16x32_bf16 a[240:243], v[240:243], a[156:159], a[240:243]
  v_mfma_f32_16x16x32_bf16 a[244:247], v[132:135], a[128:131], 0
  v_mfma_f32_16x16x32_bf16 a[244:247], v[148:151], a[132:135], a[244:247]
  v_mfma_f32_16x16x32_bf16 a[244:247], v[164:167], a[136:139], a[244:247]
  v_mfma_f32_16x16x32_bf16 a[244:247], v[180:183], a[140:143], a[244:247]
  v_mfma_f32_16x16x32_bf16 a[244:247], v[196:199], a[144:147], a[244:247]
  v_mfma_f32_16x16x32_bf16 a[244:247], v[212:215], a[148:151], a[244:247]
  v_mfma_f32_16x16x32_bf16 a[244:247], v[228:231], a[152:155], a[244:247]
  v_mfma_f32_16x16x32_bf16 a[244:247], v[244:247], a[156:159], a[244:247]
  s_nop 7
  v_accvgpr_read_b32 v32, a240
  v_cmp_u_f32 vcc, v32, v32
  s_cbranch_vccz L_xdone_35
  s_cmp_eq_u32 s97, 0
  s_cbranch_scc1 L_xdone_35
  v_cmp_eq_u32 s[50:51], v14, v13
  s_nop 1
  s_andn2_b32 s97, 0xffff, s50
  s_branch L_xloop_34
L_xdone_35:
  s_branch L_xok_32
L_xslow_37:
  s_mov_b32 s97, 1
L_xloop_38:
  s_cmp_eq_u32 s47, 0
  s_cbranch_scc1 L_xdone_39
  s_sub_u32 s47, s47, 1
  s_nop 7
  buffer_load_dword v14, v11, s[24:27], 0 offen sc1
  s_add_u32 s6, s49, 2
  s_and_b32 s6, s6, 3
  s_lshl_b32 s7, s61, 2
  s_add_u32 s6, s6, s7
  s_lshl_b32 s6, s6, 15
  s_lshl_b32 s7, s3, 13
  s_add_u32 s6, s6, s7
  s_add_u32 s6, s6, 1048576
  v_add_u32 v33, s6, v8
  buffer_load_dwordx4 a[160:163], v33, s[24:27], s8 offen sc1
  buffer_load_dwordx4 a[164:167], v33, s[24:27], s9 offen sc1
  buffer_load_dwordx4 a[168:171], v33, s[24:27], s10 offen sc1
  buffer_load_dwordx4 a[172:175], v33, s[24:27], s11 offen sc1
  buffer_load_dwordx4 a[176:179], v33, s[24:27], s16 offen sc1
  buffer_load_dwordx4 a[180:183], v33, s[24:27], s17 offen sc1
  buffer_load_dwordx4 a[184:187], v33, s[24:27], s18 offen sc1
  buffer_load_dwordx4 a[188:191], v33, s[24:27], s19 offen sc1
  s_add_u32 s6, s49, 3
  s_and_b32 s6, s6, 3
  s_lshl_b32 s7, s61, 2
  s_add_u32 s6, s6, s7
  s_lshl_b32 s6, s6, 15
  s_lshl_b32 s7, s3, 13
  s_add_u32 s6, s6, s7
  s_add_u32 s6, s6, 1048576
  v_add_u32 v33, s6, v8
  buffer_load_dwordx4 a[192:195], v33, s[24:27], s8 offen sc1
  buffer_load_dwordx4 a[196:199], v33, s[24:27], s9 offen sc1
  buffer_load_dwordx4 a[200:203], v33, s[24:27], s10 offen sc1
  buffer_load_dwordx4 a[204:207], v33, s[24:27], s11 offen sc1
  buffer_load_dwordx4 a[208:211], v33, s[24:27], s16 offen sc1
  buffer_load_dwordx4 a[212:215], v33, s[24:27], s17 offen sc1
  buffer_load_dwordx4 a[216:219], v33, s[24:27], s18 offen sc1
  buffer_load_dwordx4 a[220:223], v33, s[24:27], s19 offen sc1
  s_waitcnt vmcnt(0)
  v_mfma_f32_16x16x32_bf16 a[224:227], v[128:131], a[160:163], 0
  v_mfma_f32_16x16x32_bf16 a[224:227], v[144:147], a[164:167], a[224:227]
  v_mfma_f32_16x16x32_bf16 a[224:227], v[160:163], a[168:171], a[224:227]
  v_mfma_f32_16x16x32_bf16 a[224:227], v[176:179], a[172:175], a[224:227]
  v_mfma_f32_16x16x32_bf16 a[224:227], v[192:195], a[176:179], a[224:227]
  v_mfma_f32_16x16x32_bf16 a[224:227], v[208:211], a[180:183], a[224:227]
  v_mfma_f32_16x16x32_bf16 a[224:227], v[224:227], a[184:187], a[224:227]
  v_mfma_f32_16x16x32_bf16 a[224:227], v[240:243], a[188:191], a[224:227]
  v_mfma_f32_16x16x32_bf16 a[228:231], v[132:135], a[160:163], 0
  v_mfma_f32_16x16x32_bf16 a[228:231], v[148:151], a[164:167], a[228:231]
  v_mfma_f32_16x16x32_bf16 a[228:231], v[164:167], a[168:171], a[228:231]
  v_mfma_f32_16x16x32_bf16 a[228:231], v[180:183], a[172:175], a[228:231]
  v_mfma_f32_16x16x32_bf16 a[228:231], v[196:199], a[176:179], a[228:231]
  v_mfma_f32_16x16x32_bf16 a[228:231], v[212:215], a[180:183], a[228:231]
  v_mfma_f32_16x16x32_bf16 a[228:231], v[228:231], a[184:187], a[228:231]
  v_mfma_f32_16x16x32_bf16 a[228:231], v[244:247], a[188:191], a[228:231]
  s_nop 7
  v_accvgpr_read_b32 v32, a224
  v_cmp_u_f32 vcc, v32, v32
  s_cbranch_vccz L_xdone_39
  s_cmp_eq_u32 s97, 0
  s_cbranch_scc1 L_xdone_39
  v_cmp_eq_u32 s[50:51], v14, v13
  s_nop 1
  s_andn2_b32 s97, 0xffff, s50
  s_branch L_xloop_38
L_xdone_39:
  s_branch L_xok_36
L_xslow_41:
  s_mov_b32 s97, 1
L_xloop_42:
  s_cmp_eq_u32 s47, 0
  s_cbranch_scc1 L_xdone_43
  s_sub_u32 s47, s47, 1
  s_nop 7
  buffer_load_dword v14, v11, s[24:27], 0 offen sc1
  s_add_u32 s6, s49, 3
  s_and_b32 s6, s6, 3
  s_lshl_b32 s7, s61, 2
  s_add_u32 s6, s6, s7
  s_lshl_b32 s6, s6, 15
  s_lshl_b32 s7, s3, 13
  s_add_u32 s6, s6, s7
  s_add_u32 s6, s6, 1048576
  v_add_u32 v33, s6, v8
  buffer_load_dwordx4 a[192:195], v33, s[24:27], s8 offen sc1
  buffer_load_dwordx4 a[196:199], v33, s[24:27], s9 offen sc1
  buffer_load_dwordx4 a[200:203], v33, s[24:27], s10 offen sc1
  buffer_load_dwordx4 a[204:207], v33, s[24:27], s11 offen sc1
  buffer_load_dwordx4 a[208:211], v33, s[24:27], s16 offen sc1
  buffer_load_dwordx4 a[212:215], v33, s[24:27], s17 offen sc1
  buffer_load_dwordx4 a[216:219], v33, s[24:27], s18 offen sc1
  buffer_load_dwordx4 a[220:223], v33, s[24:27], s19 offen sc1
  s_waitcnt vmcnt(0)
  v_mfma_f32_16x16x32_bf16 a[240:243], v[128:131], a[192:195], 0
  v_mfma_f32_16x16x32_bf16 a[240:243], v[144:147], a[196:199], a[240:243]
  v_mfma_f32_16x16x32_bf16 a[240:243], v[160:163], a[200:203], a[240:243]
  v_mfma_f32_16x16x32_bf16 a[240:243], v[176:179], a[204:207], a[240:243]
  v_mfma_f32_16x16x32_bf16 a[240:243], v[192:195], a[208:211], a[240:243]
  v_mfma_f32_16x16x32_bf16 a[240:243], v[208:211], a[212:215], a[240:243]
  v_mfma_f32_16x16x32_bf16 a[240:243], v[224:227], a[216:219], a[240:243]
  v_mfma_f32_16x16x32_bf16 a[240:243], v[240:243], a[220:223], a[240:243]
  v_mfma_f32_16x16x32_bf16 a[244:247], v[132:135], a[192:195], 0
  v_mfma_f32_16x16x32_bf16 a[244:247], v[148:151], a[196:199], a[244:247]
  v_mfma_f32_16x16x32_bf16 a[244:247], v[164:167], a[200:203], a[244:247]
  v_mfma_f32_16x16x32_bf16 a[244:247], v[180:183], a[204:207], a[244:247]
  v_mfma_f32_16x16x32_bf16 a[244:247], v[196:199], a[208:211], a[244:247]
  v_mfma_f32_16x16x32_bf16 a[244:247], v[212:215], a[212:215], a[244:247]
  v_mfma_f32_16x16x32_bf16 a[244:247], v[228:231], a[216:219], a[244:247]
  v_mfma_f32_16x16x32_bf16 a[244:247], v[244:247], a[220:223], a[244:247]
  s_nop 7
  v_accvgpr_read_b32 v32, a240
  v_cmp_u_f32 vcc, v32, v32
  s_cbranch_vccz L_xdone_43
  s_cmp_eq_u32 s97, 0
  s_cbranch_scc1 L_xdone_43
  v_cmp_eq_u32 s[50:51], v14, v13
  s_nop 1
  s_andn2_b32 s97, 0xffff, s50
  s_branch L_xloop_42
L_xdone_43:
  s_branch L_xok_40
L_rslow_45:
  s_cmp_eq_u32 s47, 0
  s_cbranch_scc1 L_rok_44
  s_sub_u32 s47, s47, 1
  buffer_load_dword v14, v12, s[24:27], 0 offen sc1
  s_waitcnt vmcnt(0)
  v_cmp_eq_u32 s[50:51], v14, v13
  s_nop 1
  s_andn2_b32 s6, 0xff, s50
  s_cbranch_scc1 L_rslow_45
  s_branch L_rok_44
L_rslow_47:
  s_cmp_eq_u32 s47, 0
  s_cbranch_scc1 L_rok_46
  s_sub_u32 s47, s47, 1
  buffer_load_dword v14, v12, s[24:27], 0 offen sc1
  s_waitcnt vmcnt(0)
  v_cmp_eq_u32 s[50:51], v14, v13
  s_nop 1
  s_andn2_b32 s6, 0xff00, s50
  s_cbranch_scc1 L_rslow_47
  s_branch L_rok_46
L_rslow_49:
  s_cmp_eq_u32 s47, 0
  s_cbranch_scc1 L_rok_48
  s_sub_u32 s47, s47, 1
  buffer_load_dword v14, v12, s[24:27], 0 offen sc1
  s_waitcnt vmcnt(0)
  v_cmp_eq_u32 s[50:51], v14, v13
  s_nop 1
  s_andn2_b32 s6, 0xff0000, s50
  s_cbranch_scc1 L_rslow_49
  s_branch L_rok_48
L_rslow_51:
  s_cmp_eq_u32 s47, 0
  s_cbranch_scc1 L_rok_50
  s_sub_u32 s47, s47, 1
  buffer_load_dword v14, v12, s[24:27], 0 offen sc1
  s_waitcnt vmcnt(0)
  v_cmp_eq_u32 s[50:51], v14, v13
  s_nop 1
  s_andn2_b32 s6, 0xff000000, s50
  s_cbranch_scc1 L_rslow_51
  s_branch L_rok_50
L_rslow_53:
  s_cmp_eq_u32 s47, 0
  s_cbranch_scc1 L_rok_52
  s_sub_u32 s47, s47, 1
  buffer_load_dword v14, v12, s[24:27], 0 offen sc1
  s_waitcnt vmcnt(0)
  v_cmp_eq_u32 s[50:51], v14, v13
  s_nop 1
  s_andn2_b32 s6, 0xff, s51
  s_cbranch_scc1 L_rslow_53
  s_branch L_rok_52
L_rslow_55:
  s_cmp_eq_u32 s47, 0
  s_cbranch_scc1 L_rok_54
  s_sub_u32 s47, s47, 1
  buffer_load_dword v14, v12, s[24:27], 0 offen sc1
  s_waitcnt vmcnt(0)
  v_cmp_eq_u32 s[50:51], v14, v13
  s_nop 1
  s_andn2_b32 s6, 0xff00, s51
  s_cbranch_scc1 L_rslow_55
  s_branch L_rok_54
L_rslow_57:
  s_cmp_eq_u32 s47, 0
  s_cbranch_scc1 L_rok_56
  s_sub_u32 s47, s47, 1
  buffer_load_dword v14, v12, s[24:27], 0 offen sc1
  s_waitcnt vmcnt(0)
  v_cmp_eq_u32 s[50:51], v14, v13
  s_nop 1
  s_andn2_b32 s6, 0xff0000, s51
  s_cbranch_scc1 L_rslow_57
  s_branch L_rok_56
L_rslow_59:
  s_cmp_eq_u32 s47, 0
  s_cbranch_scc1 L_rok_58
  s_sub_u32 s47, s47, 1
  buffer_load_dword v14, v12, s[24:27], 0 offen sc1
  s_waitcnt vmcnt(0)
  v_cmp_eq_u32 s[50:51], v14, v13
  s_nop 1
  s_andn2_b32 s6, 0xff000000, s51
  s_cbranch_scc1 L_rslow_59
  s_branch L_rok_58
L_pslow_61:
  s_cmp_eq_u32 s47, 0
  s_cbranch_scc1 L_pok_60
  s_sub_u32 s47, s47, 1
  buffer_load_dwordx4 v[32:35], v8, s[24:27], s8 offen offset:0 sc1
  buffer_load_dwordx4 v[36:39], v8, s[24:27], s8 offen offset:1024 sc1
  buffer_load_dwordx4 v[40:43], v8, s[24:27], s9 offen offset:0 sc1
  buffer_load_dwordx4 v[44:47], v8, s[24:27], s9 offen offset:1024 sc1
  buffer_load_dwordx4 v[48:51], v8, s[24:27], s10 offen offset:0 sc1
  buffer_load_dwordx4 v[52:55], v8, s[24:27], s10 offen offset:1024 sc1
  s_waitcnt vmcnt(0)
  v_msad_u8 v31, v32, s56, 0
  v_msad_u8 v31, v33, s57, v31
  v_msad_u8 v31, v34, s58, v31
  v_msad_u8 v31, v35, s59, v31
  v_msad_u8 v31, v36, s56, v31
  v_msad_u8 v31, v37, s57, v31
  v_msad_u8 v31, v38, s58, v31
  v_msad_u8 v31, v39, s59, v31
  v_msad_u8 v31, v40, s56, v31
  v_msad_u8 v31, v41, s57, v31
  v_msad_u8 v31, v42, s58, v31
  v_msad_u8 v31, v43, s59, v31
  v_msad_u8 v31, v44, s56, v31
  v_msad_u8 v31, v45, s57, v31
  v_msad_u8 v31, v46, s58, v31
  v_msad_u8 v31, v47, s59, v31
  v_msad_u8 v31, v48, s56, v31
  v_msad_u8 v31, v49, s57, v31
  v_msad_u8 v31, v50, s58, v31
  v_msad_u8 v31, v51, s59, v31
  v_msad_u8 v31, v52, s56, v31
  v_msad_u8 v31, v53, s57, v31
  v_msad_u8 v31, v54, s58, v31
  v_msad_u8 v31, v55, s59, v31
  v_cmp_ne_u32 vcc, 0, v31
  s_cbranch_vccnz L_pslow_61
  s_branch L_pok_60
L_end:
.section .rodata,"a"
.p2align 6
.amdhsa_kernel standalone__weight_only_int_quip__sampling_kernel
  .amdhsa_next_free_vgpr 512
  .amdhsa_next_free_sgpr 102
  .amdhsa_accum_offset 256
  .amdhsa_group_segment_fixed_size 0
  .amdhsa_kernarg_size 72
  .amdhsa_user_sgpr_count 2
  .amdhsa_user_sgpr_kernarg_segment_ptr 1
  .amdhsa_system_sgpr_workgroup_id_x 1
.end_amdhsa_kernel
```
